```python
import torch

def _softmax(x, axis=-1):
    return torch.softmax(x, dim=axis)

def _gelu(x):
    return torch.nn.functional.gelu(x, approximate='tanh')

def _silu(x):
    return torch.nn.functional.silu(x)

def _sigmoid(x):
    return torch.sigmoid(x)

def _layernorm(x, axis=-1, eps=1e-05):
    m = x.mean(dim=axis, keepdim=True)
    v = x.var(dim=axis, keepdim=True, unbiased=False)
    return (x - m) / torch.sqrt(v + eps)

def _scatter_add(tgt, idx, src, axis=0):
    return tgt.clone().index_add_(axis, idx, src)

def _segment_sum(src, seg, n):
    out = torch.zeros((n,) + src.shape[1:], dtype=src.dtype)
    return out.index_add_(0, seg, src)

def _pad(x, pw):
    flat = tuple((v for pair in reversed(pw) for v in pair))
    return torch.nn.functional.pad(x, flat)
kernel_name = 'adaLN_cond__linear_kernel_hedgehog__glu_gated_swiglu__prompt'

def setup_inputs():

    _w = lambda a: (lambda t: t.to(torch.bfloat16) if t.is_floating_point() else t)(torch.as_tensor(a))

    def _A_setup():
        B, S, D, H = (1, 2048, 640, 32)
        Dh = D // H
        return {'x': _w((lambda *s: torch.randn(*s, dtype=torch.bfloat16) * 0.05)(B, S, D)), 'wqkv': _w((lambda *s: torch.randn(*s, dtype=torch.bfloat16) * 0.4)(D, 3 * D)), 'w_phi': _w((lambda *s: torch.randn(*s, dtype=torch.bfloat16) * 0.4)(H, Dh, Dh) * Dh ** (-0.5)), 'wo': _w((lambda *s: torch.randn(*s, dtype=torch.bfloat16) * 0.05)(D, D))}
    _A_in = _A_setup()

    def _B_setup():
        B, S, D, F = (1, 2048, 640, 1728)
        return {'x': _w((lambda *s: torch.randn(*s, dtype=torch.bfloat16) * 0.05)(B, S, D)), 'w1': _w((lambda *s: torch.randn(*s, dtype=torch.bfloat16) * 0.8)(D, F) * (2.0 / D) ** 0.5), 'w3': _w((lambda *s: torch.randn(*s, dtype=torch.bfloat16) * 0.8)(D, F) * (2.0 / D) ** 0.5), 'w2': _w((lambda *s: torch.randn(*s, dtype=torch.bfloat16) * 0.8)(F, D) * (2.0 / F) ** 0.5)}
    _B_in = _B_setup()
    return {'A_x': _A_in['x'], 'A_wqkv': _A_in['wqkv'], 'A_w_phi': _A_in['w_phi'], 'A_wo': _A_in['wo'], 'B_x': _B_in['x'], 'B_w1': _B_in['w1'], 'B_w3': _B_in['w3'], 'B_w2': _B_in['w2'], 'c': _w((lambda *s: torch.randn(*s, dtype=torch.bfloat16) * 0.2)(1, 640) * 8.0), 'w_mod': _w((lambda *s: torch.randn(*s, dtype=torch.bfloat16) * 0.2)(640, 6 * 640) * 640 ** (-0.5) * 8.0)}

def reference(A_x, A_wqkv, A_w_phi, A_wo, B_x, B_w1, B_w3, B_w2, c, w_mod):

    def _A_ref(x, wqkv, w_phi, wo):
        B, S, D = x.shape
        H = 32
        Dh = D // H
        qkv = (lambda x, *d: x.permute(*d))((x @ wqkv).reshape(B, S, 3, H, Dh), 2, 0, 3, 1, 4)
        q, k, v = (qkv[0], qkv[1], qkv[2])
        pq = torch.einsum('bhsd,hdf->bhsf', q, w_phi)
        pk = torch.einsum('bhsd,hdf->bhsf', k, w_phi)
        phi_q = torch.concatenate([_softmax(pq, axis=-1), _softmax(-pq, axis=-1)], axis=-1)
        phi_k = torch.concatenate([_softmax(pk, axis=-1), _softmax(-pk, axis=-1)], axis=-1)
        kv = torch.einsum('bhsf,bhsd->bhfd', phi_k, v)
        z = torch.einsum('bhsf->bhf', phi_k)
        num = torch.einsum('bhqf,bhfd->bhqd', phi_q, kv)
        den = torch.einsum('bhqf,bhf->bhq', phi_q, z)[..., None] + 1e-06
        o = num / den
        return (lambda x, *d: x.permute(*d))(o, 0, 2, 1, 3).reshape(B, S, D) @ wo

    def _B_ref(x, w1, w3, w2):
        gate = torch.einsum('bsd,df->bsf', x, w1)
        up = torch.einsum('bsd,df->bsf', x, w3)
        h = _silu(gate) * up
        out = torch.einsum('bsf,fd->bsd', h, w2)
        return out
    x = A_x
    mod = (_silu(c) @ w_mod).reshape(c.shape[0], 6, 1, -1)
    sa, ca, ga, sb, cb, gb = (mod[:, 0].clone(), mod[:, 1].clone(), mod[:, 2].clone(), mod[:, 3].clone(), mod[:, 4].clone(), mod[:, 5].clone())
    h = _layernorm(x, axis=-1) * (1 + ca) + sa
    x = x + ga * _A_ref(h, A_wqkv, A_w_phi, A_wo)
    h = _layernorm(x, axis=-1) * (1 + cb) + sb
    x = x + gb * _B_ref(h, B_w1, B_w3, B_w2)
    return x
```

```asm
; @launch grid=(256,1,1) block=(256,1,1) lds=163840
.amdgcn_target "amdgcn-amd-amdhsa--gfx950"
.text
.globl adaLN_cond__linear_kernel_hedgehog__glu_gated_swiglu__prompt_kernel
.p2align 8
.type adaLN_cond__linear_kernel_hedgehog__glu_gated_swiglu__prompt_kernel,@function
adaLN_cond__linear_kernel_hedgehog__glu_gated_swiglu__prompt_kernel:
    s_cmp_ge_u32 s2, 256
    s_cbranch_scc1 L_end
    s_load_dwordx16 s[4:19], s[0:1], 0
    s_load_dwordx8 s[20:27], s[0:1], 64
    s_load_dwordx2 s[28:29], s[0:1], 96
    s_mov_b32 s3, 1073741824
    v_lshrrev_b32 v1, 6, v0
    v_and_b32 v0, 63, v0
    v_readfirstlane_b32 s56, v1
    v_lshlrev_b32 v1, 4, v0
    s_and_b32 s57, s2, 7
    s_lshr_b32 s58, s2, 3
    s_mov_b32 s65, s2
    s_getpc_b64 s[68:69]
L_pc:
    s_lshl_b32 s70, s58, 2
    s_add_u32 s70, s70, s56
    s_lshl_b32 s70, s70, 9
    v_and_b32 v4, 3, v0
    v_lshlrev_b32 v4, 7, v4
    v_add_u32 v4, s70, v4
    v_min_u32 v4, L_end-L_pc, v4
    v_mov_b32 v5, s69
    v_add_co_u32 v4, vcc, s68, v4
    s_nop 1
    v_addc_co_u32 v5, vcc, 0, v5, vcc
    s_mov_b64 exec, 15
    global_load_dword v254, v[4:5], off
    s_mov_b64 exec, -1
    v_bfe_u32 v9, v0, 4, 1
    v_and_b32 v10, 7, v0
    v_xor_b32 v4, v10, v9
    v_lshlrev_b32 v4, 4, v4
    v_lshrrev_b32 v5, 3, v0
    s_mov_b32 s68, 1280
    v_xor_b32 v11, v10, v5
    v_lshlrev_b32 v11, 4, v11
    v_mad_u32_u24 v12, v5, s68, v11
    s_mov_b32 s68, 7680
    v_and_b32 v11, 2, v5
    v_xor_b32 v11, v10, v11
    v_lshlrev_b32 v11, 4, v11
    v_mad_u32_u24 v244, v5, s68, v11
    s_mul_i32 s70, s65, 10240
    s_lshl_b32 s69, s56, 7
    s_add_u32 s70, s70, s69
    s_cmp_lt_u32 s56, 2
    s_cselect_b32 s71, s70, s3
    s_mul_i32 s73, s56, 3072
    s_add_u32 s73, s73, 20480
    s_lshr_b32 s68, s58, 2
    s_lshl_b32 s68, s68, 3
    s_add_u32 s68, s68, s57
    s_and_b32 s69, s58, 3
    s_mul_i32 s72, s69, 160
    s_mul_i32 s84, s56, 40
    s_add_u32 s72, s72, s84
    s_mul_i32 s72, s72, 7680
    s_lshl_b32 s84, s68, 7
    s_add_u32 s72, s72, s84
    s_lshl_b32 s84, s68, 2
    s_add_u32 s84, s84, s69
    s_lshl_b32 s84, s84, 2
    s_add_u32 s84, s84, s56
    s_lshl_b32 s84, s84, 6
    s_add_u32 s84, s84, 851968
    s_sub_u32 s68, s68, 0
    s_cmp_lt_u32 s68, 20
    s_cselect_b32 s72, s72, s3
    s_cselect_b32 s84, s84, s3
    s_waitcnt lgkmcnt(0)
    s_mov_b32 s0, s65
    s_mov_b32 s36, s22
    s_mov_b32 s37, s23
    s_mov_b32 s38, 4915200
    s_mov_b32 s39, 0x20000
    s_mov_b32 s48, s4
    s_mov_b32 s49, s5
    s_mov_b32 s50, 2621440
    s_mov_b32 s51, 0x20000
    s_mov_b32 s32, s28
    s_mov_b32 s33, s29
    s_mov_b32 s34, 29360128
    s_mov_b32 s35, 0x20000
    s_cmp_lg_u32 s56, 0
    s_cbranch_scc1 L_noc_1
    s_mov_b32 s40, s20
    s_mov_b32 s41, s21
    s_mov_b32 s42, 1280
    s_mov_b32 s43, 0x20000
    v_lshlrev_b32 v9, 2, v0
    buffer_load_dwordx4 v[64:67], v1, s[40:43], 0 offen
    buffer_load_dword v68, v9, s[40:43], 0 offen offset:1024
L_noc_1:
    buffer_load_dwordx2 v[2:3], off, s[32:35], 0 sc1
    s_add_u32 m0, s73, 0
    s_nop 0
    buffer_load_dwordx4 v12, s[48:51], s70 offen offset:0 nt lds
    s_add_u32 m0, s73, 512
    s_nop 0
    buffer_load_dwordx4 v12, s[48:51], s70 offen offset:512 nt lds
    s_add_u32 m0, s73, 1024
    s_nop 0
    buffer_load_dwordx4 v12, s[48:51], s71 offen offset:1024 nt lds
    s_mul_i32 s68, s56, 5120
    s_add_u32 m0, s68, 0
    s_add_u32 s68, s72, 0
    buffer_load_dwordx4 v244, s[36:39], s68 offen nt lds
    s_mul_i32 s68, s56, 5120
    s_add_u32 m0, s68, 1024
    s_add_u32 s68, s72, 61440
    buffer_load_dwordx4 v244, s[36:39], s68 offen nt lds
    s_mul_i32 s68, s56, 5120
    s_add_u32 m0, s68, 2048
    s_add_u32 s68, s72, 122880
    buffer_load_dwordx4 v244, s[36:39], s68 offen nt lds
    s_mul_i32 s68, s56, 5120
    s_add_u32 m0, s68, 3072
    s_add_u32 s68, s72, 184320
    buffer_load_dwordx4 v244, s[36:39], s68 offen nt lds
    s_mul_i32 s68, s56, 5120
    s_add_u32 m0, s68, 4096
    s_add_u32 s68, s72, 245760
    buffer_load_dwordx4 v244, s[36:39], s68 offen nt lds
    s_lshr_b32 s68, s57, 2
    s_lshl_b32 s68, s68, 3
    s_lshr_b32 s69, s58, 2
    s_add_u32 s59, s68, s69
    s_and_b32 s68, s57, 3
    s_lshl_b32 s68, s68, 2
    s_and_b32 s69, s58, 3
    s_add_u32 s60, s68, s69
    s_lshr_b32 s68, s57, 0
    s_lshl_b32 s68, s68, 2
    s_lshr_b32 s69, s58, 3
    s_add_u32 s61, s68, s69
    s_and_b32 s68, s57, 0
    s_lshl_b32 s68, s68, 3
    s_and_b32 s69, s58, 7
    s_add_u32 s62, s68, s69
    s_lshr_b32 s68, s57, 2
    s_lshl_b32 s68, s68, 3
    s_lshr_b32 s69, s58, 2
    s_add_u32 s63, s68, s69
    s_and_b32 s68, s57, 3
    s_lshl_b32 s68, s68, 2
    s_and_b32 s69, s58, 3
    s_add_u32 s64, s68, s69
    s_mul_i32 s21, s2, 1
    s_lshl_b32 s21, s21, 2
    s_add_u32 s21, s21, s56
    s_lshl_b32 s21, s21, 7
    s_add_u32 s21, s21, 28311552
    s_mov_b32 s66, 0x3fb8aa3b
    s_mov_b32 s67, 0x3fb8aa3b
    v_lshrrev_b32 v6, 4, v0
    v_lshlrev_b32 v6, 10, v6
    v_bfe_u32 v9, v0, 2, 2
    v_lshl_add_u32 v6, v9, 7, v6
    v_lshrrev_b32 v9, 1, v9
    v_and_b32 v8, 3, v0
    v_lshl_or_b32 v9, v8, 1, v9
    v_lshl_add_u32 v6, v9, 4, v6
    v_lshlrev_b32 v8, 4, v8
    s_lshl_b32 s68, s56, 13
    s_add_u32 s87, s68, 102400
    v_add_u32 v34, s87, v6
    v_xor_b32 v35, 16, v34
    s_lshl_b32 s68, s56, 12
    s_add_u32 s68, s68, 32768
    v_add_u32 v6, s68, v6
    v_xor_b32 v7, 16, v6
    s_cmp_lg_u32 s56, 0
    s_cbranch_scc1 L_jqkv_2
    s_mov_b32 s52, s10
    s_mov_b32 s53, s11
    s_mov_b32 s54, 819200
    s_mov_b32 s55, 0x20000
    s_cmp_lt_u32 s2, 200
    s_cselect_b32 s75, 0, s3
    s_cselect_b32 s72, s2, 0
    s_mul_i32 s74, s72, 205
    s_lshr_b32 s74, s74, 11
    s_mul_i32 s73, s74, 10
    s_sub_u32 s73, s72, s73
    s_mov_b32 s76, 1280
    s_add_u32 s77, s75, 12582912
    s_sub_u32 s69, s74, 10
    s_lshl_b32 s69, s69, 1
    s_add_u32 s69, s69, 1
    s_lshl_b32 s70, s74, 1
    s_cmp_lt_u32 s74, 10
    s_cselect_b32 s69, s70, s69
    s_mul_i32 s69, s69, 5120
    s_add_u32 s69, s69, s77
    s_lshl_b32 s68, s73, 4
    v_and_b32 v9, 15, v0
    v_add_u32 v9, s68, v9
    v_mul_u32_u24 v10, 103, v9
    v_lshrrev_b32 v10, 11, v10
    v_mul_u32_u24 v11, 20, v10
    v_sub_u32 v11, v9, v11
    v_lshrrev_b32 v12, 3, v11
    v_lshlrev_b32 v12, 1, v12
    v_and_b32 v13, 1, v11
    v_add_u32 v13, v12, v13
    v_bfe_u32 v14, v11, 1, 2
    v_and_b32 v15, 3, v11
    v_cmp_gt_u32 vcc, 16, v11
    s_nop 1
    v_cndmask_b32 v13, 4, v13, vcc
    v_cndmask_b32 v14, v15, v14, vcc
    v_lshlrev_b32 v13, 10, v13
    v_lshl_add_u32 v13, v14, 8, v13
    v_and_b32 v14, 2, v14
    v_lshrrev_b32 v15, 4, v0
    v_xor_b32 v14, v14, v15
    v_lshl_add_u32 v13, v14, 6, v13
    s_mov_b32 s68, 102400
    v_mad_u32_u24 v13, v10, s68, v13
    v_add_u32 v29, s69, v13
    s_branch L_jgo_3
L_jqkv_2:
    s_mov_b32 s52, s6
    s_mov_b32 s53, s7
    s_mov_b32 s54, 2457600
    s_mov_b32 s55, 0x20000
    s_mul_i32 s72, s2, 3
    s_add_u32 s72, s72, s56
    s_sub_u32 s72, s72, 1
    s_cmp_lt_u32 s72, 600
    s_cselect_b32 s75, 0, s3
    s_cselect_b32 s72, s72, 0
    s_mul_i32 s73, s72, 205
    s_lshr_b32 s73, s73, 12
    s_mul_i32 s74, s73, 20
    s_sub_u32 s74, s72, s74
    s_mov_b32 s76, 3840
    s_add_u32 s77, s75, 2097152
    s_mul_i32 s68, s73, 205
    s_lshr_b32 s68, s68, 11
    s_mul_i32 s69, s68, 10
    s_sub_u32 s69, s73, s69
    s_lshl_b32 s69, s69, 4
    v_and_b32 v9, 15, v0
    v_add_u32 v9, s69, v9
    v_mul_u32_u24 v10, 103, v9
    v_lshrrev_b32 v10, 9, v10
    v_mul_u32_u24 v11, 5, v10
    v_sub_u32 v11, v9, v11
    v_and_b32 v12, 1, v10
    v_lshlrev_b32 v14, 1, v12
    s_lshr_b32 s69, s68, 1
    v_add_u32 v13, s69, v14
    v_lshlrev_b32 v13, 8, v13
    v_lshl_add_u32 v13, v11, 10, v13
    v_and_b32 v9, 1, v11
    v_add_u32 v9, v9, v14
    v_cmp_gt_u32 vcc, 4, v11
    s_nop 1
    v_cndmask_b32 v9, v12, v9, vcc
    v_lshlrev_b32 v9, 8, v9
    v_lshrrev_b32 v11, 1, v11
    v_lshl_add_u32 v9, v11, 10, v9
    s_cmp_eq_u32 s68, 0
    s_cselect_b64 vcc, -1, 0
    s_mul_i32 s69, s74, 5120
    s_mul_i32 s70, s74, 2560
    s_add_u32 s70, s70, 102400
    s_cmp_eq_u32 s68, 0
    s_cselect_b32 s69, s70, s69
    s_add_u32 s69, s69, s77
    v_cndmask_b32 v13, v13, v9, vcc
    v_and_b32 v14, 2, v14
    v_lshrrev_b32 v15, 4, v0
    v_xor_b32 v14, v14, v15
    v_lshl_add_u32 v13, v14, 6, v13
    s_mov_b32 s70, 153600
    v_lshrrev_b32 v10, 1, v10
    v_mad_u32_u24 v13, v10, s70, v13
    v_add_u32 v29, s69, v13
L_jgo_3:
    s_lshl_b32 s94, s76, 3
    s_mul_i32 s93, s94, s74
    s_lshl_b32 s93, s93, 2
    s_lshl_b32 s68, s73, 7
    s_add_u32 s93, s93, s68
    s_add_u32 s93, s93, s75
    v_mad_u32_u24 v28, v5, s76, v4
    v_lshrrev_b32 v9, 4, v0
    v_bfe_u32 v10, v0, 2, 2
    v_lshl_add_u32 v11, v9, 3, v10
    v_lshlrev_b32 v11, 7, v11
    v_lshrrev_b32 v10, 1, v10
    v_xor_b32 v10, s56, v10
    v_lshl_add_u32 v11, v10, 5, v11
    v_and_b32 v10, 3, v0
    v_lshl_add_u32 v245, v10, 3, v11
    s_and_b32 s68, s58, 3
    s_mul_i32 s68, s68, 320
    s_add_u32 s68, s68, 158720
    v_lshlrev_b32 v9, 4, v9
    v_add_u32 v246, s68, v9
    s_cmp_lg_u32 s56, 0
    s_cbranch_scc1 L_nosilu_4
    s_waitcnt vmcnt(8)
    v_lshlrev_b32 v70, 16, v64
    v_and_b32 v71, 0xffff0000, v64
    v_lshlrev_b32 v72, 16, v65
    v_and_b32 v73, 0xffff0000, v65
    v_lshlrev_b32 v74, 16, v66
    v_and_b32 v75, 0xffff0000, v66
    v_lshlrev_b32 v76, 16, v67
    v_and_b32 v77, 0xffff0000, v67
    v_lshlrev_b32 v78, 16, v68
    v_and_b32 v79, 0xffff0000, v68
    v_mul_f32 v80, 0xbfb8aa3b, v70
    v_mul_f32 v81, 0xbfb8aa3b, v71
    v_mul_f32 v82, 0xbfb8aa3b, v72
    v_mul_f32 v83, 0xbfb8aa3b, v73
    v_mul_f32 v84, 0xbfb8aa3b, v74
    v_mul_f32 v85, 0xbfb8aa3b, v75
    v_mul_f32 v86, 0xbfb8aa3b, v76
    v_mul_f32 v87, 0xbfb8aa3b, v77
    v_mul_f32 v88, 0xbfb8aa3b, v78
    v_mul_f32 v89, 0xbfb8aa3b, v79
    v_exp_f32 v80, v80
    v_exp_f32 v81, v81
    v_exp_f32 v82, v82
    v_exp_f32 v83, v83
    v_exp_f32 v84, v84
    v_exp_f32 v85, v85
    v_exp_f32 v86, v86
    v_exp_f32 v87, v87
    v_exp_f32 v88, v88
    v_exp_f32 v89, v89
    v_add_f32 v80, 1.0, v80
    v_add_f32 v81, 1.0, v81
    v_add_f32 v82, 1.0, v82
    v_add_f32 v83, 1.0, v83
    v_add_f32 v84, 1.0, v84
    v_add_f32 v85, 1.0, v85
    v_add_f32 v86, 1.0, v86
    v_add_f32 v87, 1.0, v87
    v_add_f32 v88, 1.0, v88
    v_add_f32 v89, 1.0, v89
    v_rcp_f32 v80, v80
    v_rcp_f32 v81, v81
    v_rcp_f32 v82, v82
    v_rcp_f32 v83, v83
    v_rcp_f32 v84, v84
    v_rcp_f32 v85, v85
    v_rcp_f32 v86, v86
    v_rcp_f32 v87, v87
    v_rcp_f32 v88, v88
    v_rcp_f32 v89, v89
    v_mul_f32 v80, v70, v80
    v_mul_f32 v81, v71, v81
    v_mul_f32 v82, v72, v82
    v_mul_f32 v83, v73, v83
    v_mul_f32 v84, v74, v84
    v_mul_f32 v85, v75, v85
    v_mul_f32 v86, v76, v86
    v_mul_f32 v87, v77, v87
    v_mul_f32 v88, v78, v88
    v_mul_f32 v89, v79, v89
    v_cvt_pk_bf16_f32 v64, v80, v81
    v_cvt_pk_bf16_f32 v65, v82, v83
    v_cvt_pk_bf16_f32 v66, v84, v85
    v_cvt_pk_bf16_f32 v67, v86, v87
    v_cvt_pk_bf16_f32 v68, v88, v89
    v_add_u32 v9, 158720, v1
    v_lshlrev_b32 v10, 2, v0
    v_add_u32 v10, 159744, v10
    ds_write_b128 v9, v[64:67]
    ds_write_b32 v10, v68
    s_waitcnt lgkmcnt(0)
L_nosilu_4:
    s_waitcnt vmcnt(8)
    v_readfirstlane_b32 s30, v2
    v_readfirstlane_b32 s31, v3
    s_mul_i32 s30, s30, 1664525
    s_add_u32 s30, s30, 1013904223
    s_mul_i32 s31, s31, 22695477
    s_add_u32 s31, s31, 0x3c6ef35f
    v_mov_b32 v2, s30
    v_mov_b32 v3, s31
    s_bfe_u32 s26, s30, 524288
    s_bfe_u32 s27, s30, 524296
    s_bfe_u32 s28, s30, 524304
    s_bfe_u32 s29, s30, 524312
    s_lshl_b32 s68, s56, 12
    s_add_u32 s68, s68, 32768
    s_add_u32 m0, s68, 0
    s_nop 0
    buffer_load_dwordx4 v28, s[52:55], s93 offen nt lds
    s_add_u32 m0, s68, 1024
    s_add_u32 s93, s93, s94
    buffer_load_dwordx4 v28, s[52:55], s93 offen nt lds
    s_add_u32 m0, s68, 2048
    s_add_u32 s93, s93, s94
    buffer_load_dwordx4 v28, s[52:55], s93 offen nt lds
    s_add_u32 m0, s68, 3072
    s_add_u32 s93, s93, s94
    buffer_load_dwordx4 v28, s[52:55], s93 offen nt lds
    s_mov_b32 s40, s8
    s_mov_b32 s41, s9
    s_mov_b32 s42, 25600
    s_mov_b32 s43, 0x20000
    s_mul_i32 s68, s60, 1600
    s_lshl_b32 s69, s56, 9
    s_add_u32 s68, s68, s69
    s_add_u32 m0, s69, 160256
    s_mov_b32 exec_hi, 0
    buffer_load_dwordx4 v1, s[40:43], s68 offen lds
    s_mov_b64 exec, -1
    v_and_b32 v9, 7, v0
    v_xor_b32 v10, v9, v5
    v_lshlrev_b32 v10, 4, v10
    v_lshl_add_u32 v10, v9, 7, v10
    s_mul_i32 s68, s56, 3072
    s_add_u32 s68, s68, 20480
    v_add_u32 v11, s68, v10
    v_lshlrev_b32 v9, 4, v9
    s_lshl_b32 s68, s56, 2
    s_add_u32 s68, s68, 160000
    v_add_u32 v10, s68, v9
    v_add_u32 v9, 160000, v9
    s_cmp_lt_u32 s56, 2
    s_cselect_b32 s70, 1.0, 0
    s_waitcnt vmcnt(10)
    ds_read_b128 v[112:115], v11 offset:0
    ds_read_b128 v[116:119], v11 offset:1024
    ds_read_b128 v[120:123], v11 offset:2048
    s_waitcnt lgkmcnt(2)
    v_lshlrev_b32 v128, 16, v112
    v_and_b32 v129, 0xffff0000, v112
    v_lshlrev_b32 v130, 16, v113
    v_and_b32 v131, 0xffff0000, v113
    v_lshlrev_b32 v132, 16, v114
    v_and_b32 v133, 0xffff0000, v114
    v_lshlrev_b32 v134, 16, v115
    v_and_b32 v135, 0xffff0000, v115
    s_waitcnt lgkmcnt(1)
    v_lshlrev_b32 v136, 16, v116
    v_and_b32 v137, 0xffff0000, v116
    v_lshlrev_b32 v138, 16, v117
    v_and_b32 v139, 0xffff0000, v117
    v_lshlrev_b32 v140, 16, v118
    v_and_b32 v141, 0xffff0000, v118
    v_lshlrev_b32 v142, 16, v119
    v_and_b32 v143, 0xffff0000, v119
    s_waitcnt lgkmcnt(0)
    v_lshlrev_b32 v144, 16, v120
    v_and_b32 v145, 0xffff0000, v120
    v_lshlrev_b32 v146, 16, v121
    v_and_b32 v147, 0xffff0000, v121
    v_lshlrev_b32 v148, 16, v122
    v_and_b32 v149, 0xffff0000, v122
    v_lshlrev_b32 v150, 16, v123
    v_and_b32 v151, 0xffff0000, v123
    v_pk_add_f32 v[152:153], v[128:129], v[130:131]
    v_pk_add_f32 v[152:153], v[152:153], v[132:133]
    v_pk_add_f32 v[152:153], v[152:153], v[134:135]
    v_pk_add_f32 v[152:153], v[152:153], v[136:137]
    v_pk_add_f32 v[152:153], v[152:153], v[138:139]
    v_pk_add_f32 v[154:155], v[140:141], v[142:143]
    v_pk_add_f32 v[154:155], v[154:155], v[144:145]
    v_pk_add_f32 v[154:155], v[154:155], v[146:147]
    v_pk_add_f32 v[154:155], v[154:155], v[148:149]
    v_pk_add_f32 v[154:155], v[154:155], v[150:151]
    v_pk_add_f32 v[152:153], v[152:153], v[154:155]
    v_add_f32 v152, v152, v153
    s_nop 1
    v_add_f32_dpp v152, v152, v152 row_ror:8 row_mask:0xf bank_mask:0xf
    v_mov_b32 v11, v152
    s_nop 1
    v_permlane16_swap_b32 v152, v11
    v_add_f32 v152, v152, v11
    v_mov_b32 v11, v152
    s_nop 1
    v_permlane32_swap_b32 v152, v11
    v_add_f32 v152, v152, v11
    ds_write_b32 v10, v152 offset:0
    s_waitcnt vmcnt(5)
    s_waitcnt lgkmcnt(0)
    s_barrier
    v_add_u32 v108, 0, v245
    ds_read_b128 v[84:87], v246 offset:0
    ds_read_b64_tr_b16 v[64:65], v108 offset:0
    ds_read_b64_tr_b16 v[66:67], v108 offset:512
    ds_read_b128 v[88:91], v246 offset:64
    ds_read_b64_tr_b16 v[68:69], v108 offset:4096
    ds_read_b64_tr_b16 v[70:71], v108 offset:4608
    ds_read_b128 v[92:95], v246 offset:128
    ds_read_b64_tr_b16 v[72:73], v108 offset:8192
    ds_read_b64_tr_b16 v[74:75], v108 offset:8704
    ds_read_b128 v[96:99], v246 offset:192
    ds_read_b64_tr_b16 v[76:77], v108 offset:12288
    ds_read_b64_tr_b16 v[78:79], v108 offset:12800
    ds_read_b128 v[100:103], v246 offset:256
    ds_read_b64_tr_b16 v[80:81], v108 offset:16384
    ds_read_b64_tr_b16 v[82:83], v108 offset:16896
    s_waitcnt lgkmcnt(12)
    v_mfma_f32_16x16x32_bf16 v[104:107], v[64:67], v[84:87], 0
    s_waitcnt lgkmcnt(9)
    v_mfma_f32_16x16x32_bf16 v[104:107], v[68:71], v[88:91], v[104:107]
    s_waitcnt lgkmcnt(6)
    v_mfma_f32_16x16x32_bf16 v[104:107], v[72:75], v[92:95], v[104:107]
    s_waitcnt lgkmcnt(3)
    v_mfma_f32_16x16x32_bf16 v[104:107], v[76:79], v[96:99], v[104:107]
    s_waitcnt lgkmcnt(0)
    v_mfma_f32_16x16x32_bf16 v[104:107], v[80:83], v[100:103], v[104:107]
    s_nop 7
    v_add_u32 v104, 0x80, v104
    v_add_u32 v105, 0x80, v105
    v_add_u32 v106, 0x80, v106
    v_add_u32 v107, 0x80, v107
    v_and_b32 v104, 0xffffff00, v104
    v_and_b32 v105, 0xffffff00, v105
    v_and_b32 v106, 0xffffff00, v106
    v_and_b32 v107, 0xffffff00, v107
    v_or_b32 v104, s26, v104
    v_or_b32 v105, s27, v105
    v_or_b32 v106, s28, v106
    v_or_b32 v107, s29, v107
    s_mov_b32 exec_lo, 0x00010001
    s_mov_b32 exec_hi, 0x00010001
    buffer_store_dwordx4 v[104:107], v0, s[32:35], s84 offen sc1
    s_mov_b64 exec, -1
    ds_read_b128 v[12:15], v9 offset:0
    s_waitcnt lgkmcnt(0)
    v_add_f32 v12, v12, v13
    v_add_f32 v14, v14, v15
    v_add_f32 v152, v12, v14
    v_mul_f32 v152, 0x3acccccd, v152
    v_pk_add_f32 v[128:129], v[128:129], v[152:153] op_sel_hi:[1,0] neg_lo:[0,1] neg_hi:[0,1]
    v_pk_add_f32 v[130:131], v[130:131], v[152:153] op_sel_hi:[1,0] neg_lo:[0,1] neg_hi:[0,1]
    v_pk_add_f32 v[132:133], v[132:133], v[152:153] op_sel_hi:[1,0] neg_lo:[0,1] neg_hi:[0,1]
    v_pk_add_f32 v[134:135], v[134:135], v[152:153] op_sel_hi:[1,0] neg_lo:[0,1] neg_hi:[0,1]
    v_pk_add_f32 v[136:137], v[136:137], v[152:153] op_sel_hi:[1,0] neg_lo:[0,1] neg_hi:[0,1]
    v_pk_add_f32 v[138:139], v[138:139], v[152:153] op_sel_hi:[1,0] neg_lo:[0,1] neg_hi:[0,1]
    v_pk_add_f32 v[140:141], v[140:141], v[152:153] op_sel_hi:[1,0] neg_lo:[0,1] neg_hi:[0,1]
    v_pk_add_f32 v[142:143], v[142:143], v[152:153] op_sel_hi:[1,0] neg_lo:[0,1] neg_hi:[0,1]
    v_pk_add_f32 v[144:145], v[144:145], v[152:153] op_sel_hi:[1,0] neg_lo:[0,1] neg_hi:[0,1]
    v_pk_add_f32 v[146:147], v[146:147], v[152:153] op_sel_hi:[1,0] neg_lo:[0,1] neg_hi:[0,1]
    v_pk_add_f32 v[148:149], v[148:149], v[152:153] op_sel_hi:[1,0] neg_lo:[0,1] neg_hi:[0,1]
    v_pk_add_f32 v[150:151], v[150:151], v[152:153] op_sel_hi:[1,0] neg_lo:[0,1] neg_hi:[0,1]
    v_pk_mul_f32 v[154:155], v[128:129], v[128:129]
    v_pk_mul_f32 v[156:157], v[144:145], v[144:145]
    v_pk_fma_f32 v[154:155], v[130:131], v[130:131], v[154:155]
    v_pk_fma_f32 v[156:157], v[146:147], v[146:147], v[156:157]
    v_pk_fma_f32 v[154:155], v[132:133], v[132:133], v[154:155]
    v_pk_fma_f32 v[156:157], v[148:149], v[148:149], v[156:157]
    v_pk_fma_f32 v[154:155], v[134:135], v[134:135], v[154:155]
    v_pk_fma_f32 v[156:157], v[150:151], v[150:151], v[156:157]
    v_pk_fma_f32 v[154:155], v[136:137], v[136:137], v[154:155]
    v_pk_fma_f32 v[154:155], v[138:139], v[138:139], v[154:155]
    v_pk_fma_f32 v[154:155], v[140:141], v[140:141], v[154:155]
    v_pk_fma_f32 v[154:155], v[142:143], v[142:143], v[154:155]
    v_add_f32 v154, v154, v155
    v_add_f32 v156, v156, v157
    v_fma_f32 v154, v156, s70, v154
    s_nop 1
    v_add_f32_dpp v154, v154, v154 row_ror:8 row_mask:0xf bank_mask:0xf
    v_mov_b32 v11, v154
    s_nop 1
    v_permlane16_swap_b32 v154, v11
    v_add_f32 v154, v154, v11
    v_mov_b32 v11, v154
    s_nop 1
    v_permlane32_swap_b32 v154, v11
    v_add_f32 v154, v154, v11
    ds_write_b32 v10, v154 offset:128
    s_waitcnt lgkmcnt(0)
    s_barrier
    ds_read_b128 v[12:15], v9 offset:128
    s_waitcnt lgkmcnt(0)
    v_add_f32 v12, v12, v13
    v_add_f32 v14, v14, v15
    v_add_f32 v154, v12, v14
    v_mul_f32 v154, 0x3acccccd, v154
    v_add_f32 v154, 0x3727c5ac, v154
    v_rsq_f32 v154, v154
    s_nop 0
    v_pk_mul_f32 v[128:129], v[128:129], v[154:155] op_sel_hi:[1,0]
    v_pk_mul_f32 v[130:131], v[130:131], v[154:155] op_sel_hi:[1,0]
    v_pk_mul_f32 v[132:133], v[132:133], v[154:155] op_sel_hi:[1,0]
    v_pk_mul_f32 v[134:135], v[134:135], v[154:155] op_sel_hi:[1,0]
    v_pk_mul_f32 v[136:137], v[136:137], v[154:155] op_sel_hi:[1,0]
    v_pk_mul_f32 v[138:139], v[138:139], v[154:155] op_sel_hi:[1,0]
    v_pk_mul_f32 v[140:141], v[140:141], v[154:155] op_sel_hi:[1,0]
    v_pk_mul_f32 v[142:143], v[142:143], v[154:155] op_sel_hi:[1,0]
    v_pk_mul_f32 v[144:145], v[144:145], v[154:155] op_sel_hi:[1,0]
    v_pk_mul_f32 v[146:147], v[146:147], v[154:155] op_sel_hi:[1,0]
    v_pk_mul_f32 v[148:149], v[148:149], v[154:155] op_sel_hi:[1,0]
    v_pk_mul_f32 v[150:151], v[150:151], v[154:155] op_sel_hi:[1,0]
    s_waitcnt vmcnt(2)
    ds_read_b64_tr_b16 v[44:45], v6 offset:0
    ds_read_b64_tr_b16 v[46:47], v6 offset:512
    ds_read_b64_tr_b16 v[48:49], v6 offset:8
    ds_read_b64_tr_b16 v[50:51], v6 offset:520
    ds_read_b64_tr_b16 v[52:53], v7 offset:0
    ds_read_b64_tr_b16 v[54:55], v7 offset:512
    ds_read_b64_tr_b16 v[56:57], v7 offset:8
    ds_read_b64_tr_b16 v[58:59], v7 offset:520
    v_add_u32_dpp v60, v29, v8 quad_perm:[0,0,0,0] row_mask:0xf bank_mask:0xf
    v_add_u32_dpp v61, v29, v8 quad_perm:[1,1,1,1] row_mask:0xf bank_mask:0xf
    v_add_u32_dpp v62, v29, v8 quad_perm:[2,2,2,2] row_mask:0xf bank_mask:0xf
    v_add_u32_dpp v63, v29, v8 quad_perm:[3,3,3,3] row_mask:0xf bank_mask:0xf
    s_waitcnt lgkmcnt(6)
    buffer_store_dwordx4 v[44:47], v60, s[32:35], 0 offen sc1
    s_waitcnt lgkmcnt(4)
    buffer_store_dwordx4 v[48:51], v61, s[32:35], 0 offen sc1
    s_waitcnt lgkmcnt(2)
    buffer_store_dwordx4 v[52:55], v62, s[32:35], 0 offen sc1
    s_waitcnt lgkmcnt(0)
    buffer_store_dwordx4 v[56:59], v63, s[32:35], 0 offen sc1
    s_mul_i32 s82, s56, 5120
    s_add_u32 s82, s82, 851968
    s_add_u32 s83, s82, 4096
    v_and_b32 v41, 0xf0, v1
    v_lshrrev_b32 v40, 4, v0
    v_lshl_add_u32 v40, v40, 10, v41
    s_mul_i32 s86, s2, 1
    s_lshl_b32 s86, s86, 3
    s_add_u32 s86, s86, 4096
    s_cmp_eq_u32 s56, 0
    s_cselect_b32 s86, s86, s3
    s_lshr_b32 s68, s58, 2
    s_lshl_b32 s68, s68, 3
    s_add_u32 s68, s68, s57
    s_and_b32 s69, s58, 3
    s_mul_i32 s85, s69, 160
    s_mul_i32 s84, s56, 40
    s_add_u32 s85, s85, s84
    s_mul_i32 s85, s85, 7680
    s_lshl_b32 s84, s68, 7
    s_add_u32 s85, s85, s84
    s_lshl_b32 s84, s68, 2
    s_add_u32 s84, s84, s69
    s_lshl_b32 s84, s84, 2
    s_add_u32 s84, s84, s56
    s_lshl_b32 s84, s84, 6
    s_add_u32 s84, s84, 851968
    s_sub_u32 s68, s68, 20
    s_cmp_lt_u32 s68, 40
    s_cselect_b32 s85, s85, s3
    s_cselect_b32 s84, s84, s3
    s_mul_i32 s69, s56, 1280
    s_add_u32 s69, s69, 20480
    v_add_u32 v42, s69, v1
    v_add_u32 v43, s69, v41
    s_lshl_b32 s70, s56, 8
    s_add_u32 s70, s70, 20480
    v_lshlrev_b32 v158, 5, v5
    v_add_u32 v158, s70, v158
    v_and_b32 v159, 7, v0
    v_lshlrev_b32 v159, 4, v159
    v_lshl_add_u32 v159, v5, 8, v159
    s_lshr_b32 s88, s0, 1
    s_mul_i32 s88, s88, 20480
    s_and_b32 s68, s0, 1
    s_lshl_b32 s68, s68, 7
    s_add_u32 s88, s88, s68
    s_lshl_b32 s68, s56, 11
    s_add_u32 s88, s88, s68
    s_add_u32 s88, s88, 4718592
    s_add_u32 s89, s88, 8192
    s_add_u32 s90, s88, 16384
    s_cmp_lt_u32 s56, 2
    s_cselect_b32 s90, s90, s3
    s_cselect_b32 s94, 0, 1.0
    s_mov_b32 s95, s94
    s_mul_i32 s91, s0, 1
    s_lshl_b32 s91, s91, 7
    s_add_u32 s91, s91, 65536
    s_cmp_eq_u32 s56, 0
    s_cselect_b32 s91, s91, s21
    v_min_u32 v9, 49, v0
    v_lshlrev_b32 v39, 5, v9
    s_mov_b32 s92, 4096
    s_lshl_b32 s72, s2, 2
    s_add_u32 s72, s72, s56
    s_cmp_ge_u32 s72, 540
    s_cselect_b32 s76, 1, 0
    s_cselect_b32 s40, s16, s14
    s_cselect_b32 s41, s17, s15
    s_cselect_b32 s77, 540, 0
    s_sub_u32 s72, s72, s77
    s_mov_b32 s42, 2211840
    s_mov_b32 s43, 0x20000
    s_mul_i32 s74, s72, 607
    s_lshr_b32 s74, s74, 14
    s_mul_i32 s73, s74, 27
    s_sub_u32 s73, s72, s73
    s_lshl_b32 s68, s73, 4
    v_and_b32 v9, 15, v0
    v_add_u32 v9, s68, v9
    v_lshrrev_b32 v10, 1, v9
    v_and_b32 v9, 1, v9
    v_mul_u32_u24 v11, 19, v10
    v_lshrrev_b32 v11, 9, v11
    v_mul_u32_u24 v12, 27, v11
    v_sub_u32 v12, v10, v12
    v_cmp_le_u32 vcc, 14, v12
    v_lshlrev_b32 v11, 1, v11
    v_subrev_u32 v13, 14, v12
    v_cndmask_b32 v12, v12, v13, vcc
    v_addc_co_u32 v11, vcc, 0, v11, vcc
    v_lshrrev_b32 v13, 2, v12
    v_lshl_add_u32 v13, v13, 1, v9
    v_and_b32 v14, 3, v12
    v_lshl_add_u32 v10, v14, 1, v9
    v_cmp_gt_u32 vcc, 12, v12
    s_nop 1
    v_cndmask_b32 v13, 6, v13, vcc
    v_cndmask_b32 v14, v10, v14, vcc
    s_lshl_b32 s68, s74, 13
    s_mul_i32 s69, s74, 6144
    s_add_u32 s69, s69, 155648
    v_mov_b32 v9, s68
    v_mov_b32 v10, s69
    v_cmp_gt_u32 vcc, 4, v13
    s_nop 1
    v_cndmask_b32 v9, v10, v9, vcc
    v_lshl_add_u32 v13, v13, 11, v9
    v_lshl_add_u32 v13, v14, 8, v13
    v_and_b32 v14, 2, v14
    v_lshrrev_b32 v15, 4, v0
    v_xor_b32 v14, v14, v15
    v_lshl_add_u32 v13, v14, 6, v13
    s_mov_b32 s68, 286720
    v_mad_u32_u24 v13, v11, s68, v13
    s_lshl_b32 s68, s76, 10
    s_add_u32 s68, s68, 13631488
    v_add_u32 v31, s68, v13
    s_mov_b32 s68, 3456
    v_mad_u32_u24 v30, v5, s68, v4
    s_mul_i32 s78, s74, 110592
    s_lshl_b32 s73, s73, 7
    s_add_u32 s78, s78, s73
    s_add_u32 s79, s78, 27648
    s_add_u32 s80, s78, 55296
    s_add_u32 s81, s78, 82944
    s_mov_b32 s4, s78
    s_mov_b32 s5, s79
    s_mov_b32 s6, s80
    s_mov_b32 s7, s81
    s_waitcnt vmcnt(0)
    s_barrier
    s_mov_b64 exec, 1
    buffer_store_dwordx2 v[2:3], off, s[32:35], s86 sc1
    s_mov_b64 exec, -1
    buffer_load_dwordx4 v[64:67], v40, s[32:35], s82 offen offset:0 sc1
    buffer_load_dwordx4 v[68:71], v40, s[32:35], s82 offen offset:256 sc1
    buffer_load_dwordx4 v[72:75], v40, s[32:35], s82 offen offset:512 sc1
    buffer_load_dwordx4 v[76:79], v40, s[32:35], s82 offen offset:768 sc1
    buffer_load_dwordx4 v[80:83], v41, s[32:35], s83 offen offset:0 sc1
    buffer_load_dwordx4 v[84:87], v41, s[32:35], s83 offen offset:256 sc1
    buffer_load_dwordx4 v[88:91], v41, s[32:35], s83 offen offset:512 sc1
    buffer_load_dwordx4 v[92:95], v41, s[32:35], s83 offen offset:768 sc1
    s_add_u32 m0, s87, 0
    s_nop 0
    buffer_load_dwordx4 v30, s[40:43], s4 offen nt lds
    s_add_u32 m0, s87, 1024
    s_nop 0
    buffer_load_dwordx4 v30, s[40:43], s5 offen nt lds
    s_add_u32 m0, s87, 2048
    s_nop 0
    buffer_load_dwordx4 v30, s[40:43], s6 offen nt lds
    s_add_u32 m0, s87, 3072
    s_nop 0
    buffer_load_dwordx4 v30, s[40:43], s7 offen nt lds
    s_lshl_b32 s72, s2, 2
    s_add_u32 s72, s72, s56
    s_add_u32 s72, s72, 1024
    s_cmp_ge_u32 s72, 1080
    s_cbranch_scc1 L_jw2_7
    s_cmp_ge_u32 s72, 540
    s_cselect_b32 s76, 1, 0
    s_cselect_b32 s44, s16, s14
    s_cselect_b32 s45, s17, s15
    s_cselect_b32 s77, 540, 0
    s_sub_u32 s72, s72, s77
    s_mov_b32 s46, 2211840
    s_mov_b32 s47, 0x20000
    s_mul_i32 s74, s72, 607
    s_lshr_b32 s74, s74, 14
    s_mul_i32 s73, s74, 27
    s_sub_u32 s73, s72, s73
    s_lshl_b32 s68, s73, 4
    v_and_b32 v9, 15, v0
    v_add_u32 v9, s68, v9
    v_lshrrev_b32 v10, 1, v9
    v_and_b32 v9, 1, v9
    v_mul_u32_u24 v11, 19, v10
    v_lshrrev_b32 v11, 9, v11
    v_mul_u32_u24 v12, 27, v11
    v_sub_u32 v12, v10, v12
    v_cmp_le_u32 vcc, 14, v12
    v_lshlrev_b32 v11, 1, v11
    v_subrev_u32 v13, 14, v12
    v_cndmask_b32 v12, v12, v13, vcc
    v_addc_co_u32 v11, vcc, 0, v11, vcc
    v_lshrrev_b32 v13, 2, v12
    v_lshl_add_u32 v13, v13, 1, v9
    v_and_b32 v14, 3, v12
    v_lshl_add_u32 v10, v14, 1, v9
    v_cmp_gt_u32 vcc, 12, v12
    s_nop 1
    v_cndmask_b32 v13, 6, v13, vcc
    v_cndmask_b32 v14, v10, v14, vcc
    s_lshl_b32 s68, s74, 13
    s_mul_i32 s69, s74, 6144
    s_add_u32 s69, s69, 155648
    v_mov_b32 v9, s68
    v_mov_b32 v10, s69
    v_cmp_gt_u32 vcc, 4, v13
    s_nop 1
    v_cndmask_b32 v9, v10, v9, vcc
    v_lshl_add_u32 v13, v13, 11, v9
    v_lshl_add_u32 v13, v14, 8, v13
    v_and_b32 v14, 2, v14
    v_lshrrev_b32 v15, 4, v0
    v_xor_b32 v14, v14, v15
    v_lshl_add_u32 v13, v14, 6, v13
    s_mov_b32 s68, 286720
    v_mad_u32_u24 v13, v11, s68, v13
    s_lshl_b32 s68, s76, 10
    s_add_u32 s68, s68, 13631488
    v_add_u32 v33, s68, v13
    s_mov_b32 s68, 3456
    v_mad_u32_u24 v32, v5, s68, v4
    s_mul_i32 s78, s74, 110592
    s_lshl_b32 s73, s73, 7
    s_add_u32 s78, s78, s73
    s_add_u32 s79, s78, 27648
    s_add_u32 s80, s78, 55296
    s_add_u32 s81, s78, 82944
    s_branch L_jdone_8
L_jw2_7:
    s_mov_b32 s44, s18
    s_mov_b32 s45, s19
    s_mov_b32 s46, 2211840
    s_mov_b32 s47, 0x20000
    s_sub_u32 s72, s72, 1080
    s_mov_b32 s77, 18350080
    s_cmp_lt_u32 s72, 560
    s_cselect_b32 s77, s77, s3
    s_cselect_b32 s76, 0, s3
    s_cselect_b32 s72, s72, 0
    s_mul_i32 s74, s72, 205
    s_lshr_b32 s74, s74, 11
    s_mul_i32 s73, s74, 10
    s_sub_u32 s73, s72, s73
    s_mov_b32 s69, s74
    s_mul_i32 s69, s69, 5120
    s_add_u32 s69, s69, s77
    s_lshl_b32 s68, s73, 4
    v_and_b32 v9, 15, v0
    v_add_u32 v9, s68, v9
    v_mul_u32_u24 v10, 103, v9
    v_lshrrev_b32 v10, 11, v10
    v_mul_u32_u24 v11, 20, v10
    v_sub_u32 v11, v9, v11
    v_lshrrev_b32 v12, 3, v11
    v_lshlrev_b32 v12, 1, v12
    v_and_b32 v13, 1, v11
    v_add_u32 v13, v12, v13
    v_bfe_u32 v14, v11, 1, 2
    v_and_b32 v15, 3, v11
    v_cmp_gt_u32 vcc, 16, v11
    s_nop 1
    v_cndmask_b32 v13, 4, v13, vcc
    v_cndmask_b32 v14, v15, v14, vcc
    v_lshlrev_b32 v13, 10, v13
    v_lshl_add_u32 v13, v14, 8, v13
    v_and_b32 v14, 2, v14
    v_lshrrev_b32 v15, 4, v0
    v_xor_b32 v14, v14, v15
    v_lshl_add_u32 v13, v14, 6, v13
    s_mov_b32 s68, 286720
    v_mad_u32_u24 v13, v10, s68, v13
    v_add_u32 v33, s69, v13
    s_mov_b32 s68, 1280
    v_mad_u32_u24 v32, v5, s68, v4
    s_lshl_b32 s73, s73, 7
    s_add_u32 s73, s73, s76
    s_mul_i32 s75, s74, 37
    s_lshr_b32 s75, s75, 9
    s_mul_i32 s68, s75, 14
    s_sub_u32 s74, s74, s68
    s_lshl_b32 s74, s74, 2
    s_mul_i32 s75, s75, 54
    s_lshr_b32 s68, s74, 4
    s_mul_i32 s68, s68, 27
    s_bfe_u32 s69, s74, 0x10003
    s_mul_i32 s69, s69, 14
    s_add_u32 s68, s68, s69
    s_and_b32 s69, s74, 7
    s_add_u32 s72, s68, s69
    s_add_u32 s68, s74, -32
    s_add_u32 s69, s68, 8
    s_cmp_ge_i32 s68, 6
    s_cselect_b32 s70, 8, 0
    s_add_u32 s69, s69, s70
    s_cmp_ge_i32 s68, 11
    s_cselect_b32 s70, 8, 0
    s_add_u32 s69, s69, s70
    s_cmp_ge_i32 s68, 17
    s_cselect_b32 s70, 8, 0
    s_add_u32 s69, s69, s70
    s_add_u32 s70, s72, 0
    s_cmp_lt_i32 s68, 0
    s_cselect_b32 s69, s70, s69
    s_add_u32 s69, s69, s75
    s_mul_i32 s69, s69, 10240
    s_add_u32 s69, s69, s73
    s_cmp_ge_i32 s68, 22
    s_cselect_b32 s78, s3, s69
    s_add_u32 s68, s74, -31
    s_add_u32 s69, s68, 8
    s_cmp_ge_i32 s68, 6
    s_cselect_b32 s70, 8, 0
    s_add_u32 s69, s69, s70
    s_cmp_ge_i32 s68, 11
    s_cselect_b32 s70, 8, 0
    s_add_u32 s69, s69, s70
    s_cmp_ge_i32 s68, 17
    s_cselect_b32 s70, 8, 0
    s_add_u32 s69, s69, s70
    s_add_u32 s70, s72, 1
    s_cmp_lt_i32 s68, 0
    s_cselect_b32 s69, s70, s69
    s_add_u32 s69, s69, s75
    s_mul_i32 s69, s69, 10240
    s_add_u32 s69, s69, s73
    s_cmp_ge_i32 s68, 22
    s_cselect_b32 s79, s3, s69
    s_add_u32 s68, s74, -30
    s_add_u32 s69, s68, 8
    s_cmp_ge_i32 s68, 6
    s_cselect_b32 s70, 8, 0
    s_add_u32 s69, s69, s70
    s_cmp_ge_i32 s68, 11
    s_cselect_b32 s70, 8, 0
    s_add_u32 s69, s69, s70
    s_cmp_ge_i32 s68, 17
    s_cselect_b32 s70, 8, 0
    s_add_u32 s69, s69, s70
    s_add_u32 s70, s72, 2
    s_cmp_lt_i32 s68, 0
    s_cselect_b32 s69, s70, s69
    s_add_u32 s69, s69, s75
    s_mul_i32 s69, s69, 10240
    s_add_u32 s69, s69, s73
    s_cmp_ge_i32 s68, 22
    s_cselect_b32 s80, s3, s69
    s_add_u32 s68, s74, -29
    s_add_u32 s69, s68, 8
    s_cmp_ge_i32 s68, 6
    s_cselect_b32 s70, 8, 0
    s_add_u32 s69, s69, s70
    s_cmp_ge_i32 s68, 11
    s_cselect_b32 s70, 8, 0
    s_add_u32 s69, s69, s70
    s_cmp_ge_i32 s68, 17
    s_cselect_b32 s70, 8, 0
    s_add_u32 s69, s69, s70
    s_add_u32 s70, s72, 3
    s_cmp_lt_i32 s68, 0
    s_cselect_b32 s69, s70, s69
    s_add_u32 s69, s69, s75
    s_mul_i32 s69, s69, 10240
    s_add_u32 s69, s69, s73
    s_cmp_ge_i32 s68, 22
    s_cselect_b32 s81, s3, s69
L_jdone_8:
    s_mov_b32 s8, s78
    s_mov_b32 s9, s79
    s_mov_b32 s10, s80
    s_mov_b32 s11, s81
    s_waitcnt vmcnt(4)
    v_xor_b32 v64, s26, v64
    v_xor_b32 v65, s27, v65
    v_xor_b32 v66, s28, v66
    v_xor_b32 v67, s29, v67
    v_or3_b32 v9, v64, v65, v64
    v_or3_b32 v9, v66, v67, v9
    v_xor_b32 v68, s26, v68
    v_xor_b32 v69, s27, v69
    v_xor_b32 v70, s28, v70
    v_xor_b32 v71, s29, v71
    v_or3_b32 v9, v68, v69, v9
    v_or3_b32 v9, v70, v71, v9
    v_xor_b32 v72, s26, v72
    v_xor_b32 v73, s27, v73
    v_xor_b32 v74, s28, v74
    v_xor_b32 v75, s29, v75
    v_or3_b32 v9, v72, v73, v9
    v_or3_b32 v9, v74, v75, v9
    v_xor_b32 v76, s26, v76
    v_xor_b32 v77, s27, v77
    v_xor_b32 v78, s28, v78
    v_xor_b32 v79, s29, v79
    v_or3_b32 v9, v76, v77, v9
    v_or3_b32 v9, v78, v79, v9
    v_xor_b32 v80, s26, v80
    v_xor_b32 v81, s27, v81
    v_xor_b32 v82, s28, v82
    v_xor_b32 v83, s29, v83
    v_or3_b32 v9, v80, v81, v9
    v_or3_b32 v9, v82, v83, v9
    v_xor_b32 v84, s26, v84
    v_xor_b32 v85, s27, v85
    v_xor_b32 v86, s28, v86
    v_xor_b32 v87, s29, v87
    v_or3_b32 v9, v84, v85, v9
    v_or3_b32 v9, v86, v87, v9
    v_xor_b32 v88, s26, v88
    v_xor_b32 v89, s27, v89
    v_xor_b32 v90, s28, v90
    v_xor_b32 v91, s29, v91
    v_or3_b32 v9, v88, v89, v9
    v_or3_b32 v9, v90, v91, v9
    v_xor_b32 v92, s26, v92
    v_xor_b32 v93, s27, v93
    v_xor_b32 v94, s28, v94
    v_xor_b32 v95, s29, v95
    v_or3_b32 v9, v92, v93, v9
    v_or3_b32 v9, v94, v95, v9
    v_and_b32 v9, 0xff, v9
    v_cmp_ne_u32 vcc, 0, v9
    s_cbranch_vccz L_polled_10
    s_mov_b32 s65, 200000
L_poll_9:
    buffer_load_dwordx4 v[64:67], v40, s[32:35], s82 offen offset:0 sc1
    buffer_load_dwordx4 v[68:71], v40, s[32:35], s82 offen offset:256 sc1
    buffer_load_dwordx4 v[72:75], v40, s[32:35], s82 offen offset:512 sc1
    buffer_load_dwordx4 v[76:79], v40, s[32:35], s82 offen offset:768 sc1
    buffer_load_dwordx4 v[80:83], v41, s[32:35], s83 offen offset:0 sc1
    buffer_load_dwordx4 v[84:87], v41, s[32:35], s83 offen offset:256 sc1
    buffer_load_dwordx4 v[88:91], v41, s[32:35], s83 offen offset:512 sc1
    buffer_load_dwordx4 v[92:95], v41, s[32:35], s83 offen offset:768 sc1
    s_waitcnt vmcnt(0)
    v_xor_b32 v64, s26, v64
    v_xor_b32 v65, s27, v65
    v_xor_b32 v66, s28, v66
    v_xor_b32 v67, s29, v67
    v_or3_b32 v9, v64, v65, v64
    v_or3_b32 v9, v66, v67, v9
    v_xor_b32 v68, s26, v68
    v_xor_b32 v69, s27, v69
    v_xor_b32 v70, s28, v70
    v_xor_b32 v71, s29, v71
    v_or3_b32 v9, v68, v69, v9
    v_or3_b32 v9, v70, v71, v9
    v_xor_b32 v72, s26, v72
    v_xor_b32 v73, s27, v73
    v_xor_b32 v74, s28, v74
    v_xor_b32 v75, s29, v75
    v_or3_b32 v9, v72, v73, v9
    v_or3_b32 v9, v74, v75, v9
    v_xor_b32 v76, s26, v76
    v_xor_b32 v77, s27, v77
    v_xor_b32 v78, s28, v78
    v_xor_b32 v79, s29, v79
    v_or3_b32 v9, v76, v77, v9
    v_or3_b32 v9, v78, v79, v9
    v_xor_b32 v80, s26, v80
    v_xor_b32 v81, s27, v81
    v_xor_b32 v82, s28, v82
    v_xor_b32 v83, s29, v83
    v_or3_b32 v9, v80, v81, v9
    v_or3_b32 v9, v82, v83, v9
    v_xor_b32 v84, s26, v84
    v_xor_b32 v85, s27, v85
    v_xor_b32 v86, s28, v86
    v_xor_b32 v87, s29, v87
    v_or3_b32 v9, v84, v85, v9
    v_or3_b32 v9, v86, v87, v9
    v_xor_b32 v88, s26, v88
    v_xor_b32 v89, s27, v89
    v_xor_b32 v90, s28, v90
    v_xor_b32 v91, s29, v91
    v_or3_b32 v9, v88, v89, v9
    v_or3_b32 v9, v90, v91, v9
    v_xor_b32 v92, s26, v92
    v_xor_b32 v93, s27, v93
    v_xor_b32 v94, s28, v94
    v_xor_b32 v95, s29, v95
    v_or3_b32 v9, v92, v93, v9
    v_or3_b32 v9, v94, v95, v9
    v_and_b32 v9, 0xff, v9
    v_cmp_ne_u32 vcc, 0, v9
    s_cbranch_vccz L_polled_10
    s_sub_u32 s65, s65, 1
    s_cmp_lg_u32 s65, 0
    s_cbranch_scc1 L_poll_9
L_polled_10:
    v_pk_add_f32 v[64:65], v[64:65], v[68:69]
    v_pk_add_f32 v[72:73], v[72:73], v[76:77]
    v_pk_add_f32 v[66:67], v[66:67], v[70:71]
    v_pk_add_f32 v[74:75], v[74:75], v[78:79]
    v_pk_add_f32 v[64:65], v[64:65], v[72:73]
    v_pk_add_f32 v[66:67], v[66:67], v[74:75]
    v_cvt_pk_bf16_f32 v68, v64, v65
    v_lshlrev_b32 v64, 16, v68
    v_and_b32 v65, 0xffff0000, v68
    v_cvt_pk_bf16_f32 v69, v66, v67
    v_lshlrev_b32 v66, 16, v69
    v_and_b32 v67, 0xffff0000, v69
    v_pk_add_f32 v[64:65], v[64:65], s[94:95]
    v_pk_add_f32 v[66:67], v[66:67], s[94:95]
    v_cvt_pk_bf16_f32 v68, v64, v65
    v_lshlrev_b32 v64, 16, v68
    v_and_b32 v65, 0xffff0000, v68
    v_cvt_pk_bf16_f32 v69, v66, v67
    v_lshlrev_b32 v66, 16, v69
    v_and_b32 v67, 0xffff0000, v69
    ds_write_b128 v42, v[64:67]
    v_pk_add_f32 v[80:81], v[80:81], v[84:85]
    v_pk_add_f32 v[88:89], v[88:89], v[92:93]
    v_pk_add_f32 v[82:83], v[82:83], v[86:87]
    v_pk_add_f32 v[90:91], v[90:91], v[94:95]
    v_pk_add_f32 v[80:81], v[80:81], v[88:89]
    v_pk_add_f32 v[82:83], v[82:83], v[90:91]
    v_cvt_pk_bf16_f32 v84, v80, v81
    v_lshlrev_b32 v80, 16, v84
    v_and_b32 v81, 0xffff0000, v84
    v_cvt_pk_bf16_f32 v85, v82, v83
    v_lshlrev_b32 v82, 16, v85
    v_and_b32 v83, 0xffff0000, v85
    v_pk_add_f32 v[80:81], v[80:81], s[94:95]
    v_pk_add_f32 v[82:83], v[82:83], s[94:95]
    v_cvt_pk_bf16_f32 v84, v80, v81
    v_lshlrev_b32 v80, 16, v84
    v_and_b32 v81, 0xffff0000, v84
    v_cvt_pk_bf16_f32 v85, v82, v83
    v_lshlrev_b32 v82, 16, v85
    v_and_b32 v83, 0xffff0000, v85
    ds_write_b128 v43, v[80:83] offset:1024
    s_waitcnt lgkmcnt(0)
    s_barrier
    ds_read_b128 v[64:67], v158 offset:2560
    ds_read_b128 v[68:71], v158 offset:2576
    ds_read_b128 v[72:75], v158 offset:0
    ds_read_b128 v[76:79], v158 offset:16
    ds_read_b128 v[80:83], v158 offset:3584
    ds_read_b128 v[84:87], v158 offset:3600
    ds_read_b128 v[88:91], v158 offset:1024
    ds_read_b128 v[92:95], v158 offset:1040
    ds_read_b128 v[96:99], v158 offset:4608
    ds_read_b128 v[100:103], v158 offset:4624
    ds_read_b128 v[104:107], v158 offset:2048
    ds_read_b128 v[108:111], v158 offset:2064
    s_waitcnt lgkmcnt(8)
    v_pk_fma_f32 v[128:129], v[128:129], v[64:65], v[72:73]
    v_pk_fma_f32 v[130:131], v[130:131], v[66:67], v[74:75]
    v_pk_fma_f32 v[132:133], v[132:133], v[68:69], v[76:77]
    v_pk_fma_f32 v[134:135], v[134:135], v[70:71], v[78:79]
    v_cvt_pk_bf16_f32 v112, v128, v129
    v_cvt_pk_bf16_f32 v113, v130, v131
    v_cvt_pk_bf16_f32 v114, v132, v133
    v_cvt_pk_bf16_f32 v115, v134, v135
    buffer_store_dwordx4 v[112:115], v159, s[32:35], s88 offen sc1
    s_waitcnt lgkmcnt(4)
    v_pk_fma_f32 v[136:137], v[136:137], v[80:81], v[88:89]
    v_pk_fma_f32 v[138:139], v[138:139], v[82:83], v[90:91]
    v_pk_fma_f32 v[140:141], v[140:141], v[84:85], v[92:93]
    v_pk_fma_f32 v[142:143], v[142:143], v[86:87], v[94:95]
    v_cvt_pk_bf16_f32 v116, v136, v137
    v_cvt_pk_bf16_f32 v117, v138, v139
    v_cvt_pk_bf16_f32 v118, v140, v141
    v_cvt_pk_bf16_f32 v119, v142, v143
    buffer_store_dwordx4 v[116:119], v159, s[32:35], s89 offen sc1
    s_waitcnt lgkmcnt(0)
    v_pk_fma_f32 v[144:145], v[144:145], v[96:97], v[104:105]
    v_pk_fma_f32 v[146:147], v[146:147], v[98:99], v[106:107]
    v_pk_fma_f32 v[148:149], v[148:149], v[100:101], v[108:109]
    v_pk_fma_f32 v[150:151], v[150:151], v[102:103], v[110:111]
    v_cvt_pk_bf16_f32 v120, v144, v145
    v_cvt_pk_bf16_f32 v121, v146, v147
    v_cvt_pk_bf16_f32 v122, v148, v149
    v_cvt_pk_bf16_f32 v123, v150, v151
    buffer_store_dwordx4 v[120:123], v159, s[32:35], s90 offen sc1
    buffer_load_dwordx4 v[44:47], v39, s[32:35], s92 offen sc1
    buffer_load_dwordx4 v[40:43], v39, s[32:35], s92 offen offset:16 sc1
    v_bfe_u32 v9, v0, 2, 2
    v_lshlrev_b32 v16, 8, v9
    v_and_b32 v9, 2, v9
    v_lshrrev_b32 v10, 4, v0
    v_xor_b32 v9, v9, v10
    v_lshl_add_u32 v16, v9, 6, v16
    v_add_u32 v16, v16, v8
    v_add_u32 v17, 0x10000, v16
    v_bfe_u32 v9, v0, 2, 2
    v_lshrrev_b32 v10, 1, v9
    v_sub_u32 v9, v9, v10
    v_lshlrev_b32 v9, 8, v9
    v_sub_u32 v18, v16, v9
    s_mul_i32 s68, s56, 10752
    s_add_u32 s68, s68, 51200
    v_and_b32 v9, 31, v0
    v_mul_u32_u24 v9, 336, v9
    v_add_u32 v9, s68, v9
    v_lshrrev_b32 v11, 5, v0
    v_mul_u32_u24 v10, 48, v11
    v_add_u32 v20, v10, v9
    v_mul_u32_u24 v11, 80, v11
    v_add_u32 v19, v11, v9
    v_lshrrev_b32 v11, 5, v0
    v_bfe_u32 v12, v0, 2, 2
    v_lshl_add_u32 v11, v11, 3, v12
    v_mul_u32_u24 v11, 336, v11
    v_bfe_u32 v12, v0, 4, 1
    v_and_b32 v13, 3, v0
    v_lshl_add_u32 v14, v12, 2, v13
    v_and_b32 v15, 1, v0
    v_lshlrev_b32 v15, 1, v15
    v_lshl_add_u32 v15, v12, 2, v15
    v_bfe_u32 v13, v0, 1, 1
    v_add_u32 v15, v15, v13
    s_lshr_b32 s68, s56, 1
    s_and_b32 s69, s56, 1
    s_mul_i32 s70, s68, 80
    s_lshl_b32 s71, s69, 6
    s_add_u32 s70, s70, s71
    s_add_u32 s70, s70, 51200
    s_mul_i32 s71, s68, 48
    s_add_u32 s71, s71, 51360
    v_lshl_add_u32 v12, v15, 3, v11
    v_add_u32 v21, s70, v12
    v_lshl_add_u32 v13, v14, 3, v11
    v_add_u32 v22, s71, v13
    v_lshrrev_b32 v9, 5, v0
    v_and_b32 v10, 31, v0
    s_mul_i32 s68, s68, 5
    s_lshl_b32 s70, s69, 2
    s_add_u32 s68, s68, s70
    v_add_u32 v11, s68, v9
    v_mul_u32_u24 v11, 21, v11
    v_add_u32 v11, v11, v10
    v_lshlrev_b32 v11, 4, v11
    s_cmp_eq_u32 s69, 0
    s_cselect_b32 s70, 64, 32
    s_cselect_b32 s71, 672, s3
    v_mov_b32 v9, s3
    v_cmp_gt_u32 vcc, 21, v10
    s_nop 1
    v_cndmask_b32 v11, v9, v11, vcc
    v_cmp_gt_u32 vcc, s70, v0
    s_nop 1
    v_cndmask_b32 v23, v9, v11, vcc
    s_lshl_b32 s68, s60, 4
    s_add_u32 s68, s68, s59
    s_mul_i32 s88, s68, 3456
    s_add_u32 s88, s88, 1179648
    s_add_u32 s89, s88, s71
    s_mul_i32 s90, s60, 16
    s_add_u32 s90, s90, s59
    s_lshl_b32 s90, s90, 7
    s_add_u32 s90, s90, 196608
    s_cmp_eq_u32 s56, 0
    s_cselect_b32 s90, s90, s3
    s_lshl_b32 s68, s56, 6
    v_add_u32 v9, s68, v0
    v_lshlrev_b32 v10, 4, v9
    v_mov_b32 v11, s3
    v_cmp_gt_u32 vcc, 0xd2, v9
    s_nop 1
    v_cndmask_b32 v24, v11, v10, vcc
    v_mul_u32_u24 v11, 0x187, v9
    v_lshrrev_b32 v11, 13, v11
    v_mul_u32_u24 v12, 21, v11
    v_sub_u32 v12, v9, v12
    v_mul_u32_u24 v12, 80, v12
    v_lshl_add_u32 v12, v11, 4, v12
    v_add_u32 v13, 1840, v12
    v_cmp_gt_u32 s[70:71], 5, v11
    s_nop 1
    v_cndmask_b32 v12, v13, v12, s[70:71]
    v_mov_b32 v13, 3920
    v_cndmask_b32 v12, v13, v12, vcc
    v_add_u32 v25, 153600, v12
    v_bfe_u32 v9, v0, 2, 1
    v_bfe_u32 v10, v0, 3, 2
    v_and_b32 v11, 3, v0
    v_lshrrev_b32 v12, 5, v0
    v_add_u32 v13, v10, v9
    v_lshl_add_u32 v13, v13, 2, v11
    v_lshlrev_b32 v14, 2, v9
    v_sub_u32 v14, 4, v14
    v_cmp_eq_u32 vcc, 0, v10
    s_nop 1
    v_cndmask_b32 v14, 5, v14, vcc
    v_lshl_add_u32 v14, v14, 2, v11
    v_mul_u32_u24 v15, 0x780, v9
    v_add_u32 v15, 153600, v15
    v_mov_b32 v10, 157440
    v_cmp_eq_u32 vcc, v9, v12
    v_mul_u32_u24 v13, 80, v13
    v_add_u32 v13, v13, v15
    v_cndmask_b32 v26, v10, v13, vcc
    v_mul_u32_u24 v14, 80, v14
    v_add_u32 v14, v14, v15
    v_cndmask_b32 v27, v10, v14, vcc
    v_bfe_u32 v9, v0, 4, 1
    v_mul_u32_u24 v9, 0x5000, v9
    v_and_b32 v10, 0xf0, v1
    v_add_u32 v37, v9, v10
    v_mul_u32_u24 v12, 0x300, v12
    v_add_u32 v36, v37, v12
    v_and_b32 v9, 15, v0
    v_lshlrev_b32 v38, 7, v9
    s_mul_i32 s94, s60, 153600
    s_lshl_b32 s95, s56, 10
    s_add_u32 s94, s94, s95
    s_add_u32 s94, s94, 2097152
    s_waitcnt vmcnt(2)
    s_barrier
    s_mov_b64 exec, 1
    buffer_store_dwordx2 v[2:3], off, s[32:35], s91 sc1
    s_mov_b64 exec, -1
    s_waitcnt vmcnt(1)
    v_cmp_ne_u64 vcc, s[30:31], v[44:45]
    v_cmp_ne_u64 s[96:97], s[30:31], v[46:47]
    s_nop 0
    s_or_b64 vcc, vcc, s[96:97]
    v_cmp_ne_u64 s[96:97], s[30:31], v[40:41]
    s_nop 0
    s_or_b64 vcc, vcc, s[96:97]
    v_cmp_ne_u64 s[96:97], s[30:31], v[42:43]
    s_nop 0
    s_or_b64 vcc, vcc, s[96:97]
    s_cbranch_vccz L_polled_12
    s_mov_b32 s65, 200000
L_poll_11:
    buffer_load_dwordx4 v[44:47], v39, s[32:35], s92 offen sc1
    buffer_load_dwordx4 v[40:43], v39, s[32:35], s92 offen offset:16 sc1
    s_waitcnt vmcnt(0)
    v_cmp_ne_u64 vcc, s[30:31], v[44:45]
    v_cmp_ne_u64 s[96:97], s[30:31], v[46:47]
    s_nop 0
    s_or_b64 vcc, vcc, s[96:97]
    v_cmp_ne_u64 s[96:97], s[30:31], v[40:41]
    s_nop 0
    s_or_b64 vcc, vcc, s[96:97]
    v_cmp_ne_u64 s[96:97], s[30:31], v[42:43]
    s_nop 0
    s_or_b64 vcc, vcc, s[96:97]
    s_cbranch_vccz L_polled_12
    s_sub_u32 s65, s65, 1
    s_cmp_lg_u32 s65, 0
    s_cbranch_scc1 L_poll_11
L_polled_12:
    s_add_u32 m0, s95, 0
    s_add_u32 s68, s94, 0
    buffer_load_dwordx4 v1, s[32:35], s68 offen sc1 lds
    s_add_u32 m0, s95, 4096
    s_add_u32 s68, s94, 4096
    buffer_load_dwordx4 v1, s[32:35], s68 offen sc1 lds
    s_add_u32 m0, s95, 8192
    s_add_u32 s68, s94, 8192
    buffer_load_dwordx4 v1, s[32:35], s68 offen sc1 lds
    s_add_u32 m0, s95, 12288
    s_add_u32 s68, s94, 12288
    buffer_load_dwordx4 v1, s[32:35], s68 offen sc1 lds
    s_add_u32 m0, s95, 16384
    s_add_u32 s68, s94, 16384
    buffer_load_dwordx4 v1, s[32:35], s68 offen sc1 lds
    s_add_u32 m0, s95, 20480
    s_add_u32 s68, s94, 20480
    buffer_load_dwordx4 v1, s[32:35], s68 offen sc1 lds
    s_add_u32 m0, s95, 24576
    s_add_u32 s68, s94, 24576
    buffer_load_dwordx4 v1, s[32:35], s68 offen sc1 lds
    s_add_u32 m0, s95, 28672
    s_add_u32 s68, s94, 28672
    buffer_load_dwordx4 v1, s[32:35], s68 offen sc1 lds
    s_add_u32 m0, s95, 32768
    s_add_u32 s68, s94, 32768
    buffer_load_dwordx4 v1, s[32:35], s68 offen sc1 lds
    s_add_u32 m0, s95, 36864
    s_add_u32 s68, s94, 36864
    buffer_load_dwordx4 v1, s[32:35], s68 offen sc1 lds
    s_lshl_b32 s68, s59, 2
    s_add_u32 s68, s68, s56
    s_mul_i32 s83, s68, 40960
    s_add_u32 s83, s83, 4718592
    s_lshl_b32 s82, s68, 9
    s_add_u32 s82, s82, 65536
    v_and_b32 v40, 3, v0
    v_lshlrev_b32 v40, 7, v40
    v_and_b32 v9, 1, v0
    v_mul_u32_u24 v9, 0x320, v9
    v_bfe_u32 v10, v0, 2, 2
    v_mul_u32_u24 v10, 40, v10
    v_add_u32 v9, v9, v10
    v_bfe_u32 v10, v0, 1, 1
    v_bfe_u32 v11, v0, 4, 1
    v_lshl_add_u32 v10, v11, 1, v10
    v_lshl_add_u32 v9, v10, 3, v9
    v_add_u32 v9, 160256, v9
    v_bfe_u32 v10, v0, 2, 1
    v_lshrrev_b32 v11, 5, v0
    v_cmp_eq_u32 vcc, v10, v11
    s_nop 1
    v_cndmask_b32 v10, 0, -1, vcc
    ds_read_b64_tr_b16 v[200:201], v9 offset:0
    ds_read_b64_tr_b16 v[202:203], v9 offset:160
    ds_read_b64_tr_b16 v[204:205], v9 offset:320
    ds_read_b64_tr_b16 v[206:207], v9 offset:480
    ds_read_b64_tr_b16 v[208:209], v9 offset:640
    v_mov_b32 v210, 0
    v_mov_b32 v211, 0
    ds_read_b64_tr_b16 v[212:213], v9 offset:32
    ds_read_b64_tr_b16 v[214:215], v9 offset:192
    ds_read_b64_tr_b16 v[216:217], v9 offset:352
    ds_read_b64_tr_b16 v[218:219], v9 offset:512
    ds_read_b64_tr_b16 v[220:221], v9 offset:672
    v_mov_b32 v222, 0
    v_mov_b32 v223, 0
    s_waitcnt lgkmcnt(0)
    v_and_b32 v200, v200, v10
    v_and_b32 v201, v201, v10
    v_and_b32 v202, v202, v10
    v_and_b32 v203, v203, v10
    v_and_b32 v204, v204, v10
    v_and_b32 v205, v205, v10
    v_and_b32 v206, v206, v10
    v_and_b32 v207, v207, v10
    v_and_b32 v208, v208, v10
    v_and_b32 v209, v209, v10
    v_and_b32 v212, v212, v10
    v_and_b32 v213, v213, v10
    v_and_b32 v214, v214, v10
    v_and_b32 v215, v215, v10
    v_and_b32 v216, v216, v10
    v_and_b32 v217, v217, v10
    v_and_b32 v218, v218, v10
    v_and_b32 v219, v219, v10
    v_and_b32 v220, v220, v10
    v_and_b32 v221, v221, v10
    s_add_u32 s92, s83, 20480
    s_waitcnt vmcnt(10)
    buffer_load_dwordx2 v[42:43], v40, s[32:35], s82 offen sc1
    s_add_u32 m0, s95, 40960
    s_add_u32 s68, s94, 40960
    buffer_load_dwordx4 v1, s[32:35], s68 offen sc1 lds
    s_add_u32 m0, s95, 45056
    s_add_u32 s68, s94, 45056
    buffer_load_dwordx4 v1, s[32:35], s68 offen sc1 lds
    s_add_u32 m0, s95, 49152
    s_add_u32 s68, s94, 49152
    buffer_load_dwordx4 v1, s[32:35], s68 offen sc1 lds
    s_add_u32 m0, s95, 53248
    s_add_u32 s68, s94, 53248
    buffer_load_dwordx4 v1, s[32:35], s68 offen sc1 lds
    s_add_u32 m0, s95, 57344
    s_add_u32 s68, s94, 57344
    buffer_load_dwordx4 v1, s[32:35], s68 offen sc1 lds
    s_add_u32 m0, s95, 61440
    s_add_u32 s68, s94, 61440
    buffer_load_dwordx4 v1, s[32:35], s68 offen sc1 lds
    s_add_u32 m0, s95, 65536
    s_add_u32 s68, s94, 65536
    buffer_load_dwordx4 v1, s[32:35], s68 offen sc1 lds
    s_add_u32 m0, s95, 69632
    s_add_u32 s68, s94, 69632
    buffer_load_dwordx4 v1, s[32:35], s68 offen sc1 lds
    s_add_u32 m0, s95, 73728
    s_add_u32 s68, s94, 73728
    buffer_load_dwordx4 v1, s[32:35], s68 offen sc1 lds
    s_add_u32 m0, s95, 77824
    s_add_u32 s68, s94, 77824
    buffer_load_dwordx4 v1, s[32:35], s68 offen sc1 lds
    s_waitcnt vmcnt(10)
    v_cmp_ne_u64 vcc, s[30:31], v[42:43]
    s_cbranch_vccz L_polled_14
    s_mov_b32 s65, 200000
L_poll_13:
    buffer_load_dwordx2 v[42:43], v40, s[32:35], s82 offen sc1
    s_waitcnt vmcnt(0)
    v_cmp_ne_u64 vcc, s[30:31], v[42:43]
    s_cbranch_vccz L_polled_14
    s_sub_u32 s65, s65, 1
    s_cmp_lg_u32 s65, 0
    s_cbranch_scc1 L_poll_13
L_polled_14:
    buffer_load_dwordx4 a[0:3], v1, s[32:35], s83 offen offset:0 sc1
    buffer_load_dwordx4 a[4:7], v1, s[32:35], s92 offen offset:0 sc1
    buffer_load_dwordx4 a[8:11], v1, s[32:35], s83 offen offset:1024 sc1
    buffer_load_dwordx4 a[12:15], v1, s[32:35], s92 offen offset:1024 sc1
    buffer_load_dwordx4 a[16:19], v1, s[32:35], s83 offen offset:2048 sc1
    buffer_load_dwordx4 a[20:23], v1, s[32:35], s92 offen offset:2048 sc1
    buffer_load_dwordx4 a[24:27], v1, s[32:35], s83 offen offset:3072 sc1
    buffer_load_dwordx4 a[28:31], v1, s[32:35], s92 offen offset:3072 sc1
    s_add_u32 s83, s83, 4096
    buffer_load_dwordx4 a[32:35], v1, s[32:35], s83 offen offset:0 sc1
    s_add_u32 s92, s92, 4096
    buffer_load_dwordx4 a[36:39], v1, s[32:35], s92 offen offset:0 sc1
    buffer_load_dwordx4 a[40:43], v1, s[32:35], s83 offen offset:1024 sc1
    buffer_load_dwordx4 a[44:47], v1, s[32:35], s92 offen offset:1024 sc1
    buffer_load_dwordx4 a[48:51], v1, s[32:35], s83 offen offset:2048 sc1
    buffer_load_dwordx4 a[52:55], v1, s[32:35], s92 offen offset:2048 sc1
    buffer_load_dwordx4 a[56:59], v1, s[32:35], s83 offen offset:3072 sc1
    buffer_load_dwordx4 a[60:63], v1, s[32:35], s92 offen offset:3072 sc1
    s_waitcnt vmcnt(16)
    s_barrier
    ds_read_b128 a[160:163], v16 offset:0
    ds_read_b128 a[164:167], v16 offset:1024
    ds_read_b128 a[168:171], v16 offset:2048
    ds_read_b128 a[172:175], v16 offset:3072
    ds_read_b128 a[176:179], v16 offset:4096
    ds_read_b128 a[180:183], v16 offset:5120
    s_waitcnt vmcnt(14) lgkmcnt(4)
    v_mfma_f32_16x16x32_bf16 v[64:67], a[160:163], a[0:3], 0
    ds_read_b128 a[184:187], v16 offset:6144
    v_mfma_f32_16x16x32_bf16 v[84:87], a[160:163], a[4:7], 0
    s_add_u32 s83, s83, 4096
    buffer_load_dwordx4 a[64:67], v1, s[32:35], s83 offen offset:0 sc1
    v_mfma_f32_16x16x32_bf16 v[68:71], a[164:167], a[0:3], 0
    ds_read_b128 a[188:191], v16 offset:7168
    v_mfma_f32_16x16x32_bf16 v[88:91], a[164:167], a[4:7], 0
    s_waitcnt lgkmcnt(4)
    v_mfma_f32_16x16x32_bf16 v[72:75], a[168:171], a[0:3], 0
    ds_read_b128 a[160:163], v16 offset:8192
    v_mfma_f32_16x16x32_bf16 v[92:95], a[168:171], a[4:7], 0
    s_add_u32 s92, s92, 4096
    buffer_load_dwordx4 a[68:71], v1, s[32:35], s92 offen offset:0 sc1
    v_mfma_f32_16x16x32_bf16 v[76:79], a[172:175], a[0:3], 0
    ds_read_b128 a[164:167], v16 offset:9216
    v_mfma_f32_16x16x32_bf16 v[96:99], a[172:175], a[4:7], 0
    s_waitcnt lgkmcnt(4)
    v_mfma_f32_16x16x32_bf16 v[80:83], a[176:179], a[0:3], 0
    ds_read_b128 a[168:171], v16 offset:10240
    v_mfma_f32_16x16x32_bf16 v[100:103], a[176:179], a[4:7], 0
    s_add_u32 m0, s95, 81920
    s_add_u32 s68, s94, 81920
    buffer_load_dwordx4 v1, s[32:35], s68 offen sc1 lds
    s_waitcnt vmcnt(15)
    v_mfma_f32_16x16x32_bf16 v[64:67], a[180:183], a[8:11], v[64:67]
    ds_read_b128 a[172:175], v16 offset:11264
    v_mfma_f32_16x16x32_bf16 v[84:87], a[180:183], a[12:15], v[84:87]
    s_waitcnt lgkmcnt(4)
    v_mfma_f32_16x16x32_bf16 v[68:71], a[184:187], a[8:11], v[68:71]
    ds_read_b128 a[176:179], v16 offset:12288
    v_mfma_f32_16x16x32_bf16 v[88:91], a[184:187], a[12:15], v[88:91]
    buffer_load_dwordx4 a[72:75], v1, s[32:35], s83 offen offset:1024 sc1
    v_mfma_f32_16x16x32_bf16 v[72:75], a[188:191], a[8:11], v[72:75]
    ds_read_b128 a[180:183], v16 offset:13312
    v_mfma_f32_16x16x32_bf16 v[92:95], a[188:191], a[12:15], v[92:95]
    s_waitcnt lgkmcnt(4)
    v_mfma_f32_16x16x32_bf16 v[76:79], a[160:163], a[8:11], v[76:79]
    ds_read_b128 a[184:187], v16 offset:14336
    v_mfma_f32_16x16x32_bf16 v[96:99], a[160:163], a[12:15], v[96:99]
    buffer_load_dwordx4 a[76:79], v1, s[32:35], s92 offen offset:1024 sc1
    v_mfma_f32_16x16x32_bf16 v[80:83], a[164:167], a[8:11], v[80:83]
    ds_read_b128 a[188:191], v16 offset:15360
    v_mfma_f32_16x16x32_bf16 v[100:103], a[164:167], a[12:15], v[100:103]
    s_waitcnt vmcnt(15) lgkmcnt(4)
    v_mfma_f32_16x16x32_bf16 v[64:67], a[168:171], a[16:19], v[64:67]
    ds_read_b128 a[160:163], v16 offset:16384
    v_mfma_f32_16x16x32_bf16 v[84:87], a[168:171], a[20:23], v[84:87]
    s_add_u32 m0, s95, 86016
    s_add_u32 s68, s94, 86016
    buffer_load_dwordx4 v1, s[32:35], s68 offen sc1 lds
    v_mfma_f32_16x16x32_bf16 v[68:71], a[172:175], a[16:19], v[68:71]
    ds_read_b128 a[164:167], v16 offset:17408
    v_mfma_f32_16x16x32_bf16 v[88:91], a[172:175], a[20:23], v[88:91]
    s_waitcnt lgkmcnt(4)
    v_mfma_f32_16x16x32_bf16 v[72:75], a[176:179], a[16:19], v[72:75]
    ds_read_b128 a[168:171], v16 offset:18432
    v_mfma_f32_16x16x32_bf16 v[92:95], a[176:179], a[20:23], v[92:95]
    buffer_load_dwordx4 a[80:83], v1, s[32:35], s83 offen offset:2048 sc1
    v_mfma_f32_16x16x32_bf16 v[76:79], a[180:183], a[16:19], v[76:79]
    ds_read_b128 a[172:175], v16 offset:19456
    v_mfma_f32_16x16x32_bf16 v[96:99], a[180:183], a[20:23], v[96:99]
    s_waitcnt lgkmcnt(4)
    v_mfma_f32_16x16x32_bf16 v[80:83], a[184:187], a[16:19], v[80:83]
    ds_read_b128 a[176:179], v16 offset:20480
    v_mfma_f32_16x16x32_bf16 v[100:103], a[184:187], a[20:23], v[100:103]
    buffer_load_dwordx4 a[84:87], v1, s[32:35], s92 offen offset:2048 sc1
    s_waitcnt vmcnt(16)
    v_mfma_f32_16x16x32_bf16 v[64:67], a[188:191], a[24:27], v[64:67]
    ds_read_b128 a[180:183], v16 offset:21504
    v_mfma_f32_16x16x32_bf16 v[84:87], a[188:191], a[28:31], v[84:87]
    s_waitcnt lgkmcnt(4)
    v_mfma_f32_16x16x32_bf16 v[68:71], a[160:163], a[24:27], v[68:71]
    ds_read_b128 a[184:187], v16 offset:22528
    v_mfma_f32_16x16x32_bf16 v[88:91], a[160:163], a[28:31], v[88:91]
    s_add_u32 m0, s95, 90112
    s_add_u32 s68, s94, 90112
    buffer_load_dwordx4 v1, s[32:35], s68 offen sc1 lds
    v_mfma_f32_16x16x32_bf16 v[72:75], a[164:167], a[24:27], v[72:75]
    ds_read_b128 a[188:191], v16 offset:23552
    v_mfma_f32_16x16x32_bf16 v[92:95], a[164:167], a[28:31], v[92:95]
    s_waitcnt lgkmcnt(4)
    v_mfma_f32_16x16x32_bf16 v[76:79], a[168:171], a[24:27], v[76:79]
    ds_read_b128 a[160:163], v16 offset:24576
    v_mfma_f32_16x16x32_bf16 v[96:99], a[168:171], a[28:31], v[96:99]
    buffer_load_dwordx4 a[88:91], v1, s[32:35], s83 offen offset:3072 sc1
    v_mfma_f32_16x16x32_bf16 v[80:83], a[172:175], a[24:27], v[80:83]
    ds_read_b128 a[164:167], v16 offset:25600
    v_mfma_f32_16x16x32_bf16 v[100:103], a[172:175], a[28:31], v[100:103]
    s_waitcnt vmcnt(16) lgkmcnt(4)
    v_mfma_f32_16x16x32_bf16 v[64:67], a[176:179], a[32:35], v[64:67]
    ds_read_b128 a[168:171], v16 offset:26624
    v_mfma_f32_16x16x32_bf16 v[84:87], a[176:179], a[36:39], v[84:87]
    buffer_load_dwordx4 a[92:95], v1, s[32:35], s92 offen offset:3072 sc1
    v_mfma_f32_16x16x32_bf16 v[68:71], a[180:183], a[32:35], v[68:71]
    ds_read_b128 a[172:175], v16 offset:27648
    v_mfma_f32_16x16x32_bf16 v[88:91], a[180:183], a[36:39], v[88:91]
    s_waitcnt lgkmcnt(4)
    v_mfma_f32_16x16x32_bf16 v[72:75], a[184:187], a[32:35], v[72:75]
    ds_read_b128 a[176:179], v16 offset:28672
    v_mfma_f32_16x16x32_bf16 v[92:95], a[184:187], a[36:39], v[92:95]
    s_add_u32 m0, s95, 94208
    s_add_u32 s68, s94, 94208
    buffer_load_dwordx4 v1, s[32:35], s68 offen sc1 lds
    v_mfma_f32_16x16x32_bf16 v[76:79], a[188:191], a[32:35], v[76:79]
    ds_read_b128 a[180:183], v16 offset:29696
    v_mfma_f32_16x16x32_bf16 v[96:99], a[188:191], a[36:39], v[96:99]
    s_waitcnt lgkmcnt(4)
    v_mfma_f32_16x16x32_bf16 v[80:83], a[160:163], a[32:35], v[80:83]
    ds_read_b128 a[184:187], v16 offset:30720
    v_mfma_f32_16x16x32_bf16 v[100:103], a[160:163], a[36:39], v[100:103]
    s_add_u32 s83, s83, 4096
    buffer_load_dwordx4 a[96:99], v1, s[32:35], s83 offen offset:0 sc1
    s_waitcnt vmcnt(17)
    v_mfma_f32_16x16x32_bf16 v[64:67], a[164:167], a[40:43], v[64:67]
    ds_read_b128 a[188:191], v16 offset:31744
    v_mfma_f32_16x16x32_bf16 v[84:87], a[164:167], a[44:47], v[84:87]
    s_waitcnt lgkmcnt(4)
    v_mfma_f32_16x16x32_bf16 v[68:71], a[168:171], a[40:43], v[68:71]
    ds_read_b128 a[160:163], v16 offset:32768
    v_mfma_f32_16x16x32_bf16 v[88:91], a[168:171], a[44:47], v[88:91]
    s_add_u32 s92, s92, 4096
    buffer_load_dwordx4 a[100:103], v1, s[32:35], s92 offen offset:0 sc1
    v_mfma_f32_16x16x32_bf16 v[72:75], a[172:175], a[40:43], v[72:75]
    ds_read_b128 a[164:167], v16 offset:33792
    v_mfma_f32_16x16x32_bf16 v[92:95], a[172:175], a[44:47], v[92:95]
    s_waitcnt lgkmcnt(4)
    v_mfma_f32_16x16x32_bf16 v[76:79], a[176:179], a[40:43], v[76:79]
    ds_read_b128 a[168:171], v16 offset:34816
    v_mfma_f32_16x16x32_bf16 v[96:99], a[176:179], a[44:47], v[96:99]
    s_add_u32 m0, s95, 98304
    s_add_u32 s68, s94, 98304
    buffer_load_dwordx4 v1, s[32:35], s68 offen sc1 lds
    v_mfma_f32_16x16x32_bf16 v[80:83], a[180:183], a[40:43], v[80:83]
    ds_read_b128 a[172:175], v16 offset:35840
    v_mfma_f32_16x16x32_bf16 v[100:103], a[180:183], a[44:47], v[100:103]
    s_waitcnt vmcnt(17) lgkmcnt(4)
    v_mfma_f32_16x16x32_bf16 v[64:67], a[184:187], a[48:51], v[64:67]
    ds_read_b128 a[176:179], v16 offset:36864
    v_mfma_f32_16x16x32_bf16 v[84:87], a[184:187], a[52:55], v[84:87]
    buffer_load_dwordx4 a[104:107], v1, s[32:35], s83 offen offset:1024 sc1
    v_mfma_f32_16x16x32_bf16 v[68:71], a[188:191], a[48:51], v[68:71]
    ds_read_b128 a[180:183], v16 offset:37888
    v_mfma_f32_16x16x32_bf16 v[88:91], a[188:191], a[52:55], v[88:91]
    s_waitcnt lgkmcnt(4)
    v_mfma_f32_16x16x32_bf16 v[72:75], a[160:163], a[48:51], v[72:75]
    ds_read_b128 a[184:187], v16 offset:38912
    v_mfma_f32_16x16x32_bf16 v[92:95], a[160:163], a[52:55], v[92:95]
    buffer_load_dwordx4 a[108:111], v1, s[32:35], s92 offen offset:1024 sc1
    v_mfma_f32_16x16x32_bf16 v[76:79], a[164:167], a[48:51], v[76:79]
    ds_read_b128 a[188:191], v16 offset:39936
    v_mfma_f32_16x16x32_bf16 v[96:99], a[164:167], a[52:55], v[96:99]
    s_waitcnt lgkmcnt(4)
    v_mfma_f32_16x16x32_bf16 v[80:83], a[168:171], a[48:51], v[80:83]
    ds_read_b128 a[160:163], v16 offset:40960
    v_mfma_f32_16x16x32_bf16 v[100:103], a[168:171], a[52:55], v[100:103]
    buffer_load_dwordx4 a[112:115], v1, s[32:35], s83 offen offset:2048 sc1
    s_waitcnt vmcnt(18)
    v_mfma_f32_16x16x32_bf16 v[64:67], a[172:175], a[56:59], v[64:67]
    ds_read_b128 a[164:167], v16 offset:41984
    v_mfma_f32_16x16x32_bf16 v[84:87], a[172:175], a[60:63], v[84:87]
    s_waitcnt lgkmcnt(4)
    v_mfma_f32_16x16x32_bf16 v[68:71], a[176:179], a[56:59], v[68:71]
    ds_read_b128 a[168:171], v16 offset:43008
    v_mfma_f32_16x16x32_bf16 v[88:91], a[176:179], a[60:63], v[88:91]
    buffer_load_dwordx4 a[116:119], v1, s[32:35], s92 offen offset:2048 sc1
    v_mfma_f32_16x16x32_bf16 v[72:75], a[180:183], a[56:59], v[72:75]
    ds_read_b128 a[172:175], v16 offset:44032
    v_mfma_f32_16x16x32_bf16 v[92:95], a[180:183], a[60:63], v[92:95]
    s_waitcnt lgkmcnt(4)
    v_mfma_f32_16x16x32_bf16 v[76:79], a[184:187], a[56:59], v[76:79]
    ds_read_b128 a[176:179], v16 offset:45056
    v_mfma_f32_16x16x32_bf16 v[96:99], a[184:187], a[60:63], v[96:99]
    buffer_load_dwordx4 a[120:123], v1, s[32:35], s83 offen offset:3072 sc1
    v_mfma_f32_16x16x32_bf16 v[80:83], a[188:191], a[56:59], v[80:83]
    ds_read_b128 a[180:183], v16 offset:46080
    v_mfma_f32_16x16x32_bf16 v[100:103], a[188:191], a[60:63], v[100:103]
    s_waitcnt vmcnt(18) lgkmcnt(4)
    v_mfma_f32_16x16x32_bf16 v[64:67], a[160:163], a[64:67], v[64:67]
    ds_read_b128 a[184:187], v16 offset:47104
    v_mfma_f32_16x16x32_bf16 v[84:87], a[160:163], a[68:71], v[84:87]
    buffer_load_dwordx4 a[124:127], v1, s[32:35], s92 offen offset:3072 sc1
    v_mfma_f32_16x16x32_bf16 v[68:71], a[164:167], a[64:67], v[68:71]
    ds_read_b128 a[188:191], v16 offset:48128
    v_mfma_f32_16x16x32_bf16 v[88:91], a[164:167], a[68:71], v[88:91]
    s_waitcnt lgkmcnt(4)
    v_mfma_f32_16x16x32_bf16 v[72:75], a[168:171], a[64:67], v[72:75]
    ds_read_b128 a[160:163], v16 offset:49152
    v_mfma_f32_16x16x32_bf16 v[92:95], a[168:171], a[68:71], v[92:95]
    s_add_u32 s83, s83, 4096
    buffer_load_dwordx4 a[128:131], v1, s[32:35], s83 offen offset:0 sc1
    v_mfma_f32_16x16x32_bf16 v[76:79], a[172:175], a[64:67], v[76:79]
    ds_read_b128 a[164:167], v16 offset:50176
    v_mfma_f32_16x16x32_bf16 v[96:99], a[172:175], a[68:71], v[96:99]
    s_waitcnt lgkmcnt(4)
    v_mfma_f32_16x16x32_bf16 v[80:83], a[176:179], a[64:67], v[80:83]
    ds_read_b128 a[168:171], v16 offset:51200
    v_mfma_f32_16x16x32_bf16 v[100:103], a[176:179], a[68:71], v[100:103]
    s_add_u32 s92, s92, 4096
    buffer_load_dwordx4 a[132:135], v1, s[32:35], s92 offen offset:0 sc1
    s_waitcnt vmcnt(18)
    v_mfma_f32_16x16x32_bf16 v[64:67], a[180:183], a[72:75], v[64:67]
    ds_read_b128 a[172:175], v16 offset:52224
    v_mfma_f32_16x16x32_bf16 v[84:87], a[180:183], a[76:79], v[84:87]
    s_waitcnt lgkmcnt(4)
    v_mfma_f32_16x16x32_bf16 v[68:71], a[184:187], a[72:75], v[68:71]
    ds_read_b128 a[176:179], v16 offset:53248
    v_mfma_f32_16x16x32_bf16 v[88:91], a[184:187], a[76:79], v[88:91]
    buffer_load_dwordx4 a[136:139], v1, s[32:35], s83 offen offset:1024 sc1
    v_mfma_f32_16x16x32_bf16 v[72:75], a[188:191], a[72:75], v[72:75]
    ds_read_b128 a[180:183], v16 offset:54272
    v_mfma_f32_16x16x32_bf16 v[92:95], a[188:191], a[76:79], v[92:95]
    s_waitcnt lgkmcnt(4)
    v_mfma_f32_16x16x32_bf16 v[76:79], a[160:163], a[72:75], v[76:79]
    ds_read_b128 a[184:187], v16 offset:55296
    v_mfma_f32_16x16x32_bf16 v[96:99], a[160:163], a[76:79], v[96:99]
    buffer_load_dwordx4 a[140:143], v1, s[32:35], s92 offen offset:1024 sc1
    v_mfma_f32_16x16x32_bf16 v[80:83], a[164:167], a[72:75], v[80:83]
    ds_read_b128 a[188:191], v16 offset:56320
    v_mfma_f32_16x16x32_bf16 v[100:103], a[164:167], a[76:79], v[100:103]
    s_waitcnt vmcnt(17) lgkmcnt(4)
    v_mfma_f32_16x16x32_bf16 v[64:67], a[168:171], a[80:83], v[64:67]
    ds_read_b128 a[160:163], v16 offset:57344
    v_mfma_f32_16x16x32_bf16 v[84:87], a[168:171], a[84:87], v[84:87]
    buffer_load_dwordx4 a[144:147], v1, s[32:35], s83 offen offset:2048 sc1
    v_mfma_f32_16x16x32_bf16 v[68:71], a[172:175], a[80:83], v[68:71]
    ds_read_b128 a[164:167], v16 offset:58368
    v_mfma_f32_16x16x32_bf16 v[88:91], a[172:175], a[84:87], v[88:91]
    s_waitcnt lgkmcnt(4)
    v_mfma_f32_16x16x32_bf16 v[72:75], a[176:179], a[80:83], v[72:75]
    ds_read_b128 a[168:171], v16 offset:59392
    v_mfma_f32_16x16x32_bf16 v[92:95], a[176:179], a[84:87], v[92:95]
    buffer_load_dwordx4 a[148:151], v1, s[32:35], s92 offen offset:2048 sc1
    v_mfma_f32_16x16x32_bf16 v[76:79], a[180:183], a[80:83], v[76:79]
    ds_read_b128 a[172:175], v16 offset:60416
    v_mfma_f32_16x16x32_bf16 v[96:99], a[180:183], a[84:87], v[96:99]
    s_waitcnt lgkmcnt(4)
    v_mfma_f32_16x16x32_bf16 v[80:83], a[184:187], a[80:83], v[80:83]
    ds_read_b128 a[176:179], v16 offset:61440
    v_mfma_f32_16x16x32_bf16 v[100:103], a[184:187], a[84:87], v[100:103]
    buffer_load_dwordx4 a[152:155], v1, s[32:35], s83 offen offset:3072 sc1
    s_waitcnt vmcnt(17)
    v_mfma_f32_16x16x32_bf16 v[64:67], a[188:191], a[88:91], v[64:67]
    ds_read_b128 a[180:183], v16 offset:62464
    v_mfma_f32_16x16x32_bf16 v[84:87], a[188:191], a[92:95], v[84:87]
    s_waitcnt lgkmcnt(4)
    v_mfma_f32_16x16x32_bf16 v[68:71], a[160:163], a[88:91], v[68:71]
    ds_read_b128 a[184:187], v16 offset:63488
    v_mfma_f32_16x16x32_bf16 v[88:91], a[160:163], a[92:95], v[88:91]
    buffer_load_dwordx4 a[156:159], v1, s[32:35], s92 offen offset:3072 sc1
    v_mfma_f32_16x16x32_bf16 v[72:75], a[164:167], a[88:91], v[72:75]
    ds_read_b128 a[188:191], v16 offset:64512
    v_mfma_f32_16x16x32_bf16 v[92:95], a[164:167], a[92:95], v[92:95]
    s_waitcnt lgkmcnt(4)
    v_mfma_f32_16x16x32_bf16 v[76:79], a[168:171], a[88:91], v[76:79]
    ds_read_b128 a[160:163], v17 offset:0
    v_mfma_f32_16x16x32_bf16 v[96:99], a[168:171], a[92:95], v[96:99]
    v_mfma_f32_16x16x32_bf16 v[80:83], a[172:175], a[88:91], v[80:83]
    ds_read_b128 a[164:167], v17 offset:1024
    v_mfma_f32_16x16x32_bf16 v[100:103], a[172:175], a[92:95], v[100:103]
    s_add_u32 m0, s87, 4096
    s_nop 0
    buffer_load_dwordx4 v32, s[44:47], s8 offen nt lds
    s_waitcnt vmcnt(16) lgkmcnt(4)
    v_mfma_f32_16x16x32_bf16 v[64:67], a[176:179], a[96:99], v[64:67]
    ds_read_b128 a[168:171], v17 offset:2048
    v_mfma_f32_16x16x32_bf16 v[84:87], a[176:179], a[100:103], v[84:87]
    v_mfma_f32_16x16x32_bf16 v[68:71], a[180:183], a[96:99], v[68:71]
    ds_read_b128 a[172:175], v17 offset:3072
    v_mfma_f32_16x16x32_bf16 v[88:91], a[180:183], a[100:103], v[88:91]
    s_waitcnt lgkmcnt(4)
    v_mfma_f32_16x16x32_bf16 v[72:75], a[184:187], a[96:99], v[72:75]
    ds_read_b128 a[176:179], v17 offset:4096
    v_mfma_f32_16x16x32_bf16 v[92:95], a[184:187], a[100:103], v[92:95]
    v_mfma_f32_16x16x32_bf16 v[76:79], a[188:191], a[96:99], v[76:79]
    ds_read_b128 a[180:183], v17 offset:5120
    v_mfma_f32_16x16x32_bf16 v[96:99], a[188:191], a[100:103], v[96:99]
    s_add_u32 m0, s87, 5120
    s_nop 0
    buffer_load_dwordx4 v32, s[44:47], s9 offen nt lds
    s_waitcnt lgkmcnt(4)
    v_mfma_f32_16x16x32_bf16 v[80:83], a[160:163], a[96:99], v[80:83]
    ds_read_b128 a[184:187], v17 offset:6144
    v_mfma_f32_16x16x32_bf16 v[100:103], a[160:163], a[100:103], v[100:103]
    s_waitcnt vmcnt(14)
    v_mfma_f32_16x16x32_bf16 v[64:67], a[164:167], a[104:107], v[64:67]
    ds_read_b128 a[188:191], v17 offset:7168
    v_mfma_f32_16x16x32_bf16 v[84:87], a[164:167], a[108:111], v[84:87]
    s_waitcnt lgkmcnt(4)
    v_mfma_f32_16x16x32_bf16 v[68:71], a[168:171], a[104:107], v[68:71]
    ds_read_b128 a[160:163], v17 offset:8192
    v_mfma_f32_16x16x32_bf16 v[88:91], a[168:171], a[108:111], v[88:91]
    v_mfma_f32_16x16x32_bf16 v[72:75], a[172:175], a[104:107], v[72:75]
    ds_read_b128 a[164:167], v17 offset:9216
    v_mfma_f32_16x16x32_bf16 v[92:95], a[172:175], a[108:111], v[92:95]
    s_add_u32 m0, s87, 6144
    s_nop 0
    buffer_load_dwordx4 v32, s[44:47], s10 offen nt lds
    s_waitcnt lgkmcnt(4)
    v_mfma_f32_16x16x32_bf16 v[76:79], a[176:179], a[104:107], v[76:79]
    ds_read_b128 a[168:171], v17 offset:10240
    v_mfma_f32_16x16x32_bf16 v[96:99], a[176:179], a[108:111], v[96:99]
    v_mfma_f32_16x16x32_bf16 v[80:83], a[180:183], a[104:107], v[80:83]
    ds_read_b128 a[172:175], v17 offset:11264
    v_mfma_f32_16x16x32_bf16 v[100:103], a[180:183], a[108:111], v[100:103]
    s_waitcnt vmcnt(13) lgkmcnt(4)
    v_mfma_f32_16x16x32_bf16 v[64:67], a[184:187], a[112:115], v[64:67]
    ds_read_b128 a[176:179], v17 offset:12288
    v_mfma_f32_16x16x32_bf16 v[84:87], a[184:187], a[116:119], v[84:87]
    v_mfma_f32_16x16x32_bf16 v[68:71], a[188:191], a[112:115], v[68:71]
    ds_read_b128 a[180:183], v17 offset:13312
    v_mfma_f32_16x16x32_bf16 v[88:91], a[188:191], a[116:119], v[88:91]
    s_add_u32 m0, s87, 7168
    s_nop 0
    buffer_load_dwordx4 v32, s[44:47], s11 offen nt lds
    s_waitcnt lgkmcnt(4)
    v_mfma_f32_16x16x32_bf16 v[72:75], a[160:163], a[112:115], v[72:75]
    ds_read_b128 a[184:187], v17 offset:14336
    v_mfma_f32_16x16x32_bf16 v[92:95], a[160:163], a[116:119], v[92:95]
    v_mfma_f32_16x16x32_bf16 v[76:79], a[164:167], a[112:115], v[76:79]
    ds_read_b128 a[188:191], v17 offset:15360
    v_mfma_f32_16x16x32_bf16 v[96:99], a[164:167], a[116:119], v[96:99]
    s_waitcnt lgkmcnt(4)
    v_mfma_f32_16x16x32_bf16 v[80:83], a[168:171], a[112:115], v[80:83]
    s_barrier
    ds_read_b128 a[160:163], v17 offset:16384
    v_mfma_f32_16x16x32_bf16 v[100:103], a[168:171], a[116:119], v[100:103]
    s_waitcnt vmcnt(12)
    v_mfma_f32_16x16x32_bf16 v[64:67], a[172:175], a[120:123], v[64:67]
    ds_read_b128 a[164:167], v17 offset:17408
    v_mfma_f32_16x16x32_bf16 v[84:87], a[172:175], a[124:127], v[84:87]
    s_mul_i32 s68, s56, 5120
    s_add_u32 m0, s68, 135168
    s_add_u32 s68, s85, 0
    buffer_load_dwordx4 v244, s[36:39], s68 offen nt lds
    s_waitcnt lgkmcnt(4)
    v_mfma_f32_16x16x32_bf16 v[68:71], a[176:179], a[120:123], v[68:71]
    ds_read_b128 a[168:171], v17 offset:18432
    v_mfma_f32_16x16x32_bf16 v[88:91], a[176:179], a[124:127], v[88:91]
    v_mfma_f32_16x16x32_bf16 v[72:75], a[180:183], a[120:123], v[72:75]
    ds_read_b128 a[172:175], v17 offset:19456
    v_mfma_f32_16x16x32_bf16 v[92:95], a[180:183], a[124:127], v[92:95]
    s_waitcnt lgkmcnt(4)
    v_mfma_f32_16x16x32_bf16 v[76:79], a[184:187], a[120:123], v[76:79]
    ds_read_b128 a[176:179], v17 offset:20480
    v_mfma_f32_16x16x32_bf16 v[96:99], a[184:187], a[124:127], v[96:99]
    v_mfma_f32_16x16x32_bf16 v[80:83], a[188:191], a[120:123], v[80:83]
    ds_read_b128 a[180:183], v17 offset:21504
    v_mfma_f32_16x16x32_bf16 v[100:103], a[188:191], a[124:127], v[100:103]
    s_mul_i32 s68, s56, 5120
    s_add_u32 m0, s68, 136192
    s_add_u32 s68, s85, 61440
    buffer_load_dwordx4 v244, s[36:39], s68 offen nt lds
    s_waitcnt vmcnt(12) lgkmcnt(4)
    v_mfma_f32_16x16x32_bf16 v[64:67], a[160:163], a[128:131], v[64:67]
    ds_read_b128 a[184:187], v17 offset:22528
    v_mfma_f32_16x16x32_bf16 v[84:87], a[160:163], a[132:135], v[84:87]
    v_mfma_f32_16x16x32_bf16 v[68:71], a[164:167], a[128:131], v[68:71]
    ds_read_b128 a[188:191], v17 offset:23552
    v_mfma_f32_16x16x32_bf16 v[88:91], a[164:167], a[132:135], v[88:91]
    s_waitcnt lgkmcnt(4)
    v_mfma_f32_16x16x32_bf16 v[72:75], a[168:171], a[128:131], v[72:75]
    ds_read_b128 a[160:163], v17 offset:24576
    v_mfma_f32_16x16x32_bf16 v[92:95], a[168:171], a[132:135], v[92:95]
    v_mfma_f32_16x16x32_bf16 v[76:79], a[172:175], a[128:131], v[76:79]
    ds_read_b128 a[164:167], v17 offset:25600
    v_mfma_f32_16x16x32_bf16 v[96:99], a[172:175], a[132:135], v[96:99]
    s_mul_i32 s68, s56, 5120
    s_add_u32 m0, s68, 137216
    s_add_u32 s68, s85, 122880
    buffer_load_dwordx4 v244, s[36:39], s68 offen nt lds
    s_waitcnt lgkmcnt(4)
    v_mfma_f32_16x16x32_bf16 v[80:83], a[176:179], a[128:131], v[80:83]
    ds_read_b128 a[168:171], v17 offset:26624
    v_mfma_f32_16x16x32_bf16 v[100:103], a[176:179], a[132:135], v[100:103]
    s_waitcnt vmcnt(11)
    v_mfma_f32_16x16x32_bf16 v[64:67], a[180:183], a[136:139], v[64:67]
    ds_read_b128 a[172:175], v17 offset:27648
    v_mfma_f32_16x16x32_bf16 v[84:87], a[180:183], a[140:143], v[84:87]
    s_waitcnt lgkmcnt(4)
    v_mfma_f32_16x16x32_bf16 v[68:71], a[184:187], a[136:139], v[68:71]
    ds_read_b128 a[176:179], v17 offset:28672
    v_mfma_f32_16x16x32_bf16 v[88:91], a[184:187], a[140:143], v[88:91]
    v_mfma_f32_16x16x32_bf16 v[72:75], a[188:191], a[136:139], v[72:75]
    ds_read_b128 a[180:183], v17 offset:29696
    v_mfma_f32_16x16x32_bf16 v[92:95], a[188:191], a[140:143], v[92:95]
    s_mul_i32 s68, s56, 5120
    s_add_u32 m0, s68, 138240
    s_add_u32 s68, s85, 184320
    buffer_load_dwordx4 v244, s[36:39], s68 offen nt lds
    s_waitcnt lgkmcnt(4)
    v_mfma_f32_16x16x32_bf16 v[76:79], a[160:163], a[136:139], v[76:79]
    ds_read_b128 a[184:187], v17 offset:30720
    v_mfma_f32_16x16x32_bf16 v[96:99], a[160:163], a[140:143], v[96:99]
    v_mfma_f32_16x16x32_bf16 v[80:83], a[164:167], a[136:139], v[80:83]
    ds_read_b128 a[188:191], v17 offset:31744
    v_mfma_f32_16x16x32_bf16 v[100:103], a[164:167], a[140:143], v[100:103]
    s_waitcnt vmcnt(10) lgkmcnt(4)
    v_mfma_f32_16x16x32_bf16 v[64:67], a[168:171], a[144:147], v[64:67]
    ds_read_b128 a[160:163], v17 offset:32768
    v_mfma_f32_16x16x32_bf16 v[84:87], a[168:171], a[148:151], v[84:87]
    v_mfma_f32_16x16x32_bf16 v[68:71], a[172:175], a[144:147], v[68:71]
    ds_read_b128 a[164:167], v17 offset:33792
    v_mfma_f32_16x16x32_bf16 v[88:91], a[172:175], a[148:151], v[88:91]
    s_mul_i32 s68, s56, 5120
    s_add_u32 m0, s68, 139264
    s_add_u32 s68, s85, 245760
    buffer_load_dwordx4 v244, s[36:39], s68 offen nt lds
    s_waitcnt lgkmcnt(4)
    v_mfma_f32_16x16x32_bf16 v[72:75], a[176:179], a[144:147], v[72:75]
    ds_read_b128 a[168:171], v17 offset:34816
    v_mfma_f32_16x16x32_bf16 v[92:95], a[176:179], a[148:151], v[92:95]
    v_mfma_f32_16x16x32_bf16 v[76:79], a[180:183], a[144:147], v[76:79]
    ds_read_b128 a[172:175], v17 offset:35840
    v_mfma_f32_16x16x32_bf16 v[96:99], a[180:183], a[148:151], v[96:99]
    s_waitcnt lgkmcnt(4)
    v_mfma_f32_16x16x32_bf16 v[80:83], a[184:187], a[144:147], v[80:83]
    v_mfma_f32_16x16x32_bf16 v[100:103], a[184:187], a[148:151], v[100:103]
    s_waitcnt vmcnt(9)
    v_mfma_f32_16x16x32_bf16 v[64:67], a[188:191], a[152:155], v[64:67]
    v_mfma_f32_16x16x32_bf16 v[84:87], a[188:191], a[156:159], v[84:87]
    s_waitcnt lgkmcnt(2)
    v_mfma_f32_16x16x32_bf16 v[68:71], a[160:163], a[152:155], v[68:71]
    v_mfma_f32_16x16x32_bf16 v[88:91], a[160:163], a[156:159], v[88:91]
    v_mfma_f32_16x16x32_bf16 v[72:75], a[164:167], a[152:155], v[72:75]
    v_mfma_f32_16x16x32_bf16 v[92:95], a[164:167], a[156:159], v[92:95]
    s_waitcnt lgkmcnt(0)
    v_mfma_f32_16x16x32_bf16 v[76:79], a[168:171], a[152:155], v[76:79]
    v_mfma_f32_16x16x32_bf16 v[96:99], a[168:171], a[156:159], v[96:99]
    v_mfma_f32_16x16x32_bf16 v[80:83], a[172:175], a[152:155], v[80:83]
    v_mfma_f32_16x16x32_bf16 v[100:103], a[172:175], a[156:159], v[100:103]
    s_barrier
    v_cvt_pk_bf16_f32 v128, v64, v65
    v_cvt_pk_bf16_f32 v40, v84, v85
    v_cvt_pk_bf16_f32 v129, v66, v67
    v_cvt_pk_bf16_f32 v41, v86, v87
    v_cvt_pk_bf16_f32 v130, v68, v69
    v_cvt_pk_bf16_f32 v42, v88, v89
    v_cvt_pk_bf16_f32 v131, v70, v71
    v_cvt_pk_bf16_f32 v43, v90, v91
    v_cvt_pk_bf16_f32 v132, v72, v73
    v_cvt_pk_bf16_f32 v44, v92, v93
    v_cvt_pk_bf16_f32 v133, v74, v75
    v_cvt_pk_bf16_f32 v45, v94, v95
    v_cvt_pk_bf16_f32 v134, v76, v77
    v_cvt_pk_bf16_f32 v46, v96, v97
    v_cvt_pk_bf16_f32 v135, v78, v79
    v_cvt_pk_bf16_f32 v47, v98, v99
    v_cvt_pk_bf16_f32 v136, v80, v81
    v_cvt_pk_bf16_f32 v48, v100, v101
    v_cvt_pk_bf16_f32 v137, v82, v83
    v_cvt_pk_bf16_f32 v49, v102, v103
    v_mov_b32 v138, 0
    v_mov_b32 v139, 0
    v_mov_b32 v50, 0x3f80
    v_mov_b32 v51, 0
    v_permlane16_swap_b32 v128, v40
    v_permlane16_swap_b32 v129, v41
    v_permlane16_swap_b32 v130, v42
    v_permlane16_swap_b32 v131, v43
    v_permlane16_swap_b32 v132, v44
    v_permlane16_swap_b32 v133, v45
    v_permlane16_swap_b32 v134, v46
    v_permlane16_swap_b32 v135, v47
    v_permlane16_swap_b32 v136, v48
    v_permlane16_swap_b32 v137, v49
    v_mfma_f32_32x32x16_bf16 v[156:171], v[212:215], v[128:131], 0
    v_mfma_f32_32x32x16_bf16 v[156:171], v[216:219], v[132:135], v[156:171]
    v_mfma_f32_32x32x16_bf16 v[156:171], v[220:223], v[136:139], v[156:171]
    v_mfma_f32_32x32x16_bf16 v[140:155], v[200:203], v[128:131], 0
    v_mfma_f32_32x32x16_bf16 v[140:155], v[204:207], v[132:135], v[140:155]
    v_mfma_f32_32x32x16_bf16 v[140:155], v[208:211], v[136:139], v[140:155]
    ds_write_b128 v20, v[40:43] offset:160
    ds_write_b128 v20, v[44:47] offset:176
    ds_write_b128 v20, v[48:51] offset:192
    s_nop 5
    v_max3_f32 v192, v156, v157, v158
    v_min3_f32 v194, v156, v157, v158
    s_nop 0
    v_max3_f32 v193, v159, v140, v141
    v_min3_f32 v195, v159, v140, v141
    v_max3_f32 v192, v192, v142, v143
    v_min3_f32 v194, v194, v142, v143
    v_max3_f32 v193, v193, v144, v145
    v_min3_f32 v195, v195, v144, v145
    v_max3_f32 v192, v192, v146, v147
    v_min3_f32 v194, v194, v146, v147
    v_max3_f32 v193, v193, v148, v149
    s_add_u32 m0, s95, 0
    s_add_u32 s68, s94, 102400
    buffer_load_dwordx4 v1, s[32:35], s68 offen sc1 lds
    v_min3_f32 v195, v195, v148, v149
    v_max3_f32 v192, v192, v150, v151
    v_min3_f32 v194, v194, v150, v151
    v_max3_f32 v193, v193, v152, v153
    v_min3_f32 v195, v195, v152, v153
    v_max3_f32 v192, v192, v154, v155
    v_min3_f32 v194, v194, v154, v155
    v_max_f32 v192, v192, v193
    v_min_f32 v194, v194, v195
    v_mul_f32 v192, s66, v192
    v_mul_f32 v194, s66, v194
    s_add_u32 m0, s95, 4096
    s_add_u32 s68, s94, 106496
    buffer_load_dwordx4 v1, s[32:35], s68 offen sc1 lds
    v_pk_fma_f32 v[172:173], v[140:141], s[66:67], v[192:193] op_sel_hi:[1,1,0] neg_lo:[0,0,1] neg_hi:[0,0,1]
    v_pk_fma_f32 v[140:141], v[140:141], s[66:67], v[194:195] op_sel_hi:[1,1,0] neg_lo:[1,0,0] neg_hi:[1,0,0]
    v_pk_fma_f32 v[174:175], v[142:143], s[66:67], v[192:193] op_sel_hi:[1,1,0] neg_lo:[0,0,1] neg_hi:[0,0,1]
    v_pk_fma_f32 v[142:143], v[142:143], s[66:67], v[194:195] op_sel_hi:[1,1,0] neg_lo:[1,0,0] neg_hi:[1,0,0]
    v_pk_fma_f32 v[176:177], v[144:145], s[66:67], v[192:193] op_sel_hi:[1,1,0] neg_lo:[0,0,1] neg_hi:[0,0,1]
    v_pk_fma_f32 v[144:145], v[144:145], s[66:67], v[194:195] op_sel_hi:[1,1,0] neg_lo:[1,0,0] neg_hi:[1,0,0]
    v_pk_fma_f32 v[178:179], v[146:147], s[66:67], v[192:193] op_sel_hi:[1,1,0] neg_lo:[0,0,1] neg_hi:[0,0,1]
    v_pk_fma_f32 v[146:147], v[146:147], s[66:67], v[194:195] op_sel_hi:[1,1,0] neg_lo:[1,0,0] neg_hi:[1,0,0]
    v_pk_fma_f32 v[180:181], v[148:149], s[66:67], v[192:193] op_sel_hi:[1,1,0] neg_lo:[0,0,1] neg_hi:[0,0,1]
    v_pk_fma_f32 v[148:149], v[148:149], s[66:67], v[194:195] op_sel_hi:[1,1,0] neg_lo:[1,0,0] neg_hi:[1,0,0]
    v_pk_fma_f32 v[182:183], v[150:151], s[66:67], v[192:193] op_sel_hi:[1,1,0] neg_lo:[0,0,1] neg_hi:[0,0,1]
    s_add_u32 m0, s95, 8192
    s_add_u32 s68, s94, 110592
    buffer_load_dwordx4 v1, s[32:35], s68 offen sc1 lds
    v_pk_fma_f32 v[150:151], v[150:151], s[66:67], v[194:195] op_sel_hi:[1,1,0] neg_lo:[1,0,0] neg_hi:[1,0,0]
    v_pk_fma_f32 v[184:185], v[152:153], s[66:67], v[192:193] op_sel_hi:[1,1,0] neg_lo:[0,0,1] neg_hi:[0,0,1]
    v_pk_fma_f32 v[152:153], v[152:153], s[66:67], v[194:195] op_sel_hi:[1,1,0] neg_lo:[1,0,0] neg_hi:[1,0,0]
    v_pk_fma_f32 v[186:187], v[154:155], s[66:67], v[192:193] op_sel_hi:[1,1,0] neg_lo:[0,0,1] neg_hi:[0,0,1]
    v_pk_fma_f32 v[154:155], v[154:155], s[66:67], v[194:195] op_sel_hi:[1,1,0] neg_lo:[1,0,0] neg_hi:[1,0,0]
    v_pk_fma_f32 v[188:189], v[156:157], s[66:67], v[192:193] op_sel_hi:[1,1,0] neg_lo:[0,0,1] neg_hi:[0,0,1]
    v_pk_fma_f32 v[156:157], v[156:157], s[66:67], v[194:195] op_sel_hi:[1,1,0] neg_lo:[1,0,0] neg_hi:[1,0,0]
    v_pk_fma_f32 v[190:191], v[158:159], s[66:67], v[192:193] op_sel_hi:[1,1,0] neg_lo:[0,0,1] neg_hi:[0,0,1]
    v_pk_fma_f32 v[158:159], v[158:159], s[66:67], v[194:195] op_sel_hi:[1,1,0] neg_lo:[1,0,0] neg_hi:[1,0,0]
    v_exp_f32 v172, v172
    v_exp_f32 v173, v173
    s_add_u32 m0, s95, 12288
    s_add_u32 s68, s94, 114688
    buffer_load_dwordx4 v1, s[32:35], s68 offen sc1 lds
    v_exp_f32 v174, v174
    v_exp_f32 v175, v175
    v_exp_f32 v176, v176
    v_exp_f32 v177, v177
    v_exp_f32 v178, v178
    v_exp_f32 v179, v179
    v_exp_f32 v180, v180
    v_exp_f32 v181, v181
    v_exp_f32 v182, v182
    v_exp_f32 v183, v183
    v_exp_f32 v184, v184
    s_add_u32 m0, s95, 16384
    s_add_u32 s68, s94, 118784
    buffer_load_dwordx4 v1, s[32:35], s68 offen sc1 lds
    v_exp_f32 v185, v185
    v_exp_f32 v186, v186
    v_exp_f32 v187, v187
    v_exp_f32 v188, v188
    v_exp_f32 v189, v189
    v_exp_f32 v190, v190
    v_exp_f32 v191, v191
    v_exp_f32 v140, v140
    v_exp_f32 v141, v141
    v_exp_f32 v142, v142
    v_exp_f32 v143, v143
    s_add_u32 m0, s95, 20480
    s_add_u32 s68, s94, 122880
    buffer_load_dwordx4 v1, s[32:35], s68 offen sc1 lds
    v_exp_f32 v144, v144
    v_exp_f32 v145, v145
    v_exp_f32 v146, v146
    v_exp_f32 v147, v147
    v_exp_f32 v148, v148
    v_exp_f32 v149, v149
    v_exp_f32 v150, v150
    v_exp_f32 v151, v151
    v_exp_f32 v152, v152
    v_exp_f32 v153, v153
    v_exp_f32 v154, v154
    s_add_u32 m0, s95, 24576
    s_add_u32 s68, s94, 126976
    buffer_load_dwordx4 v1, s[32:35], s68 offen sc1 lds
    v_exp_f32 v155, v155
    v_exp_f32 v156, v156
    v_exp_f32 v157, v157
    v_exp_f32 v158, v158
    v_exp_f32 v159, v159
    v_pk_add_f32 v[192:193], v[172:173], v[174:175]
    v_pk_add_f32 v[194:195], v[176:177], v[178:179]
    v_pk_add_f32 v[196:197], v[140:141], v[142:143]
    v_pk_add_f32 v[198:199], v[144:145], v[146:147]
    v_pk_add_f32 v[192:193], v[192:193], v[180:181]
    v_pk_add_f32 v[194:195], v[194:195], v[182:183]
    s_add_u32 m0, s95, 28672
    s_add_u32 s68, s94, 131072
    buffer_load_dwordx4 v1, s[32:35], s68 offen sc1 lds
    v_pk_add_f32 v[196:197], v[196:197], v[148:149]
    v_pk_add_f32 v[198:199], v[198:199], v[150:151]
    v_pk_add_f32 v[192:193], v[192:193], v[184:185]
    v_pk_add_f32 v[194:195], v[194:195], v[186:187]
    v_pk_add_f32 v[196:197], v[196:197], v[152:153]
    v_pk_add_f32 v[198:199], v[198:199], v[154:155]
    v_pk_add_f32 v[192:193], v[192:193], v[188:189]
    v_pk_add_f32 v[194:195], v[194:195], v[190:191]
    v_pk_add_f32 v[196:197], v[196:197], v[156:157]
    v_pk_add_f32 v[198:199], v[198:199], v[158:159]
    v_pk_add_f32 v[192:193], v[192:193], v[194:195]
    s_add_u32 m0, s95, 32768
    s_add_u32 s68, s94, 135168
    buffer_load_dwordx4 v1, s[32:35], s68 offen sc1 lds
    v_pk_add_f32 v[196:197], v[196:197], v[198:199]
    v_add_f32 v192, v192, v193
    v_add_f32 v196, v196, v197
    v_rcp_f32 v192, v192
    v_rcp_f32 v196, v196
    v_pk_mul_f32 v[172:173], v[172:173], v[192:193] op_sel_hi:[1,0]
    v_pk_mul_f32 v[174:175], v[174:175], v[192:193] op_sel_hi:[1,0]
    v_pk_mul_f32 v[176:177], v[176:177], v[192:193] op_sel_hi:[1,0]
    v_pk_mul_f32 v[178:179], v[178:179], v[192:193] op_sel_hi:[1,0]
    v_pk_mul_f32 v[180:181], v[180:181], v[192:193] op_sel_hi:[1,0]
    v_pk_mul_f32 v[182:183], v[182:183], v[192:193] op_sel_hi:[1,0]
    s_add_u32 m0, s95, 36864
    s_add_u32 s68, s94, 139264
    buffer_load_dwordx4 v1, s[32:35], s68 offen sc1 lds
    v_pk_mul_f32 v[184:185], v[184:185], v[192:193] op_sel_hi:[1,0]
    v_pk_mul_f32 v[186:187], v[186:187], v[192:193] op_sel_hi:[1,0]
    v_pk_mul_f32 v[188:189], v[188:189], v[192:193] op_sel_hi:[1,0]
    v_pk_mul_f32 v[190:191], v[190:191], v[192:193] op_sel_hi:[1,0]
    v_cvt_pk_bf16_f32 v224, v172, v173
    v_cvt_pk_bf16_f32 v225, v174, v175
    v_cvt_pk_bf16_f32 v226, v176, v177
    v_cvt_pk_bf16_f32 v227, v178, v179
    ds_write_b128 v19, v[224:227] offset:0
    v_cvt_pk_bf16_f32 v228, v180, v181
    v_cvt_pk_bf16_f32 v229, v182, v183
    v_cvt_pk_bf16_f32 v230, v184, v185
    s_add_u32 m0, s95, 40960
    s_add_u32 s68, s94, 143360
    buffer_load_dwordx4 v1, s[32:35], s68 offen sc1 lds
    v_cvt_pk_bf16_f32 v231, v186, v187
    ds_write_b128 v19, v[228:231] offset:16
    v_cvt_pk_bf16_f32 v232, v188, v189
    v_cvt_pk_bf16_f32 v233, v190, v191
    v_pk_mul_f32 v[140:141], v[140:141], v[196:197] op_sel_hi:[1,0]
    v_pk_mul_f32 v[142:143], v[142:143], v[196:197] op_sel_hi:[1,0]
    v_pk_mul_f32 v[144:145], v[144:145], v[196:197] op_sel_hi:[1,0]
    v_pk_mul_f32 v[146:147], v[146:147], v[196:197] op_sel_hi:[1,0]
    v_pk_mul_f32 v[148:149], v[148:149], v[196:197] op_sel_hi:[1,0]
    v_pk_mul_f32 v[150:151], v[150:151], v[196:197] op_sel_hi:[1,0]
    v_pk_mul_f32 v[152:153], v[152:153], v[196:197] op_sel_hi:[1,0]
    v_pk_mul_f32 v[154:155], v[154:155], v[196:197] op_sel_hi:[1,0]
    s_add_u32 m0, s95, 45056
    s_add_u32 s68, s94, 147456
    buffer_load_dwordx4 v1, s[32:35], s68 offen sc1 lds
    v_pk_mul_f32 v[156:157], v[156:157], v[196:197] op_sel_hi:[1,0]
    v_pk_mul_f32 v[158:159], v[158:159], v[196:197] op_sel_hi:[1,0]
    v_cvt_pk_bf16_f32 v234, v140, v141
    v_cvt_pk_bf16_f32 v235, v142, v143
    ds_write_b128 v19, v[232:235] offset:32
    v_cvt_pk_bf16_f32 v236, v144, v145
    v_cvt_pk_bf16_f32 v237, v146, v147
    v_cvt_pk_bf16_f32 v238, v148, v149
    v_cvt_pk_bf16_f32 v239, v150, v151
    ds_write_b128 v19, v[236:239] offset:48
    v_cvt_pk_bf16_f32 v240, v152, v153
    v_cvt_pk_bf16_f32 v241, v154, v155
    v_cvt_pk_bf16_f32 v242, v156, v157
    s_cmp_gt_u32 s56, 1
    s_cselect_b32 s69, 2048, 0
    s_sub_u32 s94, s94, s69
    s_sub_u32 s69, s95, s69
    s_add_u32 m0, s69, 49152
    s_add_u32 s68, s94, 151552
    buffer_load_dwordx4 v1, s[32:35], s68 offen sc1 lds
    v_cvt_pk_bf16_f32 v243, v158, v159
    ds_write_b128 v19, v[240:243] offset:64
    s_waitcnt lgkmcnt(0)
    s_barrier
    ds_read_b64_tr_b16 v[128:129], v21 offset:0
    ds_read_b64_tr_b16 v[130:131], v21 offset:1344
    ds_read_b64_tr_b16 v[132:133], v22 offset:0
    ds_read_b64_tr_b16 v[134:135], v22 offset:1344
    ds_read_b64_tr_b16 v[136:137], v21 offset:5376
    ds_read_b64_tr_b16 v[138:139], v21 offset:6720
    ds_read_b64_tr_b16 v[140:141], v22 offset:5376
    ds_read_b64_tr_b16 v[142:143], v22 offset:6720
    ds_read_b64_tr_b16 v[144:145], v21 offset:10752
    ds_read_b64_tr_b16 v[146:147], v21 offset:12096
    ds_read_b64_tr_b16 v[148:149], v22 offset:10752
    ds_read_b64_tr_b16 v[150:151], v22 offset:12096
    s_waitcnt lgkmcnt(8)
    v_mfma_f32_32x32x16_bf16 v[64:79], v[128:131], v[132:135], 0
    ds_read_b64_tr_b16 v[152:153], v21 offset:16128
    ds_read_b64_tr_b16 v[154:155], v21 offset:17472
    ds_read_b64_tr_b16 v[156:157], v22 offset:16128
    ds_read_b64_tr_b16 v[158:159], v22 offset:17472
    s_waitcnt lgkmcnt(8)
    v_mfma_f32_32x32x16_bf16 v[64:79], v[136:139], v[140:143], v[64:79]
    ds_read_b64_tr_b16 v[160:161], v21 offset:21504
    ds_read_b64_tr_b16 v[162:163], v21 offset:22848
    ds_read_b64_tr_b16 v[164:165], v22 offset:21504
    ds_read_b64_tr_b16 v[166:167], v22 offset:22848
    s_waitcnt lgkmcnt(8)
    v_mfma_f32_32x32x16_bf16 v[64:79], v[144:147], v[148:151], v[64:79]
    ds_read_b64_tr_b16 v[168:169], v21 offset:26880
    ds_read_b64_tr_b16 v[170:171], v21 offset:28224
    ds_read_b64_tr_b16 v[172:173], v22 offset:26880
    ds_read_b64_tr_b16 v[174:175], v22 offset:28224
    s_waitcnt lgkmcnt(8)
    v_mfma_f32_32x32x16_bf16 v[64:79], v[152:155], v[156:159], v[64:79]
    ds_read_b64_tr_b16 v[176:177], v21 offset:32256
    ds_read_b64_tr_b16 v[178:179], v21 offset:33600
    ds_read_b64_tr_b16 v[180:181], v22 offset:32256
    ds_read_b64_tr_b16 v[182:183], v22 offset:33600
    s_waitcnt lgkmcnt(8)
    v_mfma_f32_32x32x16_bf16 v[64:79], v[160:163], v[164:167], v[64:79]
    ds_read_b64_tr_b16 v[184:185], v21 offset:37632
    ds_read_b64_tr_b16 v[186:187], v21 offset:38976
    ds_read_b64_tr_b16 v[188:189], v22 offset:37632
    ds_read_b64_tr_b16 v[190:191], v22 offset:38976
    s_waitcnt lgkmcnt(8)
    v_mfma_f32_32x32x16_bf16 v[64:79], v[168:171], v[172:175], v[64:79]
    s_waitcnt lgkmcnt(4)
    v_mfma_f32_32x32x16_bf16 v[64:79], v[176:179], v[180:183], v[64:79]
    s_waitcnt lgkmcnt(0)
    v_mfma_f32_32x32x16_bf16 v[64:79], v[184:187], v[188:191], v[64:79]
    s_nop 11
    v_cvt_pk_bf16_f32 v52, v64, v65
    v_cvt_pk_bf16_f32 v53, v66, v67
    v_cvt_pk_bf16_f32 v54, v68, v69
    v_cvt_pk_bf16_f32 v55, v70, v71
    v_cvt_pk_bf16_f32 v56, v72, v73
    v_cvt_pk_bf16_f32 v57, v74, v75
    v_cvt_pk_bf16_f32 v58, v76, v77
    v_cvt_pk_bf16_f32 v59, v78, v79
    buffer_store_dwordx4 v[52:55], v23, s[32:35], s88 offen sc1
    buffer_store_dwordx4 v[56:59], v23, s[32:35], s89 offen sc1
    s_waitcnt vmcnt(2)
    s_barrier
    ds_read_b128 a[160:163], v16 offset:0
    ds_read_b128 a[164:167], v16 offset:1024
    ds_read_b128 a[168:171], v18 offset:2048
    ds_read_b128 a[172:175], v16 offset:2560
    ds_read_b128 a[176:179], v16 offset:3584
    ds_read_b128 a[180:183], v18 offset:4608
    s_waitcnt lgkmcnt(4)
    v_mfma_f32_16x16x32_bf16 v[104:107], a[160:163], a[0:3], 0
    ds_read_b128 a[184:187], v16 offset:5120
    v_mfma_f32_16x16x32_bf16 v[116:119], a[160:163], a[4:7], 0
    v_mfma_f32_16x16x32_bf16 v[108:111], a[164:167], a[0:3], 0
    ds_read_b128 a[188:191], v16 offset:6144
    v_mfma_f32_16x16x32_bf16 v[120:123], a[164:167], a[4:7], 0
    s_waitcnt lgkmcnt(4)
    v_mfma_f32_16x16x32_bf16 v[112:115], a[168:171], a[0:3], 0
    ds_read_b128 a[160:163], v18 offset:7168
    v_mfma_f32_16x16x32_bf16 v[124:127], a[168:171], a[4:7], 0
    v_mfma_f32_16x16x32_bf16 v[104:107], a[172:175], a[8:11], v[104:107]
    ds_read_b128 a[164:167], v16 offset:7680
    v_mfma_f32_16x16x32_bf16 v[116:119], a[172:175], a[12:15], v[116:119]
    s_waitcnt lgkmcnt(4)
    v_mfma_f32_16x16x32_bf16 v[108:111], a[176:179], a[8:11], v[108:111]
    ds_read_b128 a[168:171], v16 offset:8704
    v_mfma_f32_16x16x32_bf16 v[120:123], a[176:179], a[12:15], v[120:123]
    v_mfma_f32_16x16x32_bf16 v[112:115], a[180:183], a[8:11], v[112:115]
    ds_read_b128 a[172:175], v18 offset:9728
    v_mfma_f32_16x16x32_bf16 v[124:127], a[180:183], a[12:15], v[124:127]
    s_waitcnt lgkmcnt(4)
    v_mfma_f32_16x16x32_bf16 v[104:107], a[184:187], a[16:19], v[104:107]
    ds_read_b128 a[176:179], v16 offset:10240
    v_mfma_f32_16x16x32_bf16 v[116:119], a[184:187], a[20:23], v[116:119]
    v_mfma_f32_16x16x32_bf16 v[108:111], a[188:191], a[16:19], v[108:111]
    ds_read_b128 a[180:183], v16 offset:11264
    v_mfma_f32_16x16x32_bf16 v[120:123], a[188:191], a[20:23], v[120:123]
    s_waitcnt lgkmcnt(4)
    v_mfma_f32_16x16x32_bf16 v[112:115], a[160:163], a[16:19], v[112:115]
    ds_read_b128 a[184:187], v18 offset:12288
    v_mfma_f32_16x16x32_bf16 v[124:127], a[160:163], a[20:23], v[124:127]
    v_mfma_f32_16x16x32_bf16 v[104:107], a[164:167], a[24:27], v[104:107]
    ds_read_b128 a[188:191], v16 offset:12800
    v_mfma_f32_16x16x32_bf16 v[116:119], a[164:167], a[28:31], v[116:119]
    s_waitcnt lgkmcnt(4)
    v_mfma_f32_16x16x32_bf16 v[108:111], a[168:171], a[24:27], v[108:111]
    ds_read_b128 a[160:163], v16 offset:13824
    v_mfma_f32_16x16x32_bf16 v[120:123], a[168:171], a[28:31], v[120:123]
    v_mfma_f32_16x16x32_bf16 v[112:115], a[172:175], a[24:27], v[112:115]
    ds_read_b128 a[164:167], v18 offset:14848
    v_mfma_f32_16x16x32_bf16 v[124:127], a[172:175], a[28:31], v[124:127]
    s_waitcnt lgkmcnt(4)
    v_mfma_f32_16x16x32_bf16 v[104:107], a[176:179], a[32:35], v[104:107]
    ds_read_b128 a[168:171], v16 offset:15360
    v_mfma_f32_16x16x32_bf16 v[116:119], a[176:179], a[36:39], v[116:119]
    v_mfma_f32_16x16x32_bf16 v[108:111], a[180:183], a[32:35], v[108:111]
    ds_read_b128 a[172:175], v16 offset:16384
    v_mfma_f32_16x16x32_bf16 v[120:123], a[180:183], a[36:39], v[120:123]
    s_waitcnt lgkmcnt(4)
    v_mfma_f32_16x16x32_bf16 v[112:115], a[184:187], a[32:35], v[112:115]
    ds_read_b128 a[176:179], v18 offset:17408
    v_mfma_f32_16x16x32_bf16 v[124:127], a[184:187], a[36:39], v[124:127]
    v_mfma_f32_16x16x32_bf16 v[104:107], a[188:191], a[40:43], v[104:107]
    ds_read_b128 a[180:183], v16 offset:17920
    v_mfma_f32_16x16x32_bf16 v[116:119], a[188:191], a[44:47], v[116:119]
    s_waitcnt lgkmcnt(4)
    v_mfma_f32_16x16x32_bf16 v[108:111], a[160:163], a[40:43], v[108:111]
    ds_read_b128 a[184:187], v16 offset:18944
    v_mfma_f32_16x16x32_bf16 v[120:123], a[160:163], a[44:47], v[120:123]
    v_mfma_f32_16x16x32_bf16 v[112:115], a[164:167], a[40:43], v[112:115]
    ds_read_b128 a[188:191], v18 offset:19968
    v_mfma_f32_16x16x32_bf16 v[124:127], a[164:167], a[44:47], v[124:127]
    s_waitcnt lgkmcnt(4)
    v_mfma_f32_16x16x32_bf16 v[104:107], a[168:171], a[48:51], v[104:107]
    ds_read_b128 a[160:163], v16 offset:20480
    v_mfma_f32_16x16x32_bf16 v[116:119], a[168:171], a[52:55], v[116:119]
    v_mfma_f32_16x16x32_bf16 v[108:111], a[172:175], a[48:51], v[108:111]
    ds_read_b128 a[164:167], v16 offset:21504
    v_mfma_f32_16x16x32_bf16 v[120:123], a[172:175], a[52:55], v[120:123]
    s_waitcnt vmcnt(0)
    s_barrier
    s_mov_b64 exec, 1
    buffer_store_dwordx2 v[2:3], off, s[32:35], s90 sc1
    s_mov_b64 exec, -1
    s_waitcnt lgkmcnt(4)
    v_mfma_f32_16x16x32_bf16 v[112:115], a[176:179], a[48:51], v[112:115]
    ds_read_b128 a[168:171], v18 offset:22528
    v_mfma_f32_16x16x32_bf16 v[124:127], a[176:179], a[52:55], v[124:127]
    ds_read_b64_tr_b16 v[128:129], v34 offset:0
    v_mfma_f32_16x16x32_bf16 v[104:107], a[180:183], a[56:59], v[104:107]
    ds_read_b128 a[172:175], v16 offset:23040
    ds_read_b64_tr_b16 v[130:131], v34 offset:512
    v_mfma_f32_16x16x32_bf16 v[116:119], a[180:183], a[60:63], v[116:119]
    ds_read_b64_tr_b16 v[132:133], v34 offset:8
    s_waitcnt lgkmcnt(7)
    v_mfma_f32_16x16x32_bf16 v[108:111], a[184:187], a[56:59], v[108:111]
    ds_read_b128 a[176:179], v16 offset:24064
    ds_read_b64_tr_b16 v[134:135], v34 offset:520
    v_mfma_f32_16x16x32_bf16 v[120:123], a[184:187], a[60:63], v[120:123]
    ds_read_b64_tr_b16 v[136:137], v35 offset:0
    v_mfma_f32_16x16x32_bf16 v[112:115], a[188:191], a[56:59], v[112:115]
    ds_read_b128 a[180:183], v18 offset:25088
    ds_read_b64_tr_b16 v[138:139], v35 offset:512
    v_mfma_f32_16x16x32_bf16 v[124:127], a[188:191], a[60:63], v[124:127]
    ds_read_b64_tr_b16 v[140:141], v35 offset:8
    s_waitcnt lgkmcnt(11)
    v_mfma_f32_16x16x32_bf16 v[104:107], a[160:163], a[64:67], v[104:107]
    ds_read_b128 a[184:187], v16 offset:25600
    ds_read_b64_tr_b16 v[142:143], v35 offset:520
    v_mfma_f32_16x16x32_bf16 v[116:119], a[160:163], a[68:71], v[116:119]
    v_add_u32_dpp v144, v31, v8 quad_perm:[0,0,0,0] row_mask:0xf bank_mask:0xf
    v_mfma_f32_16x16x32_bf16 v[108:111], a[164:167], a[64:67], v[108:111]
    ds_read_b128 a[188:191], v16 offset:26624
    v_add_u32_dpp v145, v31, v8 quad_perm:[1,1,1,1] row_mask:0xf bank_mask:0xf
    v_mfma_f32_16x16x32_bf16 v[120:123], a[164:167], a[68:71], v[120:123]
    v_add_u32_dpp v146, v31, v8 quad_perm:[2,2,2,2] row_mask:0xf bank_mask:0xf
    s_waitcnt lgkmcnt(11)
    v_mfma_f32_16x16x32_bf16 v[112:115], a[168:171], a[64:67], v[112:115]
    ds_read_b128 a[160:163], v18 offset:27648
    v_add_u32_dpp v147, v31, v8 quad_perm:[3,3,3,3] row_mask:0xf bank_mask:0xf
    v_mfma_f32_16x16x32_bf16 v[124:127], a[168:171], a[68:71], v[124:127]
    s_waitcnt lgkmcnt(11)
    buffer_store_dwordx4 v[128:131], v144, s[32:35], 0 offen sc1
    v_mfma_f32_16x16x32_bf16 v[104:107], a[172:175], a[72:75], v[104:107]
    ds_read_b128 a[164:167], v16 offset:28160
    s_waitcnt lgkmcnt(9)
    buffer_store_dwordx4 v[132:135], v145, s[32:35], 0 offen sc1
    v_mfma_f32_16x16x32_bf16 v[116:119], a[172:175], a[76:79], v[116:119]
    s_waitcnt lgkmcnt(6)
    buffer_store_dwordx4 v[136:139], v146, s[32:35], 0 offen sc1
    v_mfma_f32_16x16x32_bf16 v[108:111], a[176:179], a[72:75], v[108:111]
    ds_read_b128 a[168:171], v16 offset:29184
    s_waitcnt lgkmcnt(4)
    buffer_store_dwordx4 v[140:143], v147, s[32:35], 0 offen sc1
    v_mfma_f32_16x16x32_bf16 v[120:123], a[176:179], a[76:79], v[120:123]
    v_mfma_f32_16x16x32_bf16 v[112:115], a[180:183], a[72:75], v[112:115]
    ds_read_b128 a[172:175], v18 offset:30208
    ds_read_b64_tr_b16 v[148:149], v34 offset:4096
    v_mfma_f32_16x16x32_bf16 v[124:127], a[180:183], a[76:79], v[124:127]
    ds_read_b64_tr_b16 v[150:151], v34 offset:4608
    s_waitcnt lgkmcnt(6)
    v_mfma_f32_16x16x32_bf16 v[104:107], a[184:187], a[80:83], v[104:107]
    ds_read_b128 a[176:179], v16 offset:30720
    ds_read_b64_tr_b16 v[152:153], v34 offset:4104
    v_mfma_f32_16x16x32_bf16 v[116:119], a[184:187], a[84:87], v[116:119]
    ds_read_b64_tr_b16 v[154:155], v34 offset:4616
    v_mfma_f32_16x16x32_bf16 v[108:111], a[188:191], a[80:83], v[108:111]
    ds_read_b128 a[180:183], v16 offset:31744
    ds_read_b64_tr_b16 v[156:157], v35 offset:4096
    v_mfma_f32_16x16x32_bf16 v[120:123], a[188:191], a[84:87], v[120:123]
    ds_read_b64_tr_b16 v[158:159], v35 offset:4608
    s_waitcnt lgkmcnt(10)
    v_mfma_f32_16x16x32_bf16 v[112:115], a[160:163], a[80:83], v[112:115]
    ds_read_b128 a[184:187], v18 offset:32768
    ds_read_b64_tr_b16 v[160:161], v35 offset:4104
    v_mfma_f32_16x16x32_bf16 v[124:127], a[160:163], a[84:87], v[124:127]
    ds_read_b64_tr_b16 v[162:163], v35 offset:4616
    v_mfma_f32_16x16x32_bf16 v[104:107], a[164:167], a[88:91], v[104:107]
    ds_read_b128 a[188:191], v16 offset:33280
    v_add_u32_dpp v164, v33, v8 quad_perm:[0,0,0,0] row_mask:0xf bank_mask:0xf
    v_mfma_f32_16x16x32_bf16 v[116:119], a[164:167], a[92:95], v[116:119]
    v_add_u32_dpp v165, v33, v8 quad_perm:[1,1,1,1] row_mask:0xf bank_mask:0xf
    s_waitcnt lgkmcnt(12)
    v_mfma_f32_16x16x32_bf16 v[108:111], a[168:171], a[88:91], v[108:111]
    ds_read_b128 a[160:163], v16 offset:34304
    v_add_u32_dpp v166, v33, v8 quad_perm:[2,2,2,2] row_mask:0xf bank_mask:0xf
    v_mfma_f32_16x16x32_bf16 v[120:123], a[168:171], a[92:95], v[120:123]
    v_add_u32_dpp v167, v33, v8 quad_perm:[3,3,3,3] row_mask:0xf bank_mask:0xf
    v_mfma_f32_16x16x32_bf16 v[112:115], a[172:175], a[88:91], v[112:115]
    ds_read_b128 a[164:167], v18 offset:35328
    s_waitcnt lgkmcnt(12)
    buffer_store_dwordx4 v[148:151], v164, s[32:35], 0 offen sc1
    v_mfma_f32_16x16x32_bf16 v[124:127], a[172:175], a[92:95], v[124:127]
    s_waitcnt lgkmcnt(9)
    buffer_store_dwordx4 v[152:155], v165, s[32:35], 0 offen sc1
    s_waitcnt lgkmcnt(8)
    v_mfma_f32_16x16x32_bf16 v[104:107], a[176:179], a[96:99], v[104:107]
    ds_read_b128 a[168:171], v16 offset:35840
    s_waitcnt lgkmcnt(7)
    buffer_store_dwordx4 v[156:159], v166, s[32:35], 0 offen sc1
    v_mfma_f32_16x16x32_bf16 v[116:119], a[176:179], a[100:103], v[116:119]
    s_waitcnt lgkmcnt(4)
    buffer_store_dwordx4 v[160:163], v167, s[32:35], 0 offen sc1
    v_mfma_f32_16x16x32_bf16 v[108:111], a[180:183], a[96:99], v[108:111]
    ds_read_b128 a[172:175], v16 offset:36864
    v_add_u32 v96, 135168, v245
    v_mfma_f32_16x16x32_bf16 v[120:123], a[180:183], a[100:103], v[120:123]
    ds_read_b128 v[72:75], v246 offset:0
    s_waitcnt lgkmcnt(5)
    v_mfma_f32_16x16x32_bf16 v[112:115], a[184:187], a[96:99], v[112:115]
    ds_read_b128 a[176:179], v18 offset:37888
    ds_read_b64_tr_b16 v[52:53], v96 offset:0
    v_mfma_f32_16x16x32_bf16 v[124:127], a[184:187], a[100:103], v[124:127]
    ds_read_b64_tr_b16 v[54:55], v96 offset:512
    v_mfma_f32_16x16x32_bf16 v[104:107], a[188:191], a[104:107], v[104:107]
    ds_read_b128 a[180:183], v16 offset:38400
    ds_read_b128 v[76:79], v246 offset:64
    v_mfma_f32_16x16x32_bf16 v[116:119], a[188:191], a[108:111], v[116:119]
    ds_read_b64_tr_b16 v[56:57], v96 offset:4096
    s_waitcnt lgkmcnt(9)
    v_mfma_f32_16x16x32_bf16 v[108:111], a[160:163], a[104:107], v[108:111]
    ds_read_b128 a[184:187], v16 offset:39424
    ds_read_b64_tr_b16 v[58:59], v96 offset:4608
    v_mfma_f32_16x16x32_bf16 v[120:123], a[160:163], a[108:111], v[120:123]
    ds_read_b128 v[80:83], v246 offset:128
    v_mfma_f32_16x16x32_bf16 v[112:115], a[164:167], a[104:107], v[112:115]
    ds_read_b128 a[188:191], v18 offset:40448
    ds_read_b64_tr_b16 v[60:61], v96 offset:8192
    v_mfma_f32_16x16x32_bf16 v[124:127], a[164:167], a[108:111], v[124:127]
    ds_read_b64_tr_b16 v[62:63], v96 offset:8704
    s_waitcnt lgkmcnt(13)
    v_mfma_f32_16x16x32_bf16 v[104:107], a[168:171], a[112:115], v[104:107]
    ds_read_b128 a[160:163], v16 offset:40960
    ds_read_b128 v[84:87], v246 offset:192
    v_mfma_f32_16x16x32_bf16 v[116:119], a[168:171], a[116:119], v[116:119]
    ds_read_b64_tr_b16 v[64:65], v96 offset:12288
    v_mfma_f32_16x16x32_bf16 v[108:111], a[172:175], a[112:115], v[108:111]
    ds_read_b128 a[164:167], v16 offset:41984
    ds_read_b64_tr_b16 v[66:67], v96 offset:12800
    v_mfma_f32_16x16x32_bf16 v[120:123], a[172:175], a[116:119], v[120:123]
    ds_read_b128 v[88:91], v246 offset:256
    s_waitcnt lgkmcnt(14)
    v_mfma_f32_16x16x32_bf16 v[112:115], a[176:179], a[112:115], v[112:115]
    ds_read_b128 a[168:171], v18 offset:43008
    ds_read_b64_tr_b16 v[68:69], v96 offset:16384
    v_mfma_f32_16x16x32_bf16 v[124:127], a[176:179], a[116:119], v[124:127]
    ds_read_b64_tr_b16 v[70:71], v96 offset:16896
    v_mfma_f32_16x16x32_bf16 v[104:107], a[180:183], a[120:123], v[104:107]
    ds_read_b128 a[172:175], v16 offset:43520
    v_mfma_f32_16x16x32_bf16 v[92:95], v[52:55], v[72:75], 0
    v_mfma_f32_16x16x32_bf16 v[116:119], a[180:183], a[124:127], v[116:119]
    s_waitcnt lgkmcnt(14)
    v_mfma_f32_16x16x32_bf16 v[92:95], v[56:59], v[76:79], v[92:95]
    s_waitcnt lgkmcnt(12)
    v_mfma_f32_16x16x32_bf16 v[108:111], a[184:187], a[120:123], v[108:111]
    ds_read_b128 a[176:179], v16 offset:44544
    s_waitcnt lgkmcnt(11)
    v_mfma_f32_16x16x32_bf16 v[92:95], v[60:63], v[80:83], v[92:95]
    v_mfma_f32_16x16x32_bf16 v[120:123], a[184:187], a[124:127], v[120:123]
    s_waitcnt lgkmcnt(6)
    v_mfma_f32_16x16x32_bf16 v[92:95], v[64:67], v[84:87], v[92:95]
    v_mfma_f32_16x16x32_bf16 v[112:115], a[188:191], a[120:123], v[112:115]
    ds_read_b128 a[180:183], v18 offset:45568
    s_waitcnt lgkmcnt(3)
    v_mfma_f32_16x16x32_bf16 v[92:95], v[68:71], v[88:91], v[92:95]
    v_mfma_f32_16x16x32_bf16 v[124:127], a[188:191], a[124:127], v[124:127]
    s_nop 6
    v_add_u32 v92, 0x80, v92
    v_add_u32 v93, 0x80, v93
    v_add_u32 v94, 0x80, v94
    v_add_u32 v95, 0x80, v95
    v_and_b32 v92, 0xffffff00, v92
    v_and_b32 v93, 0xffffff00, v93
    v_and_b32 v94, 0xffffff00, v94
    v_and_b32 v95, 0xffffff00, v95
    v_or_b32 v92, s26, v92
    v_or_b32 v93, s27, v93
    v_or_b32 v94, s28, v94
    v_or_b32 v95, s29, v95
    s_mov_b32 exec_lo, 0x00010001
    s_mov_b32 exec_hi, 0x00010001
    buffer_store_dwordx4 v[92:95], v0, s[32:35], s84 offen sc1
    s_mov_b64 exec, -1
    v_mfma_f32_16x16x32_bf16 v[104:107], a[160:163], a[128:131], v[104:107]
    ds_read_b128 a[184:187], v16 offset:46080
    v_mfma_f32_16x16x32_bf16 v[116:119], a[160:163], a[132:135], v[116:119]
    v_mfma_f32_16x16x32_bf16 v[108:111], a[164:167], a[128:131], v[108:111]
    ds_read_b128 a[188:191], v16 offset:47104
    v_mfma_f32_16x16x32_bf16 v[120:123], a[164:167], a[132:135], v[120:123]
    s_waitcnt lgkmcnt(4)
    v_mfma_f32_16x16x32_bf16 v[112:115], a[168:171], a[128:131], v[112:115]
    ds_read_b128 a[160:163], v18 offset:48128
    v_mfma_f32_16x16x32_bf16 v[124:127], a[168:171], a[132:135], v[124:127]
    s_lshl_b32 s82, s60, 11
    s_add_u32 s82, s82, 196608
    v_mfma_f32_16x16x32_bf16 v[104:107], a[172:175], a[136:139], v[104:107]
    ds_read_b128 a[164:167], v16 offset:48640
    v_mfma_f32_16x16x32_bf16 v[116:119], a[172:175], a[140:143], v[116:119]
    s_waitcnt lgkmcnt(4)
    v_mfma_f32_16x16x32_bf16 v[108:111], a[176:179], a[136:139], v[108:111]
    ds_read_b128 a[168:171], v16 offset:49664
    v_mfma_f32_16x16x32_bf16 v[120:123], a[176:179], a[140:143], v[120:123]
    v_mfma_f32_16x16x32_bf16 v[112:115], a[180:183], a[136:139], v[112:115]
    ds_read_b128 a[172:175], v18 offset:50688
    v_mfma_f32_16x16x32_bf16 v[124:127], a[180:183], a[140:143], v[124:127]
    s_waitcnt lgkmcnt(4)
    v_mfma_f32_16x16x32_bf16 v[104:107], a[184:187], a[144:147], v[104:107]
    v_mfma_f32_16x16x32_bf16 v[116:119], a[184:187], a[148:151], v[116:119]
    v_mfma_f32_16x16x32_bf16 v[108:111], a[188:191], a[144:147], v[108:111]
    v_mfma_f32_16x16x32_bf16 v[120:123], a[188:191], a[148:151], v[120:123]
    s_waitcnt lgkmcnt(2)
    v_mfma_f32_16x16x32_bf16 v[112:115], a[160:163], a[144:147], v[112:115]
    v_mfma_f32_16x16x32_bf16 v[124:127], a[160:163], a[148:151], v[124:127]
    v_mfma_f32_16x16x32_bf16 v[104:107], a[164:167], a[152:155], v[104:107]
    v_mfma_f32_16x16x32_bf16 v[116:119], a[164:167], a[156:159], v[116:119]
    s_waitcnt lgkmcnt(0)
    v_mfma_f32_16x16x32_bf16 v[108:111], a[168:171], a[152:155], v[108:111]
    v_mfma_f32_16x16x32_bf16 v[120:123], a[168:171], a[156:159], v[120:123]
    v_mfma_f32_16x16x32_bf16 v[112:115], a[172:175], a[152:155], v[112:115]
    v_mfma_f32_16x16x32_bf16 v[124:127], a[172:175], a[156:159], v[124:127]
    buffer_load_dwordx2 v[12:13], v38, s[32:35], s82 offen sc1
    s_nop 0
    v_cvt_pk_bf16_f32 v128, v104, v105
    v_cvt_pk_bf16_f32 v129, v106, v107
    v_cvt_pk_bf16_f32 v130, v116, v117
    v_cvt_pk_bf16_f32 v131, v118, v119
    v_cvt_pk_bf16_f32 v132, v108, v109
    v_cvt_pk_bf16_f32 v133, v110, v111
    v_cvt_pk_bf16_f32 v134, v120, v121
    v_cvt_pk_bf16_f32 v135, v122, v123
    v_cvt_pk_bf16_f32 v136, v112, v113
    v_cvt_pk_bf16_f32 v137, v114, v115
    v_cvt_pk_bf16_f32 v138, v124, v125
    v_cvt_pk_bf16_f32 v139, v126, v127
    v_mov_b32 v60, 0
    v_mov_b32 v61, 0
    v_mov_b32 v62, 0
    v_mov_b32 v63, 0
    v_min_u32 v9, 4, v0
    v_lshlrev_b32 v9, 4, v9
    v_add_u32 v9, 157440, v9
    ds_write_b128 v9, v[60:63]
    v_permlane16_swap_b32 v128, v130
    v_permlane16_swap_b32 v129, v131
    v_permlane16_swap_b32 v132, v134
    v_permlane16_swap_b32 v133, v135
    v_permlane16_swap_b32 v136, v138
    v_permlane16_swap_b32 v137, v139
    v_mfma_f32_32x32x16_bf16 v[156:171], v[212:215], v[128:131], 0
    v_mfma_f32_32x32x16_bf16 v[156:171], v[216:219], v[132:135], v[156:171]
    v_mfma_f32_32x32x16_bf16 v[156:171], v[220:223], v[136:139], v[156:171]
    v_mfma_f32_32x32x16_bf16 v[140:155], v[200:203], v[128:131], 0
    v_mfma_f32_32x32x16_bf16 v[140:155], v[204:207], v[132:135], v[140:155]
    v_mfma_f32_32x32x16_bf16 v[140:155], v[208:211], v[136:139], v[140:155]
    s_mul_i32 s81, s2, 1
    s_lshl_b32 s81, s81, 3
    s_add_u32 s81, s81, 16384
    s_cmp_eq_u32 s56, 0
    s_cselect_b32 s81, s81, s3
    s_mul_i32 s72, s60, 55296
    s_add_u32 s72, s72, 1179648
    s_lshl_b32 s68, s61, 2
    s_add_u32 s68, s68, s56
    s_mul_i32 s17, s68, 20480
    s_mul_i32 s68, s62, 160
    s_add_u32 s17, s17, s68
    s_mov_b32 s69, 1120
    v_add_u32 v9, 0, v0
    v_mul_u32_u24 v10, 0xcd, v9
    v_lshrrev_b32 v10, 11, v10
    v_lshlrev_b32 v9, 4, v9
    v_mad_u32_u24 v39, v10, s69, v9
    v_add_u32 v9, 64, v0
    v_mul_u32_u24 v10, 0xcd, v9
    v_lshrrev_b32 v10, 11, v10
    v_lshlrev_b32 v9, 4, v9
    v_mad_u32_u24 v40, v10, s69, v9
    v_add_u32 v9, 128, v0
    v_mul_u32_u24 v10, 0xcd, v9
    v_lshrrev_b32 v10, 11, v10
    v_lshlrev_b32 v9, 4, v9
    v_mad_u32_u24 v41, v10, s69, v9
    s_mul_i32 s85, s56, 2560
    s_add_u32 s85, s85, 143360
    s_mul_i32 s68, s56, 160
    s_mul_i32 s69, s62, 20
    s_add_u32 s68, s68, s69
    s_add_u32 s68, s68, 320
    v_min_u32 v19, 19, v0
    v_add_u32 v17, s68, v19
    v_lshrrev_b32 v18, 4, v17
    v_and_b32 v17, 15, v17
    v_lshlrev_b32 v17, 4, v17
    v_lshl_add_u32 v17, v18, 10, v17
    v_add_u32 v17, 851968, v17
    v_add_u32 v18, 16384, v1
    s_mul_i32 s68, s56, 320
    s_add_u32 s68, s68, 162304
    v_lshlrev_b32 v19, 4, v19
    v_add_u32 v19, s68, v19
    s_waitcnt vmcnt(0)
    v_cmp_ne_u64 vcc, s[30:31], v[12:13]
    s_cbranch_vccz L_polled_16
    s_mov_b32 s65, 200000
L_poll_15:
    buffer_load_dwordx2 v[12:13], v38, s[32:35], s82 offen sc1
    s_waitcnt vmcnt(0)
    v_cmp_ne_u64 vcc, s[30:31], v[12:13]
    s_cbranch_vccz L_polled_16
    s_sub_u32 s65, s65, 1
    s_cmp_lg_u32 s65, 0
    s_cbranch_scc1 L_poll_15
L_polled_16:
    s_barrier
    s_mov_b64 exec, 1
    buffer_store_dwordx2 v[2:3], off, s[32:35], s81 sc1
    s_mov_b64 exec, -1
    s_lshl_b32 s15, s56, 10
    s_mul_i32 s12, s62, 102400
    s_add_u32 s12, s12, 12582912
    s_mul_i32 s13, s64, 286720
    s_add_u32 s13, s13, 13631488
    s_mul_i32 s19, s62, 286720
    s_add_u32 s19, s19, 18350080
    s_mul_i32 s16, s56, 71680
    s_add_u32 s19, s19, s16
    s_add_u32 s14, s19, 35840
    v_max3_f32 v192, v156, v157, v158
    v_min3_f32 v194, v156, v157, v158
    v_max3_f32 v193, v159, v140, v141
    v_min3_f32 v195, v159, v140, v141
    v_max3_f32 v192, v192, v142, v143
    v_min3_f32 v194, v194, v142, v143
    buffer_load_dwordx4 v[64:67], v24, s[32:35], s72 offen sc1
    v_max3_f32 v193, v193, v144, v145
    v_min3_f32 v195, v195, v144, v145
    v_max3_f32 v192, v192, v146, v147
    v_min3_f32 v194, v194, v146, v147
    v_max3_f32 v193, v193, v148, v149
    v_min3_f32 v195, v195, v148, v149
    s_add_u32 s72, s72, 3456
    buffer_load_dwordx4 v[68:71], v24, s[32:35], s72 offen sc1
    v_max3_f32 v192, v192, v150, v151
    v_min3_f32 v194, v194, v150, v151
    v_max3_f32 v193, v193, v152, v153
    v_min3_f32 v195, v195, v152, v153
    v_max3_f32 v192, v192, v154, v155
    v_min3_f32 v194, v194, v154, v155
    s_add_u32 s72, s72, 3456
    buffer_load_dwordx4 v[72:75], v24, s[32:35], s72 offen sc1
    v_max_f32 v192, v192, v193
    v_min_f32 v194, v194, v195
    v_mul_f32 v192, s66, v192
    v_mul_f32 v194, s66, v194
    v_pk_fma_f32 v[172:173], v[140:141], s[66:67], v[192:193] op_sel_hi:[1,1,0] neg_lo:[0,0,1] neg_hi:[0,0,1]
    v_pk_fma_f32 v[140:141], v[140:141], s[66:67], v[194:195] op_sel_hi:[1,1,0] neg_lo:[1,0,0] neg_hi:[1,0,0]
    s_add_u32 s72, s72, 3456
    buffer_load_dwordx4 v[76:79], v24, s[32:35], s72 offen sc1
    v_pk_fma_f32 v[174:175], v[142:143], s[66:67], v[192:193] op_sel_hi:[1,1,0] neg_lo:[0,0,1] neg_hi:[0,0,1]
    v_pk_fma_f32 v[142:143], v[142:143], s[66:67], v[194:195] op_sel_hi:[1,1,0] neg_lo:[1,0,0] neg_hi:[1,0,0]
    v_pk_fma_f32 v[176:177], v[144:145], s[66:67], v[192:193] op_sel_hi:[1,1,0] neg_lo:[0,0,1] neg_hi:[0,0,1]
    v_pk_fma_f32 v[144:145], v[144:145], s[66:67], v[194:195] op_sel_hi:[1,1,0] neg_lo:[1,0,0] neg_hi:[1,0,0]
    v_pk_fma_f32 v[178:179], v[146:147], s[66:67], v[192:193] op_sel_hi:[1,1,0] neg_lo:[0,0,1] neg_hi:[0,0,1]
    v_pk_fma_f32 v[146:147], v[146:147], s[66:67], v[194:195] op_sel_hi:[1,1,0] neg_lo:[1,0,0] neg_hi:[1,0,0]
    s_add_u32 s72, s72, 3456
    buffer_load_dwordx4 v[80:83], v24, s[32:35], s72 offen sc1
    v_pk_fma_f32 v[180:181], v[148:149], s[66:67], v[192:193] op_sel_hi:[1,1,0] neg_lo:[0,0,1] neg_hi:[0,0,1]
    v_pk_fma_f32 v[148:149], v[148:149], s[66:67], v[194:195] op_sel_hi:[1,1,0] neg_lo:[1,0,0] neg_hi:[1,0,0]
    v_pk_fma_f32 v[182:183], v[150:151], s[66:67], v[192:193] op_sel_hi:[1,1,0] neg_lo:[0,0,1] neg_hi:[0,0,1]
    v_pk_fma_f32 v[150:151], v[150:151], s[66:67], v[194:195] op_sel_hi:[1,1,0] neg_lo:[1,0,0] neg_hi:[1,0,0]
    v_pk_fma_f32 v[184:185], v[152:153], s[66:67], v[192:193] op_sel_hi:[1,1,0] neg_lo:[0,0,1] neg_hi:[0,0,1]
    v_pk_fma_f32 v[152:153], v[152:153], s[66:67], v[194:195] op_sel_hi:[1,1,0] neg_lo:[1,0,0] neg_hi:[1,0,0]
    s_add_u32 s72, s72, 3456
    buffer_load_dwordx4 v[84:87], v24, s[32:35], s72 offen sc1
    v_pk_fma_f32 v[186:187], v[154:155], s[66:67], v[192:193] op_sel_hi:[1,1,0] neg_lo:[0,0,1] neg_hi:[0,0,1]
    v_pk_fma_f32 v[154:155], v[154:155], s[66:67], v[194:195] op_sel_hi:[1,1,0] neg_lo:[1,0,0] neg_hi:[1,0,0]
    v_pk_fma_f32 v[188:189], v[156:157], s[66:67], v[192:193] op_sel_hi:[1,1,0] neg_lo:[0,0,1] neg_hi:[0,0,1]
    v_pk_fma_f32 v[156:157], v[156:157], s[66:67], v[194:195] op_sel_hi:[1,1,0] neg_lo:[1,0,0] neg_hi:[1,0,0]
    v_pk_fma_f32 v[190:191], v[158:159], s[66:67], v[192:193] op_sel_hi:[1,1,0] neg_lo:[0,0,1] neg_hi:[0,0,1]
    v_pk_fma_f32 v[158:159], v[158:159], s[66:67], v[194:195] op_sel_hi:[1,1,0] neg_lo:[1,0,0] neg_hi:[1,0,0]
    s_add_u32 s72, s72, 3456
    buffer_load_dwordx4 v[88:91], v24, s[32:35], s72 offen sc1
    v_exp_f32 v172, v172
    v_exp_f32 v173, v173
    v_exp_f32 v174, v174
    v_exp_f32 v175, v175
    v_exp_f32 v176, v176
    v_exp_f32 v177, v177
    s_add_u32 s72, s72, 3456
    buffer_load_dwordx4 v[92:95], v24, s[32:35], s72 offen sc1
    v_exp_f32 v178, v178
    v_exp_f32 v179, v179
    v_exp_f32 v180, v180
    v_exp_f32 v181, v181
    v_exp_f32 v182, v182
    v_exp_f32 v183, v183
    s_add_u32 s72, s72, 3456
    buffer_load_dwordx4 v[96:99], v24, s[32:35], s72 offen sc1
    v_exp_f32 v184, v184
    v_exp_f32 v185, v185
    v_exp_f32 v186, v186
    v_exp_f32 v187, v187
    v_exp_f32 v188, v188
    v_exp_f32 v189, v189
    s_add_u32 s72, s72, 3456
    buffer_load_dwordx4 v[100:103], v24, s[32:35], s72 offen sc1
    v_exp_f32 v190, v190
    v_exp_f32 v191, v191
    v_exp_f32 v140, v140
    v_exp_f32 v141, v141
    v_exp_f32 v142, v142
    v_exp_f32 v143, v143
    s_add_u32 s72, s72, 3456
    buffer_load_dwordx4 v[104:107], v24, s[32:35], s72 offen sc1
    v_exp_f32 v144, v144
    v_exp_f32 v145, v145
    v_exp_f32 v146, v146
    v_exp_f32 v147, v147
    v_exp_f32 v148, v148
    v_exp_f32 v149, v149
    s_add_u32 s72, s72, 3456
    buffer_load_dwordx4 v[108:111], v24, s[32:35], s72 offen sc1
    v_exp_f32 v150, v150
    v_exp_f32 v151, v151
    v_exp_f32 v152, v152
    v_exp_f32 v153, v153
    v_exp_f32 v154, v154
    v_exp_f32 v155, v155
    s_add_u32 s72, s72, 3456
    buffer_load_dwordx4 v[112:115], v24, s[32:35], s72 offen sc1
    v_exp_f32 v156, v156
    v_exp_f32 v157, v157
    v_exp_f32 v158, v158
    v_exp_f32 v159, v159
    v_pk_add_f32 v[192:193], v[172:173], v[174:175]
    v_pk_add_f32 v[194:195], v[176:177], v[178:179]
    s_add_u32 s72, s72, 3456
    buffer_load_dwordx4 v[116:119], v24, s[32:35], s72 offen sc1
    v_pk_add_f32 v[196:197], v[140:141], v[142:143]
    v_pk_add_f32 v[198:199], v[144:145], v[146:147]
    v_pk_add_f32 v[192:193], v[192:193], v[180:181]
    v_pk_add_f32 v[194:195], v[194:195], v[182:183]
    v_pk_add_f32 v[196:197], v[196:197], v[148:149]
    v_pk_add_f32 v[198:199], v[198:199], v[150:151]
    s_add_u32 s72, s72, 3456
    buffer_load_dwordx4 v[120:123], v24, s[32:35], s72 offen sc1
    v_pk_add_f32 v[192:193], v[192:193], v[184:185]
    v_pk_add_f32 v[194:195], v[194:195], v[186:187]
    v_pk_add_f32 v[196:197], v[196:197], v[152:153]
    v_pk_add_f32 v[198:199], v[198:199], v[154:155]
    v_pk_add_f32 v[192:193], v[192:193], v[188:189]
    v_pk_add_f32 v[194:195], v[194:195], v[190:191]
    s_add_u32 s72, s72, 3456
    buffer_load_dwordx4 v[124:127], v24, s[32:35], s72 offen sc1
    v_pk_add_f32 v[196:197], v[196:197], v[156:157]
    v_pk_add_f32 v[198:199], v[198:199], v[158:159]
    v_pk_add_f32 v[192:193], v[192:193], v[194:195]
    v_pk_add_f32 v[196:197], v[196:197], v[198:199]
    v_add_f32 v192, v192, v193
    v_add_f32 v196, v196, v197
    s_add_u32 m0, s15, 0
    s_add_u32 s16, s12, 0
    v_add_u32 v253, s16, v1
    buffer_load_dwordx4 v253, s[32:35], m0 offen sc1 lds
    s_add_u32 m0, s15, 4096
    v_rcp_f32 v192, v192
    v_rcp_f32 v196, v196
    v_pk_mul_f32 v[172:173], v[172:173], v[192:193] op_sel_hi:[1,0]
    v_pk_mul_f32 v[174:175], v[174:175], v[192:193] op_sel_hi:[1,0]
    v_pk_mul_f32 v[176:177], v[176:177], v[192:193] op_sel_hi:[1,0]
    v_pk_mul_f32 v[178:179], v[178:179], v[192:193] op_sel_hi:[1,0]
    buffer_load_dwordx4 v253, s[32:35], m0 offen sc1 lds
    s_add_u32 m0, s15, 8192
    v_pk_mul_f32 v[180:181], v[180:181], v[192:193] op_sel_hi:[1,0]
    v_pk_mul_f32 v[182:183], v[182:183], v[192:193] op_sel_hi:[1,0]
    v_pk_mul_f32 v[184:185], v[184:185], v[192:193] op_sel_hi:[1,0]
    v_pk_mul_f32 v[186:187], v[186:187], v[192:193] op_sel_hi:[1,0]
    v_pk_mul_f32 v[188:189], v[188:189], v[192:193] op_sel_hi:[1,0]
    v_pk_mul_f32 v[190:191], v[190:191], v[192:193] op_sel_hi:[1,0]
    buffer_load_dwordx4 v253, s[32:35], m0 offen sc1 lds
    s_add_u32 m0, s15, 12288
    v_cvt_pk_bf16_f32 v224, v172, v173
    v_cvt_pk_bf16_f32 v225, v174, v175
    v_cvt_pk_bf16_f32 v226, v176, v177
    v_cvt_pk_bf16_f32 v227, v178, v179
    v_cvt_pk_bf16_f32 v228, v180, v181
    v_cvt_pk_bf16_f32 v229, v182, v183
    buffer_load_dwordx4 v253, s[32:35], m0 offen sc1 lds
    s_add_u32 m0, s15, 16384
    v_cvt_pk_bf16_f32 v230, v184, v185
    v_cvt_pk_bf16_f32 v231, v186, v187
    v_cvt_pk_bf16_f32 v232, v188, v189
    v_cvt_pk_bf16_f32 v233, v190, v191
    v_pk_mul_f32 v[140:141], v[140:141], v[196:197] op_sel_hi:[1,0]
    v_pk_mul_f32 v[142:143], v[142:143], v[196:197] op_sel_hi:[1,0]
    buffer_load_dwordx4 v253, s[32:35], m0 offen sc1 lds
    s_add_u32 m0, s15, 20480
    v_pk_mul_f32 v[144:145], v[144:145], v[196:197] op_sel_hi:[1,0]
    v_pk_mul_f32 v[146:147], v[146:147], v[196:197] op_sel_hi:[1,0]
    v_pk_mul_f32 v[148:149], v[148:149], v[196:197] op_sel_hi:[1,0]
    v_pk_mul_f32 v[150:151], v[150:151], v[196:197] op_sel_hi:[1,0]
    v_pk_mul_f32 v[152:153], v[152:153], v[196:197] op_sel_hi:[1,0]
    v_pk_mul_f32 v[154:155], v[154:155], v[196:197] op_sel_hi:[1,0]
    buffer_load_dwordx4 v253, s[32:35], m0 offen sc1 lds
    s_add_u32 m0, s15, 24576
    v_pk_mul_f32 v[156:157], v[156:157], v[196:197] op_sel_hi:[1,0]
    v_pk_mul_f32 v[158:159], v[158:159], v[196:197] op_sel_hi:[1,0]
    v_cvt_pk_bf16_f32 v234, v140, v141
    v_cvt_pk_bf16_f32 v235, v142, v143
    v_cvt_pk_bf16_f32 v236, v144, v145
    v_cvt_pk_bf16_f32 v237, v146, v147
    buffer_load_dwordx4 v253, s[32:35], m0 offen sc1 lds
    s_add_u32 m0, s15, 28672
    v_cvt_pk_bf16_f32 v238, v148, v149
    v_cvt_pk_bf16_f32 v239, v150, v151
    v_cvt_pk_bf16_f32 v240, v152, v153
    v_cvt_pk_bf16_f32 v241, v154, v155
    v_cvt_pk_bf16_f32 v242, v156, v157
    v_cvt_pk_bf16_f32 v243, v158, v159
    buffer_load_dwordx4 v253, s[32:35], m0 offen sc1 lds
    s_add_u32 m0, s15, 32768
    s_mov_b32 s70, 0x3f80
    s_mov_b32 s71, 0x3f800000
    v_mov_b32 v52, 0
    v_mov_b32 v53, 0
    v_mov_b32 v54, 0
    v_mov_b32 v55, 0
    v_mov_b32 v56, 0
    v_mov_b32 v57, 0
    v_mov_b32 v58, 0
    v_mov_b32 v59, 0
    s_waitcnt vmcnt(23)
    s_add_u32 m0, s85, 0
    s_nop 0
    buffer_load_dwordx4 v39, s[48:51], s17 offen lds
    v_dot2c_f32_bf16 v52, s70, v64
    v_dot2c_f32_bf16 v53, s71, v64
    v_dot2c_f32_bf16 v54, s70, v65
    v_dot2c_f32_bf16 v55, s71, v65
    v_dot2c_f32_bf16 v56, s70, v66
    v_dot2c_f32_bf16 v57, s71, v66
    v_dot2c_f32_bf16 v58, s70, v67
    v_dot2c_f32_bf16 v59, s71, v67
    s_waitcnt vmcnt(23)
    s_add_u32 m0, s85, 1024
    s_nop 0
    buffer_load_dwordx4 v40, s[48:51], s17 offen lds
    v_dot2c_f32_bf16 v52, s70, v68
    v_dot2c_f32_bf16 v53, s71, v68
    v_dot2c_f32_bf16 v54, s70, v69
    v_dot2c_f32_bf16 v55, s71, v69
    v_dot2c_f32_bf16 v56, s70, v70
    v_dot2c_f32_bf16 v57, s71, v70
    v_dot2c_f32_bf16 v58, s70, v71
    v_dot2c_f32_bf16 v59, s71, v71
    s_waitcnt vmcnt(23)
    s_add_u32 m0, s85, 2048
    s_mov_b32 exec_hi, 0
    buffer_load_dwordx4 v41, s[48:51], s17 offen lds
    s_mov_b64 exec, -1
    v_dot2c_f32_bf16 v52, s70, v72
    v_dot2c_f32_bf16 v53, s71, v72
    v_dot2c_f32_bf16 v54, s70, v73
    v_dot2c_f32_bf16 v55, s71, v73
    v_dot2c_f32_bf16 v56, s70, v74
    v_dot2c_f32_bf16 v57, s71, v74
    v_dot2c_f32_bf16 v58, s70, v75
    v_dot2c_f32_bf16 v59, s71, v75
    s_waitcnt vmcnt(23)
    buffer_load_dwordx4 v[168:171], v17, s[32:35], 0 offen offset:0 sc1
    v_dot2c_f32_bf16 v52, s70, v76
    v_dot2c_f32_bf16 v53, s71, v76
    v_dot2c_f32_bf16 v54, s70, v77
    v_dot2c_f32_bf16 v55, s71, v77
    v_dot2c_f32_bf16 v56, s70, v78
    v_dot2c_f32_bf16 v57, s71, v78
    v_dot2c_f32_bf16 v58, s70, v79
    v_dot2c_f32_bf16 v59, s71, v79
    s_waitcnt vmcnt(23)
    buffer_load_dwordx4 v[172:175], v17, s[32:35], 0 offen offset:256 sc1
    v_dot2c_f32_bf16 v52, s70, v80
    v_dot2c_f32_bf16 v53, s71, v80
    v_dot2c_f32_bf16 v54, s70, v81
    v_dot2c_f32_bf16 v55, s71, v81
    v_dot2c_f32_bf16 v56, s70, v82
    v_dot2c_f32_bf16 v57, s71, v82
    v_dot2c_f32_bf16 v58, s70, v83
    v_dot2c_f32_bf16 v59, s71, v83
    s_waitcnt vmcnt(23)
    buffer_load_dwordx4 v[176:179], v17, s[32:35], 0 offen offset:512 sc1
    v_dot2c_f32_bf16 v52, s70, v84
    v_dot2c_f32_bf16 v53, s71, v84
    v_dot2c_f32_bf16 v54, s70, v85
    v_dot2c_f32_bf16 v55, s71, v85
    v_dot2c_f32_bf16 v56, s70, v86
    v_dot2c_f32_bf16 v57, s71, v86
    v_dot2c_f32_bf16 v58, s70, v87
    v_dot2c_f32_bf16 v59, s71, v87
    s_waitcnt vmcnt(23)
    buffer_load_dwordx4 v[180:183], v17, s[32:35], 0 offen offset:768 sc1
    v_dot2c_f32_bf16 v52, s70, v88
    v_dot2c_f32_bf16 v53, s71, v88
    v_dot2c_f32_bf16 v54, s70, v89
    v_dot2c_f32_bf16 v55, s71, v89
    v_dot2c_f32_bf16 v56, s70, v90
    v_dot2c_f32_bf16 v57, s71, v90
    v_dot2c_f32_bf16 v58, s70, v91
    v_dot2c_f32_bf16 v59, s71, v91
    s_waitcnt vmcnt(23)
    buffer_load_dwordx4 v[184:187], v18, s[32:35], 0 offen sc1
    v_dot2c_f32_bf16 v52, s70, v92
    v_dot2c_f32_bf16 v53, s71, v92
    v_dot2c_f32_bf16 v54, s70, v93
    v_dot2c_f32_bf16 v55, s71, v93
    v_dot2c_f32_bf16 v56, s70, v94
    v_dot2c_f32_bf16 v57, s71, v94
    v_dot2c_f32_bf16 v58, s70, v95
    v_dot2c_f32_bf16 v59, s71, v95
    s_waitcnt vmcnt(23)
    buffer_load_dwordx4 v[188:191], v18, s[32:35], 0 offen offset:1024 sc1
    v_dot2c_f32_bf16 v52, s70, v96
    v_dot2c_f32_bf16 v53, s71, v96
    v_dot2c_f32_bf16 v54, s70, v97
    v_dot2c_f32_bf16 v55, s71, v97
    v_dot2c_f32_bf16 v56, s70, v98
    v_dot2c_f32_bf16 v57, s71, v98
    v_dot2c_f32_bf16 v58, s70, v99
    v_dot2c_f32_bf16 v59, s71, v99
    s_waitcnt vmcnt(23)
    s_add_u32 m0, s15, 32768
    s_nop 0
    buffer_load_dwordx4 v253, s[32:35], m0 offen sc1 lds
    s_add_u32 m0, s15, 36864
    v_dot2c_f32_bf16 v52, s70, v100
    v_dot2c_f32_bf16 v53, s71, v100
    v_dot2c_f32_bf16 v54, s70, v101
    v_dot2c_f32_bf16 v55, s71, v101
    v_dot2c_f32_bf16 v56, s70, v102
    v_dot2c_f32_bf16 v57, s71, v102
    v_dot2c_f32_bf16 v58, s70, v103
    v_dot2c_f32_bf16 v59, s71, v103
    s_waitcnt vmcnt(23)
    buffer_load_dwordx4 v253, s[32:35], m0 offen sc1 lds
    s_add_u32 m0, s15, 40960
    v_dot2c_f32_bf16 v52, s70, v104
    v_dot2c_f32_bf16 v53, s71, v104
    v_dot2c_f32_bf16 v54, s70, v105
    v_dot2c_f32_bf16 v55, s71, v105
    v_dot2c_f32_bf16 v56, s70, v106
    v_dot2c_f32_bf16 v57, s71, v106
    v_dot2c_f32_bf16 v58, s70, v107
    v_dot2c_f32_bf16 v59, s71, v107
    s_waitcnt vmcnt(23)
    buffer_load_dwordx4 v253, s[32:35], m0 offen sc1 lds
    s_add_u32 m0, s15, 45056
    v_dot2c_f32_bf16 v52, s70, v108
    v_dot2c_f32_bf16 v53, s71, v108
    v_dot2c_f32_bf16 v54, s70, v109
    v_dot2c_f32_bf16 v55, s71, v109
    v_dot2c_f32_bf16 v56, s70, v110
    v_dot2c_f32_bf16 v57, s71, v110
    v_dot2c_f32_bf16 v58, s70, v111
    v_dot2c_f32_bf16 v59, s71, v111
    s_waitcnt vmcnt(23)
    buffer_load_dwordx4 v253, s[32:35], m0 offen sc1 lds
    s_add_u32 m0, s15, 49152
    v_dot2c_f32_bf16 v52, s70, v112
    v_dot2c_f32_bf16 v53, s71, v112
    v_dot2c_f32_bf16 v54, s70, v113
    v_dot2c_f32_bf16 v55, s71, v113
    v_dot2c_f32_bf16 v56, s70, v114
    v_dot2c_f32_bf16 v57, s71, v114
    v_dot2c_f32_bf16 v58, s70, v115
    v_dot2c_f32_bf16 v59, s71, v115
    s_waitcnt vmcnt(23)
    buffer_load_dwordx4 v253, s[32:35], m0 offen sc1 lds
    s_add_u32 m0, s15, 53248
    v_dot2c_f32_bf16 v52, s70, v116
    v_dot2c_f32_bf16 v53, s71, v116
    v_dot2c_f32_bf16 v54, s70, v117
    v_dot2c_f32_bf16 v55, s71, v117
    v_dot2c_f32_bf16 v56, s70, v118
    v_dot2c_f32_bf16 v57, s71, v118
    v_dot2c_f32_bf16 v58, s70, v119
    v_dot2c_f32_bf16 v59, s71, v119
    s_waitcnt vmcnt(23)
    buffer_load_dwordx4 v253, s[32:35], m0 offen sc1 lds
    s_add_u32 m0, s15, 57344
    v_dot2c_f32_bf16 v52, s70, v120
    v_dot2c_f32_bf16 v53, s71, v120
    v_dot2c_f32_bf16 v54, s70, v121
    v_dot2c_f32_bf16 v55, s71, v121
    v_dot2c_f32_bf16 v56, s70, v122
    v_dot2c_f32_bf16 v57, s71, v122
    v_dot2c_f32_bf16 v58, s70, v123
    v_dot2c_f32_bf16 v59, s71, v123
    s_waitcnt vmcnt(23)
    buffer_load_dwordx4 v253, s[32:35], m0 offen sc1 lds
    s_add_u32 m0, s15, 61440
    v_dot2c_f32_bf16 v52, s70, v124
    v_dot2c_f32_bf16 v53, s71, v124
    v_dot2c_f32_bf16 v54, s70, v125
    v_dot2c_f32_bf16 v55, s71, v125
    v_dot2c_f32_bf16 v56, s70, v126
    v_dot2c_f32_bf16 v57, s71, v126
    v_dot2c_f32_bf16 v58, s70, v127
    v_dot2c_f32_bf16 v59, s71, v127
    v_cvt_pk_bf16_f32 v60, v52, v53
    v_cvt_pk_bf16_f32 v61, v54, v55
    v_cvt_pk_bf16_f32 v62, v56, v57
    v_cvt_pk_bf16_f32 v63, v58, v59
    ds_write_b128 v25, v[60:63]
    s_lshl_b32 s68, s59, 2
    s_add_u32 s68, s68, s56
    s_mul_i32 s75, s68, 40960
    s_mul_i32 s68, s60, 1280
    s_add_u32 s75, s75, s68
    s_add_u32 s75, s75, 7340032
    s_mul_i32 s90, s59, 16
    s_add_u32 s90, s90, s60
    s_lshl_b32 s90, s90, 7
    s_add_u32 s90, s90, 327680
    s_cmp_eq_u32 s56, 0
    s_cselect_b32 s90, s90, s21
    s_waitcnt lgkmcnt(0)
    s_barrier
    ds_read_b128 v[148:151], v27 offset:0
    ds_read_b128 v[152:155], v27 offset:16
    ds_read_b128 v[156:159], v27 offset:32
    ds_read_b128 v[160:163], v27 offset:48
    ds_read_b128 v[164:167], v27 offset:64
    ds_read_b128 v[128:131], v26 offset:0
    ds_read_b128 v[132:135], v26 offset:16
    ds_read_b128 v[136:139], v26 offset:32
    ds_read_b128 v[140:143], v26 offset:48
    ds_read_b128 v[144:147], v26 offset:64
    s_waitcnt lgkmcnt(9)
    v_mfma_f32_32x32x16_bf16 v[80:95], v[148:151], v[224:227], 0
    buffer_load_dwordx4 v253, s[32:35], m0 offen sc1 lds
    s_add_u32 m0, s15, 65536
    s_waitcnt lgkmcnt(8)
    v_mfma_f32_32x32x16_bf16 v[80:95], v[152:155], v[228:231], v[80:95]
    buffer_load_dwordx4 v253, s[32:35], m0 offen sc1 lds
    s_add_u32 m0, s15, 69632
    s_waitcnt lgkmcnt(7)
    v_mfma_f32_32x32x16_bf16 v[80:95], v[156:159], v[232:235], v[80:95]
    buffer_load_dwordx4 v253, s[32:35], m0 offen sc1 lds
    s_add_u32 m0, s15, 73728
    s_waitcnt lgkmcnt(6)
    v_mfma_f32_32x32x16_bf16 v[80:95], v[160:163], v[236:239], v[80:95]
    buffer_load_dwordx4 v253, s[32:35], m0 offen sc1 lds
    s_add_u32 m0, s15, 77824
    s_waitcnt lgkmcnt(5)
    v_mfma_f32_32x32x16_bf16 v[80:95], v[164:167], v[240:243], v[80:95]
    buffer_load_dwordx4 v253, s[32:35], m0 offen sc1 lds
    s_add_u32 m0, s15, 81920
    s_waitcnt lgkmcnt(4)
    v_mfma_f32_32x32x16_bf16 v[64:79], v[128:131], v[224:227], 0
    buffer_load_dwordx4 v253, s[32:35], m0 offen sc1 lds
    s_add_u32 m0, s15, 86016
    s_waitcnt lgkmcnt(3)
    v_mfma_f32_32x32x16_bf16 v[64:79], v[132:135], v[228:231], v[64:79]
    buffer_load_dwordx4 v253, s[32:35], m0 offen sc1 lds
    s_add_u32 m0, s15, 90112
    s_waitcnt lgkmcnt(2)
    v_mfma_f32_32x32x16_bf16 v[64:79], v[136:139], v[232:235], v[64:79]
    buffer_load_dwordx4 v253, s[32:35], m0 offen sc1 lds
    s_add_u32 m0, s15, 94208
    s_waitcnt lgkmcnt(1)
    v_mfma_f32_32x32x16_bf16 v[64:79], v[140:143], v[236:239], v[64:79]
    buffer_load_dwordx4 v253, s[32:35], m0 offen sc1 lds
    s_add_u32 m0, s15, 98304
    s_waitcnt lgkmcnt(0)
    v_mfma_f32_32x32x16_bf16 v[64:79], v[144:147], v[240:243], v[64:79]
    buffer_load_dwordx4 v253, s[32:35], m0 offen sc1 lds
    s_add_u32 m0, s15, 102400
    v_add_f32 v84, 0x358637bd, v84
    v_rcp_f32 v84, v84
    s_nop 0
    v_pk_mul_f32 v[80:81], v[80:81], v[84:85] op_sel_hi:[1,0]
    v_pk_mul_f32 v[82:83], v[82:83], v[84:85] op_sel_hi:[1,0]
    s_nop 4
    v_pk_mul_f32 v[64:65], v[64:65], v[84:85] op_sel_hi:[1,0]
    v_pk_mul_f32 v[66:67], v[66:67], v[84:85] op_sel_hi:[1,0]
    v_pk_mul_f32 v[68:69], v[68:69], v[84:85] op_sel_hi:[1,0]
    v_pk_mul_f32 v[70:71], v[70:71], v[84:85] op_sel_hi:[1,0]
    v_pk_mul_f32 v[72:73], v[72:73], v[84:85] op_sel_hi:[1,0]
    v_pk_mul_f32 v[74:75], v[74:75], v[84:85] op_sel_hi:[1,0]
    v_pk_mul_f32 v[76:77], v[76:77], v[84:85] op_sel_hi:[1,0]
    v_pk_mul_f32 v[78:79], v[78:79], v[84:85] op_sel_hi:[1,0]
    v_cvt_pk_bf16_f32 v136, v80, v81
    v_cvt_pk_bf16_f32 v137, v82, v83
    v_cvt_pk_bf16_f32 v128, v64, v65
    v_cvt_pk_bf16_f32 v129, v66, v67
    v_cvt_pk_bf16_f32 v130, v68, v69
    v_cvt_pk_bf16_f32 v131, v70, v71
    v_cvt_pk_bf16_f32 v132, v72, v73
    v_cvt_pk_bf16_f32 v133, v74, v75
    v_cvt_pk_bf16_f32 v134, v76, v77
    v_cvt_pk_bf16_f32 v135, v78, v79
    v_permlane32_swap_b32 v136, v138
    v_permlane32_swap_b32 v137, v139
    buffer_store_dwordx4 v[128:131], v36, s[32:35], s75 offen sc1
    buffer_store_dwordx4 v[132:135], v36, s[32:35], s75 offen offset:256 sc1
    s_mov_b32 exec_hi, 0
    buffer_store_dwordx4 v[136:139], v37, s[32:35], s75 offen offset:512 sc1
    s_mov_b64 exec, -1
    s_cmp_eq_u32 s56, 2
    s_cselect_b32 s76, 1.0, 0
    s_mov_b32 s77, s76
    v_and_b32 v14, 15, v0
    v_mul_u32_u24 v14, 0xa0, v14
    v_add_u32 v14, s85, v14
    v_lshrrev_b32 v12, 4, v0
    v_lshl_add_u32 v13, v12, 3, v14
    v_lshl_add_u32 v14, v12, 4, v14
    s_waitcnt vmcnt(20)
    v_xor_b32 v168, s26, v168
    v_xor_b32 v169, s27, v169
    v_xor_b32 v170, s28, v170
    v_xor_b32 v171, s29, v171
    v_or3_b32 v9, v168, v169, v168
    v_or3_b32 v9, v170, v171, v9
    v_xor_b32 v172, s26, v172
    v_xor_b32 v173, s27, v173
    v_xor_b32 v174, s28, v174
    v_xor_b32 v175, s29, v175
    v_or3_b32 v9, v172, v173, v9
    v_or3_b32 v9, v174, v175, v9
    v_xor_b32 v176, s26, v176
    v_xor_b32 v177, s27, v177
    v_xor_b32 v178, s28, v178
    v_xor_b32 v179, s29, v179
    v_or3_b32 v9, v176, v177, v9
    v_or3_b32 v9, v178, v179, v9
    v_xor_b32 v180, s26, v180
    v_xor_b32 v181, s27, v181
    v_xor_b32 v182, s28, v182
    v_xor_b32 v183, s29, v183
    v_or3_b32 v9, v180, v181, v9
    v_or3_b32 v9, v182, v183, v9
    v_and_b32 v9, 0xff, v9
    v_cmp_ne_u32 vcc, 0, v9
    v_cmp_ne_u64 s[96:97], s[30:31], v[184:185]
    s_nop 0
    s_or_b64 vcc, vcc, s[96:97]
    v_cmp_ne_u64 s[96:97], s[30:31], v[186:187]
    s_nop 0
    s_or_b64 vcc, vcc, s[96:97]
    v_cmp_ne_u64 s[96:97], s[30:31], v[188:189]
    s_nop 0
    s_or_b64 vcc, vcc, s[96:97]
    v_cmp_ne_u64 s[96:97], s[30:31], v[190:191]
    s_nop 0
    s_or_b64 vcc, vcc, s[96:97]
    s_cbranch_vccz L_polled_18
    s_mov_b32 s65, 200000
L_poll_17:
    buffer_load_dwordx4 v[168:171], v17, s[32:35], 0 offen offset:0 sc1
    buffer_load_dwordx4 v[172:175], v17, s[32:35], 0 offen offset:256 sc1
    buffer_load_dwordx4 v[176:179], v17, s[32:35], 0 offen offset:512 sc1
    buffer_load_dwordx4 v[180:183], v17, s[32:35], 0 offen offset:768 sc1
    buffer_load_dwordx4 v[184:187], v18, s[32:35], 0 offen sc1
    buffer_load_dwordx4 v[188:191], v18, s[32:35], 0 offen offset:1024 sc1
    s_waitcnt vmcnt(0)
    v_xor_b32 v168, s26, v168
    v_xor_b32 v169, s27, v169
    v_xor_b32 v170, s28, v170
    v_xor_b32 v171, s29, v171
    v_or3_b32 v9, v168, v169, v168
    v_or3_b32 v9, v170, v171, v9
    v_xor_b32 v172, s26, v172
    v_xor_b32 v173, s27, v173
    v_xor_b32 v174, s28, v174
    v_xor_b32 v175, s29, v175
    v_or3_b32 v9, v172, v173, v9
    v_or3_b32 v9, v174, v175, v9
    v_xor_b32 v176, s26, v176
    v_xor_b32 v177, s27, v177
    v_xor_b32 v178, s28, v178
    v_xor_b32 v179, s29, v179
    v_or3_b32 v9, v176, v177, v9
    v_or3_b32 v9, v178, v179, v9
    v_xor_b32 v180, s26, v180
    v_xor_b32 v181, s27, v181
    v_xor_b32 v182, s28, v182
    v_xor_b32 v183, s29, v183
    v_or3_b32 v9, v180, v181, v9
    v_or3_b32 v9, v182, v183, v9
    v_and_b32 v9, 0xff, v9
    v_cmp_ne_u32 vcc, 0, v9
    v_cmp_ne_u64 s[96:97], s[30:31], v[184:185]
    s_nop 0
    s_or_b64 vcc, vcc, s[96:97]
    v_cmp_ne_u64 s[96:97], s[30:31], v[186:187]
    s_nop 0
    s_or_b64 vcc, vcc, s[96:97]
    v_cmp_ne_u64 s[96:97], s[30:31], v[188:189]
    s_nop 0
    s_or_b64 vcc, vcc, s[96:97]
    v_cmp_ne_u64 s[96:97], s[30:31], v[190:191]
    s_nop 0
    s_or_b64 vcc, vcc, s[96:97]
    s_cbranch_vccz L_polled_18
    s_sub_u32 s65, s65, 1
    s_cmp_lg_u32 s65, 0
    s_cbranch_scc1 L_poll_17
L_polled_18:
    ds_read_b128 v[64:67], v14
    ds_read_b128 v[68:71], v14 offset:64
    ds_read_b64 v[72:73], v13 offset:128
    v_pk_add_f32 v[168:169], v[168:169], v[172:173]
    v_pk_add_f32 v[176:177], v[176:177], v[180:181]
    v_pk_add_f32 v[170:171], v[170:171], v[174:175]
    v_pk_add_f32 v[178:179], v[178:179], v[182:183]
    v_pk_add_f32 v[168:169], v[168:169], v[176:177]
    v_pk_add_f32 v[170:171], v[170:171], v[178:179]
    v_cvt_pk_bf16_f32 v172, v168, v169
    v_lshlrev_b32 v168, 16, v172
    v_and_b32 v169, 0xffff0000, v172
    v_cvt_pk_bf16_f32 v173, v170, v171
    v_lshlrev_b32 v170, 16, v173
    v_and_b32 v171, 0xffff0000, v173
    v_pk_add_f32 v[168:169], v[168:169], s[76:77]
    v_pk_add_f32 v[170:171], v[170:171], s[76:77]
    v_cvt_pk_bf16_f32 v172, v168, v169
    v_lshlrev_b32 v168, 16, v172
    v_and_b32 v169, 0xffff0000, v172
    v_cvt_pk_bf16_f32 v173, v170, v171
    v_lshlrev_b32 v170, 16, v173
    v_and_b32 v171, 0xffff0000, v173
    ds_write_b128 v19, v[168:171]
    v_mov_b32 v36, v16
    v_add_u32 v37, 0x10000, v36
    v_add_u32 v38, 0x20000, v36
    s_and_b32 s69, s56, 1
    s_mul_i32 s68, s69, 5120
    v_add_u32 v4, s68, v36
    v_add_u32 v5, s68, v37
    s_lshr_b32 s68, s61, 1
    s_lshl_b32 s18, s68, 11
    s_lshl_b32 s73, s69, 10
    s_add_u32 s82, s18, s73
    s_add_u32 s82, s82, 327680
    v_and_b32 v7, 7, v0
    v_lshlrev_b32 v7, 7, v7
    s_lshl_b32 s73, s61, 2
    s_add_u32 s73, s73, s56
    s_xor_b32 s74, s73, 1
    s_mul_i32 s75, s69, 10240
    s_add_u32 s75, s75, 7340032
    s_mul_i32 s4, s73, 20480
    s_add_u32 s4, s4, s75
    s_mul_i32 s5, s74, 20480
    s_add_u32 s5, s5, s75
    s_waitcnt lgkmcnt(0)
    s_waitcnt vmcnt(0)
    s_barrier
    s_mov_b64 exec, 1
    buffer_store_dwordx2 v[2:3], off, s[32:35], s90 sc1
    s_mov_b64 exec, -1
    s_add_u32 s16, s13, 4294864896
    v_add_u32 v253, s16, v1
    buffer_load_dwordx4 v253, s[32:35], m0 offen sc1 lds
    s_add_u32 m0, s15, 106496
    s_nop 0
    buffer_load_dwordx4 v253, s[32:35], m0 offen sc1 lds
    s_add_u32 m0, s15, 110592
    s_nop 0
    buffer_load_dwordx4 v253, s[32:35], m0 offen sc1 lds
    s_add_u32 m0, s15, 114688
    s_nop 0
    buffer_load_dwordx4 v253, s[32:35], m0 offen sc1 lds
    s_add_u32 m0, s15, 118784
    s_nop 0
    buffer_load_dwordx4 v253, s[32:35], m0 offen sc1 lds
    s_add_u32 m0, s15, 122880
    s_nop 0
    buffer_load_dwordx4 v253, s[32:35], m0 offen sc1 lds
    s_add_u32 m0, s15, 126976
    s_mul_i32 s68, s56, 5120
    s_add_u32 s68, s68, 143360
    v_add_u32 v42, s68, v1
    s_xor_b32 s68, s56, 1
    s_mul_i32 s68, s68, 5120
    s_add_u32 s68, s68, 143360
    v_add_u32 v43, s68, v1
    v_lshlrev_b32 v11, 4, v12
    v_add_u32 v11, 162304, v11
    v_lshlrev_b32 v10, 5, v12
    v_add_u32 v10, 162304, v10
    v_lshlrev_b32 v148, 16, v64
    v_and_b32 v149, 0xffff0000, v64
    v_lshlrev_b32 v150, 16, v65
    v_and_b32 v151, 0xffff0000, v65
    v_lshlrev_b32 v152, 16, v66
    v_and_b32 v153, 0xffff0000, v66
    v_lshlrev_b32 v154, 16, v67
    v_and_b32 v155, 0xffff0000, v67
    v_lshlrev_b32 v156, 16, v68
    v_and_b32 v157, 0xffff0000, v68
    v_lshlrev_b32 v158, 16, v69
    v_and_b32 v159, 0xffff0000, v69
    v_lshlrev_b32 v160, 16, v70
    v_and_b32 v161, 0xffff0000, v70
    v_lshlrev_b32 v162, 16, v71
    v_and_b32 v163, 0xffff0000, v71
    v_lshlrev_b32 v164, 16, v72
    v_and_b32 v165, 0xffff0000, v72
    v_lshlrev_b32 v166, 16, v73
    v_and_b32 v167, 0xffff0000, v73
    ds_read_b128 v[68:71], v10 offset:960
    ds_read_b128 v[72:75], v10 offset:976
    ds_read_b128 v[76:79], v10 offset:1088
    ds_read_b128 v[80:83], v10 offset:1104
    ds_read_b128 v[84:87], v11 offset:1216
    ds_read_b128 v[88:91], v10 offset:0
    ds_read_b128 v[92:95], v10 offset:16
    ds_read_b128 v[96:99], v10 offset:128
    ds_read_b128 v[100:103], v10 offset:144
    ds_read_b128 v[104:107], v11 offset:256
    ds_read_b128 v[108:111], v10 offset:320
    ds_read_b128 v[112:115], v10 offset:336
    ds_read_b128 v[116:119], v10 offset:448
    ds_read_b128 v[120:123], v10 offset:464
    ds_read_b128 v[124:127], v11 offset:576
    ds_read_b128 v[128:131], v10 offset:640
    ds_read_b128 v[132:135], v10 offset:656
    ds_read_b128 v[136:139], v10 offset:768
    ds_read_b128 v[140:143], v10 offset:784
    ds_read_b128 v[144:147], v11 offset:896
    s_waitcnt vmcnt(6)
    buffer_load_dwordx2 v[14:15], v7, s[32:35], s82 offen sc1
    buffer_load_dwordx4 v253, s[32:35], m0 offen sc1 lds
    s_add_u32 m0, s15, 131072
    s_nop 0
    buffer_load_dwordx4 v253, s[32:35], m0 offen sc1 lds
    s_add_u32 m0, s15, 135168
    s_nop 0
    buffer_load_dwordx4 v253, s[32:35], m0 offen sc1 lds
    s_add_u32 m0, s15, 139264
    s_nop 0
    buffer_load_dwordx4 v253, s[32:35], m0 offen sc1 lds
    s_add_u32 m0, s15, 143360
    buffer_load_dwordx4 a[192:195], v36, s[32:35], s19 offen offset:0 sc1
    buffer_load_dwordx4 a[196:199], v36, s[32:35], s19 offen offset:1024 sc1
    buffer_load_dwordx4 a[200:203], v36, s[32:35], s19 offen offset:2048 sc1
    buffer_load_dwordx4 a[204:207], v36, s[32:35], s19 offen offset:3072 sc1
    v_and_b32 v9, 1, v0
    v_lshlrev_b32 v9, 4, v9
    v_lshrrev_b32 v9, v9, v2
    v_and_b32 v168, 0xff, v9
    v_bfe_u32 v169, v9, 8, 8
    v_and_b32 v9, 15, v0
    v_lshlrev_b32 v170, 3, v9
    s_waitcnt lgkmcnt(15)
    v_cvt_pk_bf16_f32 v26, v68, v69
    v_cvt_pk_bf16_f32 v27, v70, v71
    v_cvt_pk_bf16_f32 v28, v72, v73
    v_cvt_pk_bf16_f32 v29, v74, v75
    v_cvt_pk_bf16_f32 v30, v76, v77
    v_cvt_pk_bf16_f32 v31, v78, v79
    v_cvt_pk_bf16_f32 v32, v80, v81
    v_cvt_pk_bf16_f32 v33, v82, v83
    v_cvt_pk_bf16_f32 v34, v84, v85
    v_cvt_pk_bf16_f32 v35, v86, v87
    s_waitcnt vmcnt(8)
    v_cmp_ne_u64 vcc, s[30:31], v[14:15]
    s_cbranch_vccz L_polled_20
    s_mov_b32 s65, 200000
L_poll_19:
    buffer_load_dwordx2 v[14:15], v7, s[32:35], s82 offen sc1
    s_waitcnt vmcnt(0)
    v_cmp_ne_u64 vcc, s[30:31], v[14:15]
    s_cbranch_vccz L_polled_20
    s_sub_u32 s65, s65, 1
    s_cmp_lg_u32 s65, 0
    s_cbranch_scc1 L_poll_19
L_polled_20:
    buffer_load_dwordx4 a[0:3], v1, s[32:35], s4 offen offset:0 sc1
    buffer_load_dwordx4 a[4:7], v1, s[32:35], s5 offen offset:0 sc1
    buffer_load_dwordx4 a[8:11], v1, s[32:35], s4 offen offset:1024 sc1
    buffer_load_dwordx4 a[12:15], v1, s[32:35], s5 offen offset:1024 sc1
    buffer_load_dwordx4 a[16:19], v1, s[32:35], s4 offen offset:2048 sc1
    buffer_load_dwordx4 a[20:23], v1, s[32:35], s5 offen offset:2048 sc1
    buffer_load_dwordx4 a[24:27], v1, s[32:35], s4 offen offset:3072 sc1
    buffer_load_dwordx4 a[28:31], v1, s[32:35], s5 offen offset:3072 sc1
    s_add_u32 s4, s4, 4096
    buffer_load_dwordx4 a[32:35], v1, s[32:35], s4 offen offset:0 sc1
    s_add_u32 s5, s5, 4096
    buffer_load_dwordx4 a[36:39], v1, s[32:35], s5 offen offset:0 sc1
    buffer_load_dwordx4 a[40:43], v1, s[32:35], s4 offen offset:1024 sc1
    buffer_load_dwordx4 a[44:47], v1, s[32:35], s5 offen offset:1024 sc1
    buffer_load_dwordx4 a[48:51], v1, s[32:35], s4 offen offset:2048 sc1
    buffer_load_dwordx4 a[52:55], v1, s[32:35], s5 offen offset:2048 sc1
    buffer_load_dwordx4 a[56:59], v1, s[32:35], s4 offen offset:3072 sc1
    buffer_load_dwordx4 a[60:63], v1, s[32:35], s5 offen offset:3072 sc1
    s_add_u32 s4, s4, 4096
    buffer_load_dwordx4 a[64:67], v1, s[32:35], s4 offen offset:0 sc1
    s_add_u32 s5, s5, 4096
    buffer_load_dwordx4 a[68:71], v1, s[32:35], s5 offen offset:0 sc1
    buffer_load_dwordx4 a[72:75], v1, s[32:35], s4 offen offset:1024 sc1
    buffer_load_dwordx4 a[76:79], v1, s[32:35], s5 offen offset:1024 sc1
    s_lshl_b32 s83, s2, 2
    s_add_u32 s83, s83, s56
    s_cmp_eq_u32 s83, 0
    s_cselect_b32 s83, 0, s3
    s_mov_b64 exec, 1
    buffer_store_dwordx2 v[2:3], off, s[32:35], s83 sc1
    s_mov_b64 exec, -1
    ds_read_b128 a[80:83], v4 offset:0
    ds_read_b128 a[84:87], v4 offset:1024
    ds_read_b128 a[88:91], v4 offset:2048
    ds_read_b128 a[92:95], v4 offset:3072
    ds_read_b128 a[96:99], v4 offset:4096
    s_waitcnt vmcnt(20) lgkmcnt(0)
    v_mfma_f32_16x16x32_bf16 v[48:51], a[80:83], a[0:3], 0
    ds_read_b128 a[100:103], v4 offset:10240
    v_mfma_f32_16x16x32_bf16 v[52:55], a[84:87], a[0:3], 0
    ds_read_b128 a[104:107], v4 offset:11264
    v_mfma_f32_16x16x32_bf16 v[56:59], a[88:91], a[0:3], 0
    ds_read_b128 a[108:111], v4 offset:12288
    v_mfma_f32_16x16x32_bf16 v[60:63], a[92:95], a[0:3], 0
    ds_read_b128 a[112:115], v4 offset:13312
    v_mfma_f32_16x16x32_bf16 v[64:67], a[96:99], a[0:3], 0
    ds_read_b128 a[116:119], v4 offset:14336
    s_waitcnt vmcnt(19)
    v_mfma_f32_16x16x32_bf16 v[68:71], a[80:83], a[4:7], 0
    v_mfma_f32_16x16x32_bf16 v[72:75], a[84:87], a[4:7], 0
    s_add_u32 s19, s19, 4096
    buffer_load_dwordx4 a[208:211], v36, s[32:35], s19 offen offset:0 sc1
    v_mfma_f32_16x16x32_bf16 v[76:79], a[88:91], a[4:7], 0
    v_mfma_f32_16x16x32_bf16 v[80:83], a[92:95], a[4:7], 0
    buffer_load_dwordx4 a[212:215], v36, s[32:35], s19 offen offset:1024 sc1
    v_mfma_f32_16x16x32_bf16 v[84:87], a[96:99], a[4:7], 0
    s_waitcnt vmcnt(20) lgkmcnt(0)
    v_mfma_f32_16x16x32_bf16 v[48:51], a[100:103], a[8:11], v[48:51]
    ds_read_b128 a[80:83], v4 offset:20480
    v_mfma_f32_16x16x32_bf16 v[52:55], a[104:107], a[8:11], v[52:55]
    ds_read_b128 a[84:87], v4 offset:21504
    v_mfma_f32_16x16x32_bf16 v[56:59], a[108:111], a[8:11], v[56:59]
    ds_read_b128 a[88:91], v4 offset:22528
    v_mfma_f32_16x16x32_bf16 v[60:63], a[112:115], a[8:11], v[60:63]
    ds_read_b128 a[92:95], v4 offset:23552
    v_mfma_f32_16x16x32_bf16 v[64:67], a[116:119], a[8:11], v[64:67]
    ds_read_b128 a[96:99], v4 offset:24576
    s_waitcnt vmcnt(19)
    v_mfma_f32_16x16x32_bf16 v[68:71], a[100:103], a[12:15], v[68:71]
    v_mfma_f32_16x16x32_bf16 v[72:75], a[104:107], a[12:15], v[72:75]
    buffer_load_dwordx4 a[216:219], v36, s[32:35], s19 offen offset:2048 sc1
    v_mfma_f32_16x16x32_bf16 v[76:79], a[108:111], a[12:15], v[76:79]
    v_mfma_f32_16x16x32_bf16 v[80:83], a[112:115], a[12:15], v[80:83]
    buffer_load_dwordx4 a[220:223], v36, s[32:35], s19 offen offset:3072 sc1
    v_mfma_f32_16x16x32_bf16 v[84:87], a[116:119], a[12:15], v[84:87]
    s_waitcnt vmcnt(20) lgkmcnt(0)
    v_mfma_f32_16x16x32_bf16 v[48:51], a[80:83], a[16:19], v[48:51]
    ds_read_b128 a[100:103], v4 offset:30720
    v_mfma_f32_16x16x32_bf16 v[52:55], a[84:87], a[16:19], v[52:55]
    ds_read_b128 a[104:107], v4 offset:31744
    v_mfma_f32_16x16x32_bf16 v[56:59], a[88:91], a[16:19], v[56:59]
    ds_read_b128 a[108:111], v4 offset:32768
    v_mfma_f32_16x16x32_bf16 v[60:63], a[92:95], a[16:19], v[60:63]
    ds_read_b128 a[112:115], v4 offset:33792
    v_mfma_f32_16x16x32_bf16 v[64:67], a[96:99], a[16:19], v[64:67]
    ds_read_b128 a[116:119], v4 offset:34816
    s_waitcnt vmcnt(19)
    v_mfma_f32_16x16x32_bf16 v[68:71], a[80:83], a[20:23], v[68:71]
    v_mfma_f32_16x16x32_bf16 v[72:75], a[84:87], a[20:23], v[72:75]
    s_add_u32 s19, s19, 4096
    buffer_load_dwordx4 a[224:227], v36, s[32:35], s19 offen offset:0 sc1
    v_mfma_f32_16x16x32_bf16 v[76:79], a[88:91], a[20:23], v[76:79]
    v_mfma_f32_16x16x32_bf16 v[80:83], a[92:95], a[20:23], v[80:83]
    buffer_load_dwordx4 a[228:231], v36, s[32:35], s19 offen offset:1024 sc1
    v_mfma_f32_16x16x32_bf16 v[84:87], a[96:99], a[20:23], v[84:87]
    s_waitcnt vmcnt(20) lgkmcnt(0)
    v_mfma_f32_16x16x32_bf16 v[48:51], a[100:103], a[24:27], v[48:51]
    ds_read_b128 a[80:83], v4 offset:40960
    v_mfma_f32_16x16x32_bf16 v[52:55], a[104:107], a[24:27], v[52:55]
    ds_read_b128 a[84:87], v4 offset:41984
    v_mfma_f32_16x16x32_bf16 v[56:59], a[108:111], a[24:27], v[56:59]
    ds_read_b128 a[88:91], v4 offset:43008
    v_mfma_f32_16x16x32_bf16 v[60:63], a[112:115], a[24:27], v[60:63]
    ds_read_b128 a[92:95], v4 offset:44032
    v_mfma_f32_16x16x32_bf16 v[64:67], a[116:119], a[24:27], v[64:67]
    ds_read_b128 a[96:99], v4 offset:45056
    s_waitcnt vmcnt(19)
    v_mfma_f32_16x16x32_bf16 v[68:71], a[100:103], a[28:31], v[68:71]
    v_mfma_f32_16x16x32_bf16 v[72:75], a[104:107], a[28:31], v[72:75]
    buffer_load_dwordx4 a[232:235], v36, s[32:35], s19 offen offset:2048 sc1
    v_mfma_f32_16x16x32_bf16 v[76:79], a[108:111], a[28:31], v[76:79]
    v_mfma_f32_16x16x32_bf16 v[80:83], a[112:115], a[28:31], v[80:83]
    buffer_load_dwordx4 a[236:239], v36, s[32:35], s19 offen offset:3072 sc1
    v_mfma_f32_16x16x32_bf16 v[84:87], a[116:119], a[28:31], v[84:87]
    s_waitcnt vmcnt(20) lgkmcnt(0)
    v_mfma_f32_16x16x32_bf16 v[48:51], a[80:83], a[32:35], v[48:51]
    ds_read_b128 a[100:103], v4 offset:51200
    v_mfma_f32_16x16x32_bf16 v[52:55], a[84:87], a[32:35], v[52:55]
    ds_read_b128 a[104:107], v4 offset:52224
    v_mfma_f32_16x16x32_bf16 v[56:59], a[88:91], a[32:35], v[56:59]
    ds_read_b128 a[108:111], v4 offset:53248
    v_mfma_f32_16x16x32_bf16 v[60:63], a[92:95], a[32:35], v[60:63]
    ds_read_b128 a[112:115], v4 offset:54272
    v_mfma_f32_16x16x32_bf16 v[64:67], a[96:99], a[32:35], v[64:67]
    ds_read_b128 a[116:119], v4 offset:55296
    s_waitcnt vmcnt(19)
    v_mfma_f32_16x16x32_bf16 v[68:71], a[80:83], a[36:39], v[68:71]
    v_mfma_f32_16x16x32_bf16 v[72:75], a[84:87], a[36:39], v[72:75]
    s_add_u32 s19, s19, 4096
    buffer_load_dwordx4 a[240:243], v36, s[32:35], s19 offen offset:0 sc1
    v_mfma_f32_16x16x32_bf16 v[76:79], a[88:91], a[36:39], v[76:79]
    v_mfma_f32_16x16x32_bf16 v[80:83], a[92:95], a[36:39], v[80:83]
    buffer_load_dwordx4 a[244:247], v36, s[32:35], s19 offen offset:1024 sc1
    v_mfma_f32_16x16x32_bf16 v[84:87], a[96:99], a[36:39], v[84:87]
    s_barrier
    s_waitcnt vmcnt(20) lgkmcnt(0)
    v_mfma_f32_16x16x32_bf16 v[48:51], a[100:103], a[40:43], v[48:51]
    ds_read_b128 a[80:83], v4 offset:61440
    v_mfma_f32_16x16x32_bf16 v[52:55], a[104:107], a[40:43], v[52:55]
    ds_read_b128 a[84:87], v4 offset:62464
    v_mfma_f32_16x16x32_bf16 v[56:59], a[108:111], a[40:43], v[56:59]
    ds_read_b128 a[88:91], v4 offset:63488
    v_mfma_f32_16x16x32_bf16 v[60:63], a[112:115], a[40:43], v[60:63]
    ds_read_b128 a[92:95], v4 offset:64512
    v_mfma_f32_16x16x32_bf16 v[64:67], a[116:119], a[40:43], v[64:67]
    ds_read_b128 a[96:99], v5 offset:0
    s_waitcnt vmcnt(19)
    v_mfma_f32_16x16x32_bf16 v[68:71], a[100:103], a[44:47], v[68:71]
    v_mfma_f32_16x16x32_bf16 v[72:75], a[104:107], a[44:47], v[72:75]
    buffer_load_dwordx4 a[248:251], v36, s[32:35], s19 offen offset:2048 sc1
    v_mfma_f32_16x16x32_bf16 v[76:79], a[108:111], a[44:47], v[76:79]
    v_mfma_f32_16x16x32_bf16 v[80:83], a[112:115], a[44:47], v[80:83]
    buffer_load_dwordx4 a[252:255], v36, s[32:35], s19 offen offset:3072 sc1
    v_mfma_f32_16x16x32_bf16 v[84:87], a[116:119], a[44:47], v[84:87]
    s_waitcnt vmcnt(20) lgkmcnt(0)
    v_mfma_f32_16x16x32_bf16 v[48:51], a[80:83], a[48:51], v[48:51]
    ds_read_b128 a[100:103], v5 offset:6144
    v_mfma_f32_16x16x32_bf16 v[52:55], a[84:87], a[48:51], v[52:55]
    ds_read_b128 a[104:107], v5 offset:7168
    v_mfma_f32_16x16x32_bf16 v[56:59], a[88:91], a[48:51], v[56:59]
    ds_read_b128 a[108:111], v5 offset:8192
    v_mfma_f32_16x16x32_bf16 v[60:63], a[92:95], a[48:51], v[60:63]
    ds_read_b128 a[112:115], v5 offset:9216
    v_mfma_f32_16x16x32_bf16 v[64:67], a[96:99], a[48:51], v[64:67]
    ds_read_b128 a[116:119], v5 offset:10240
    s_waitcnt vmcnt(19)
    v_mfma_f32_16x16x32_bf16 v[68:71], a[80:83], a[52:55], v[68:71]
    v_mfma_f32_16x16x32_bf16 v[72:75], a[84:87], a[52:55], v[72:75]
    s_add_u32 s19, s19, 4096
    buffer_load_dwordx4 v[176:179], v36, s[32:35], s19 offen offset:0 sc1
    v_mfma_f32_16x16x32_bf16 v[76:79], a[88:91], a[52:55], v[76:79]
    v_mfma_f32_16x16x32_bf16 v[80:83], a[92:95], a[52:55], v[80:83]
    buffer_load_dwordx4 v[180:183], v36, s[32:35], s19 offen offset:1024 sc1
    v_mfma_f32_16x16x32_bf16 v[84:87], a[96:99], a[52:55], v[84:87]
    s_waitcnt vmcnt(20) lgkmcnt(0)
    v_mfma_f32_16x16x32_bf16 v[48:51], a[100:103], a[56:59], v[48:51]
    ds_read_b128 a[80:83], v5 offset:16384
    v_mfma_f32_16x16x32_bf16 v[52:55], a[104:107], a[56:59], v[52:55]
    ds_read_b128 a[84:87], v5 offset:17408
    v_mfma_f32_16x16x32_bf16 v[56:59], a[108:111], a[56:59], v[56:59]
    ds_read_b128 a[88:91], v5 offset:18432
    v_mfma_f32_16x16x32_bf16 v[60:63], a[112:115], a[56:59], v[60:63]
    ds_read_b128 a[92:95], v5 offset:19456
    v_mfma_f32_16x16x32_bf16 v[64:67], a[116:119], a[56:59], v[64:67]
    ds_read_b128 a[96:99], v5 offset:20480
    s_waitcnt vmcnt(19)
    v_mfma_f32_16x16x32_bf16 v[68:71], a[100:103], a[60:63], v[68:71]
    v_mfma_f32_16x16x32_bf16 v[72:75], a[104:107], a[60:63], v[72:75]
    buffer_load_dwordx4 v[184:187], v36, s[32:35], s19 offen offset:2048 sc1
    v_mfma_f32_16x16x32_bf16 v[76:79], a[108:111], a[60:63], v[76:79]
    v_mfma_f32_16x16x32_bf16 v[80:83], a[112:115], a[60:63], v[80:83]
    buffer_load_dwordx4 v[188:191], v36, s[32:35], s19 offen offset:3072 sc1
    v_mfma_f32_16x16x32_bf16 v[84:87], a[116:119], a[60:63], v[84:87]
    s_waitcnt vmcnt(20) lgkmcnt(0)
    v_mfma_f32_16x16x32_bf16 v[48:51], a[80:83], a[64:67], v[48:51]
    ds_read_b128 a[100:103], v5 offset:26624
    v_mfma_f32_16x16x32_bf16 v[52:55], a[84:87], a[64:67], v[52:55]
    ds_read_b128 a[104:107], v5 offset:27648
    v_mfma_f32_16x16x32_bf16 v[56:59], a[88:91], a[64:67], v[56:59]
    ds_read_b128 a[108:111], v5 offset:28672
    v_mfma_f32_16x16x32_bf16 v[60:63], a[92:95], a[64:67], v[60:63]
    ds_read_b128 a[112:115], v5 offset:29696
    v_mfma_f32_16x16x32_bf16 v[64:67], a[96:99], a[64:67], v[64:67]
    ds_read_b128 a[116:119], v5 offset:30720
    s_waitcnt vmcnt(19)
    v_mfma_f32_16x16x32_bf16 v[68:71], a[80:83], a[68:71], v[68:71]
    v_mfma_f32_16x16x32_bf16 v[72:75], a[84:87], a[68:71], v[72:75]
    s_add_u32 s19, s19, 4096
    buffer_load_dwordx4 v[192:195], v36, s[32:35], s19 offen offset:0 sc1
    v_mfma_f32_16x16x32_bf16 v[76:79], a[88:91], a[68:71], v[76:79]
    v_mfma_f32_16x16x32_bf16 v[80:83], a[92:95], a[68:71], v[80:83]
    buffer_load_dwordx4 v[196:199], v36, s[32:35], s19 offen offset:1024 sc1
    v_mfma_f32_16x16x32_bf16 v[84:87], a[96:99], a[68:71], v[84:87]
    s_waitcnt vmcnt(19) lgkmcnt(0)
    v_mfma_f32_16x16x32_bf16 v[68:71], a[100:103], a[76:79], v[68:71]
    v_mfma_f32_16x16x32_bf16 v[72:75], a[104:107], a[76:79], v[72:75]
    v_mfma_f32_16x16x32_bf16 v[76:79], a[108:111], a[76:79], v[76:79]
    v_mfma_f32_16x16x32_bf16 v[80:83], a[112:115], a[76:79], v[80:83]
    v_mfma_f32_16x16x32_bf16 v[84:87], a[116:119], a[76:79], v[84:87]
    v_mfma_f32_16x16x32_bf16 v[48:51], a[100:103], a[72:75], v[48:51]
    v_mfma_f32_16x16x32_bf16 v[52:55], a[104:107], a[72:75], v[52:55]
    buffer_load_dwordx4 v[200:203], v36, s[32:35], s19 offen offset:2048 sc1
    v_mfma_f32_16x16x32_bf16 v[56:59], a[108:111], a[72:75], v[56:59]
    v_mfma_f32_16x16x32_bf16 v[60:63], a[112:115], a[72:75], v[60:63]
    buffer_load_dwordx4 v[204:207], v36, s[32:35], s19 offen offset:3072 sc1
    v_mfma_f32_16x16x32_bf16 v[64:67], a[116:119], a[72:75], v[64:67]
    ds_write_b128 v42, v[68:71] offset:0
    ds_write_b128 v42, v[72:75] offset:1024
    ds_write_b128 v42, v[76:79] offset:2048
    ds_write_b128 v42, v[80:83] offset:3072
    ds_write_b128 v42, v[84:87] offset:4096
    s_waitcnt lgkmcnt(0)
    s_barrier
    ds_read_b128 v[68:71], v43 offset:0
    ds_read_b128 v[72:75], v43 offset:1024
    ds_read_b128 v[76:79], v43 offset:2048
    ds_read_b128 v[80:83], v43 offset:3072
    ds_read_b128 v[84:87], v43 offset:4096
    s_waitcnt lgkmcnt(4)
    v_pk_add_f32 v[48:49], v[48:49], v[68:69]
    v_pk_add_f32 v[50:51], v[50:51], v[70:71]
    s_waitcnt lgkmcnt(3)
    v_pk_add_f32 v[52:53], v[52:53], v[72:73]
    v_pk_add_f32 v[54:55], v[54:55], v[74:75]
    s_waitcnt lgkmcnt(2)
    v_pk_add_f32 v[56:57], v[56:57], v[76:77]
    v_pk_add_f32 v[58:59], v[58:59], v[78:79]
    s_waitcnt lgkmcnt(1)
    v_pk_add_f32 v[60:61], v[60:61], v[80:81]
    v_pk_add_f32 v[62:63], v[62:63], v[82:83]
    s_waitcnt lgkmcnt(0)
    v_pk_add_f32 v[64:65], v[64:65], v[84:85]
    v_pk_add_f32 v[66:67], v[66:67], v[86:87]
    v_pk_fma_f32 v[148:149], v[48:49], v[88:89], v[148:149]
    v_pk_fma_f32 v[150:151], v[50:51], v[90:91], v[150:151]
    v_pk_fma_f32 v[152:153], v[52:53], v[92:93], v[152:153]
    v_pk_fma_f32 v[154:155], v[54:55], v[94:95], v[154:155]
    v_pk_fma_f32 v[156:157], v[56:57], v[96:97], v[156:157]
    v_pk_fma_f32 v[158:159], v[58:59], v[98:99], v[158:159]
    v_pk_fma_f32 v[160:161], v[60:61], v[100:101], v[160:161]
    v_pk_fma_f32 v[162:163], v[62:63], v[102:103], v[162:163]
    v_pk_fma_f32 v[164:165], v[64:65], v[104:105], v[164:165]
    v_pk_fma_f32 v[166:167], v[66:67], v[106:107], v[166:167]
    v_cvt_pk_bf16_f32 v16, v148, v149
    v_cvt_pk_bf16_f32 v17, v150, v151
    v_cvt_pk_bf16_f32 v18, v152, v153
    v_cvt_pk_bf16_f32 v19, v154, v155
    v_cvt_pk_bf16_f32 v20, v156, v157
    v_cvt_pk_bf16_f32 v21, v158, v159
    v_cvt_pk_bf16_f32 v22, v160, v161
    v_cvt_pk_bf16_f32 v23, v162, v163
    v_cvt_pk_bf16_f32 v24, v164, v165
    v_cvt_pk_bf16_f32 v25, v166, v167
    s_mov_b32 s70, 0x3f803f80
    v_mov_b32 v48, 0
    v_mov_b32 v49, 0
    v_mov_b32 v52, 0
    v_mov_b32 v53, 0
    v_dot2c_f32_bf16 v48, s70, v16
    v_dot2c_f32_bf16 v49, v16, v16
    v_dot2c_f32_bf16 v52, s70, v17
    v_dot2c_f32_bf16 v53, v17, v17
    v_dot2c_f32_bf16 v48, s70, v18
    v_dot2c_f32_bf16 v49, v18, v18
    v_dot2c_f32_bf16 v52, s70, v19
    v_dot2c_f32_bf16 v53, v19, v19
    v_dot2c_f32_bf16 v48, s70, v20
    v_dot2c_f32_bf16 v49, v20, v20
    v_dot2c_f32_bf16 v52, s70, v21
    v_dot2c_f32_bf16 v53, v21, v21
    v_dot2c_f32_bf16 v48, s70, v22
    v_dot2c_f32_bf16 v49, v22, v22
    v_dot2c_f32_bf16 v52, s70, v23
    v_dot2c_f32_bf16 v53, v23, v23
    v_dot2c_f32_bf16 v48, s70, v24
    v_dot2c_f32_bf16 v49, v24, v24
    v_dot2c_f32_bf16 v52, s70, v25
    v_dot2c_f32_bf16 v53, v25, v25
    s_lshl_b32 s68, s61, 12
    s_lshl_b32 s69, s56, 7
    s_add_u32 s68, s68, s69
    s_add_u32 s82, s68, 917504
    s_lshl_b32 s69, s62, 9
    s_add_u32 s69, s69, s82
    v_pk_add_f32 v[48:49], v[48:49], v[52:53]
    v_mov_b32 v50, v48
    v_mov_b32 v51, v49
    s_nop 0
    v_permlane16_swap_b32 v48, v50
    v_permlane16_swap_b32 v49, v51
    v_add_f32 v48, v48, v50
    v_add_f32 v49, v49, v51
    v_mov_b32 v50, v48
    v_mov_b32 v51, v49
    s_nop 0
    v_permlane32_swap_b32 v48, v50
    v_permlane32_swap_b32 v49, v51
    v_add_f32 v48, v48, v50
    v_add_f32 v49, v49, v51
    v_add_u32 v48, 0x80, v48
    v_add_u32 v49, 0x80, v49
    v_and_b32 v48, 0xffffff00, v48
    v_and_b32 v49, 0xffffff00, v49
    v_or_b32 v48, v48, v168
    v_or_b32 v49, v49, v169
    s_mov_b64 exec, 0xffff
    buffer_store_dwordx2 v[48:49], v170, s[32:35], s69 offen sc1
    s_mov_b64 exec, -1
    s_add_u32 s19, s19, 4096
    buffer_load_dwordx4 v[208:211], v36, s[32:35], s19 offen offset:0 sc1
    buffer_load_dwordx4 v[212:215], v36, s[32:35], s19 offen offset:1024 sc1
    buffer_load_dwordx4 v[216:219], v36, s[32:35], s19 offen offset:2048 sc1
    buffer_load_dwordx4 v[220:223], v36, s[32:35], s19 offen offset:3072 sc1
    s_add_u32 s19, s19, 4096
    buffer_load_dwordx4 v[224:227], v36, s[32:35], s19 offen offset:0 sc1
    buffer_load_dwordx4 v[228:231], v36, s[32:35], s19 offen offset:1024 sc1
    buffer_load_dwordx4 v[232:235], v36, s[32:35], s19 offen offset:2048 sc1
    buffer_load_dwordx4 v[236:239], v36, s[32:35], s19 offen offset:3072 sc1
    s_add_u32 s19, s19, 4096
    buffer_load_dwordx4 v[240:243], v36, s[32:35], s19 offen offset:0 sc1
    buffer_load_dwordx4 v[244:247], v36, s[32:35], s19 offen offset:1024 sc1
    v_lshlrev_b32 v148, 16, v16
    v_and_b32 v149, 0xffff0000, v16
    v_lshlrev_b32 v150, 16, v17
    v_and_b32 v151, 0xffff0000, v17
    v_lshlrev_b32 v152, 16, v18
    v_and_b32 v153, 0xffff0000, v18
    v_lshlrev_b32 v154, 16, v19
    v_and_b32 v155, 0xffff0000, v19
    v_lshlrev_b32 v156, 16, v20
    v_and_b32 v157, 0xffff0000, v20
    v_lshlrev_b32 v158, 16, v21
    v_and_b32 v159, 0xffff0000, v21
    v_lshlrev_b32 v160, 16, v22
    v_and_b32 v161, 0xffff0000, v22
    v_lshlrev_b32 v162, 16, v23
    v_and_b32 v163, 0xffff0000, v23
    v_lshlrev_b32 v164, 16, v24
    v_and_b32 v165, 0xffff0000, v24
    v_lshlrev_b32 v166, 16, v25
    v_and_b32 v167, 0xffff0000, v25
    v_lshrrev_b32 v9, 4, v0
    v_and_b32 v10, 0xf0, v1
    v_lshl_add_u32 v11, v9, 10, v170
    v_lshrrev_b32 v9, 1, v9
    v_lshl_add_u32 v13, v9, 8, v10
    s_lshl_b32 s70, s61, 2
    s_add_u32 s70, s70, s56
    s_mul_i32 s70, s70, 20480
    s_mul_i32 s71, s62, 2560
    s_add_u32 s70, s70, s71
    s_add_u32 s70, s70, 9961472
    s_mul_i32 s74, s61, 8
    s_add_u32 s74, s74, s62
    s_lshl_b32 s74, s74, 7
    s_add_u32 s74, s74, 458752
    s_cmp_eq_u32 s56, 0
    s_cselect_b32 s74, s74, s21
    s_waitcnt vmcnt(10)
    buffer_load_dwordx2 v[52:53], v11, s[32:35], s82 offen sc1
    buffer_load_dwordx2 v[56:57], v11, s[32:35], s82 offen offset:512 sc1
    buffer_load_dwordx4 v[248:251], v36, s[32:35], s19 offen offset:2048 sc1
    v_pk_mul_f32 v[148:149], v[148:149], v[128:129]
    v_pk_mul_f32 v[150:151], v[150:151], v[130:131]
    v_pk_mul_f32 v[152:153], v[152:153], v[132:133]
    v_pk_mul_f32 v[154:155], v[154:155], v[134:135]
    v_pk_mul_f32 v[156:157], v[156:157], v[136:137]
    v_pk_mul_f32 v[158:159], v[158:159], v[138:139]
    v_pk_mul_f32 v[160:161], v[160:161], v[140:141]
    v_pk_mul_f32 v[162:163], v[162:163], v[142:143]
    v_pk_mul_f32 v[164:165], v[164:165], v[144:145]
    v_pk_mul_f32 v[166:167], v[166:167], v[146:147]
    s_waitcnt vmcnt(1)
    v_xor_b32 v52, v52, v168
    v_xor_b32 v53, v53, v169
    v_or3_b32 v9, v52, v53, v52
    v_xor_b32 v56, v56, v168
    v_xor_b32 v57, v57, v169
    v_or3_b32 v9, v56, v57, v9
    v_and_b32 v9, 0xff, v9
    v_cmp_ne_u32 vcc, 0, v9
    s_cbranch_vccz L_polled_22
    s_mov_b32 s65, 200000
L_poll_21:
    buffer_load_dwordx2 v[52:53], v11, s[32:35], s82 offen sc1
    buffer_load_dwordx2 v[56:57], v11, s[32:35], s82 offen offset:512 sc1
    s_waitcnt vmcnt(0)
    v_xor_b32 v52, v52, v168
    v_xor_b32 v53, v53, v169
    v_or3_b32 v9, v52, v53, v52
    v_xor_b32 v56, v56, v168
    v_xor_b32 v57, v57, v169
    v_or3_b32 v9, v56, v57, v9
    v_and_b32 v9, 0xff, v9
    v_cmp_ne_u32 vcc, 0, v9
    s_cbranch_vccz L_polled_22
    s_sub_u32 s65, s65, 1
    s_cmp_lg_u32 s65, 0
    s_cbranch_scc1 L_poll_21
L_polled_22:
    v_pk_add_f32 v[48:49], v[52:53], v[56:57]
    v_mov_b32 v50, v48
    v_mov_b32 v51, v49
    s_nop 0
    v_permlane16_swap_b32 v48, v50
    v_permlane16_swap_b32 v49, v51
    v_add_f32 v48, v48, v50
    v_add_f32 v49, v49, v51
    v_mov_b32 v50, v48
    v_mov_b32 v51, v49
    s_nop 0
    v_permlane32_swap_b32 v48, v50
    v_permlane32_swap_b32 v49, v51
    v_add_f32 v48, v48, v50
    v_add_f32 v49, v49, v51
    v_mul_f32 v48, 0x3acccccd, v48
    v_mul_f32 v50, 0x3acccccd, v49
    v_fma_f32 v50, -v48, v48, v50
    v_max_f32 v50, 0, v50
    v_add_f32 v50, 0x3727c5ac, v50
    v_rsq_f32 v50, v50
    s_nop 0
    v_mul_f32 v48, v48, v50
    v_pk_fma_f32 v[124:125], v[144:145], v[48:49], v[124:125] op_sel_hi:[1,0,1] neg_lo:[0,1,0] neg_hi:[0,1,0]
    v_pk_fma_f32 v[126:127], v[146:147], v[48:49], v[126:127] op_sel_hi:[1,0,1] neg_lo:[0,1,0] neg_hi:[0,1,0]
    v_pk_fma_f32 v[108:109], v[128:129], v[48:49], v[108:109] op_sel_hi:[1,0,1] neg_lo:[0,1,0] neg_hi:[0,1,0]
    v_pk_fma_f32 v[110:111], v[130:131], v[48:49], v[110:111] op_sel_hi:[1,0,1] neg_lo:[0,1,0] neg_hi:[0,1,0]
    v_pk_fma_f32 v[112:113], v[132:133], v[48:49], v[112:113] op_sel_hi:[1,0,1] neg_lo:[0,1,0] neg_hi:[0,1,0]
    v_pk_fma_f32 v[114:115], v[134:135], v[48:49], v[114:115] op_sel_hi:[1,0,1] neg_lo:[0,1,0] neg_hi:[0,1,0]
    v_pk_fma_f32 v[116:117], v[136:137], v[48:49], v[116:117] op_sel_hi:[1,0,1] neg_lo:[0,1,0] neg_hi:[0,1,0]
    v_pk_fma_f32 v[118:119], v[138:139], v[48:49], v[118:119] op_sel_hi:[1,0,1] neg_lo:[0,1,0] neg_hi:[0,1,0]
    v_pk_fma_f32 v[120:121], v[140:141], v[48:49], v[120:121] op_sel_hi:[1,0,1] neg_lo:[0,1,0] neg_hi:[0,1,0]
    v_pk_fma_f32 v[122:123], v[142:143], v[48:49], v[122:123] op_sel_hi:[1,0,1] neg_lo:[0,1,0] neg_hi:[0,1,0]
    v_pk_fma_f32 v[164:165], v[164:165], v[50:51], v[124:125] op_sel_hi:[1,0,1]
    v_pk_fma_f32 v[166:167], v[166:167], v[50:51], v[126:127] op_sel_hi:[1,0,1]
    v_pk_fma_f32 v[148:149], v[148:149], v[50:51], v[108:109] op_sel_hi:[1,0,1]
    v_pk_fma_f32 v[150:151], v[150:151], v[50:51], v[110:111] op_sel_hi:[1,0,1]
    v_pk_fma_f32 v[152:153], v[152:153], v[50:51], v[112:113] op_sel_hi:[1,0,1]
    v_pk_fma_f32 v[154:155], v[154:155], v[50:51], v[114:115] op_sel_hi:[1,0,1]
    v_pk_fma_f32 v[156:157], v[156:157], v[50:51], v[116:117] op_sel_hi:[1,0,1]
    v_pk_fma_f32 v[158:159], v[158:159], v[50:51], v[118:119] op_sel_hi:[1,0,1]
    v_pk_fma_f32 v[160:161], v[160:161], v[50:51], v[120:121] op_sel_hi:[1,0,1]
    v_pk_fma_f32 v[162:163], v[162:163], v[50:51], v[122:123] op_sel_hi:[1,0,1]
    v_cvt_pk_bf16_f32 v60, v164, v165
    v_cvt_pk_bf16_f32 v61, v166, v167
    v_cvt_pk_bf16_f32 v52, v148, v149
    v_cvt_pk_bf16_f32 v53, v150, v151
    v_cvt_pk_bf16_f32 v54, v152, v153
    v_cvt_pk_bf16_f32 v55, v154, v155
    v_cvt_pk_bf16_f32 v56, v156, v157
    v_cvt_pk_bf16_f32 v57, v158, v159
    v_cvt_pk_bf16_f32 v58, v160, v161
    v_cvt_pk_bf16_f32 v59, v162, v163
    v_permlane16_swap_b32 v60, v62
    v_permlane16_swap_b32 v61, v63
    buffer_store_dwordx4 v[52:55], v1, s[32:35], s70 offen sc1
    buffer_store_dwordx4 v[56:59], v1, s[32:35], s70 offen offset:1024 sc1
    s_mov_b32 exec_lo, 0xffff
    s_mov_b32 exec_hi, 0xffff
    buffer_store_dwordx4 v[60:63], v13, s[32:35], s70 offen offset:2048 sc1
    s_mov_b64 exec, -1
    s_waitcnt vmcnt(0)
    s_barrier
    s_mov_b64 exec, 1
    buffer_store_dwordx2 v[2:3], off, s[32:35], s74 sc1
    s_mov_b64 exec, -1
    s_lshl_b32 s68, s63, 2
    s_add_u32 s68, s68, s56
    s_lshr_b32 s69, s68, 1
    s_lshl_b32 s69, s69, 10
    s_add_u32 s82, s69, 458752
    buffer_load_dwordx4 v253, s[32:35], m0 offen sc1 lds
    s_add_u32 m0, s15, 147456
    s_nop 0
    buffer_load_dwordx4 v253, s[32:35], m0 offen sc1 lds
    s_add_u32 m0, s15, 151552
    s_nop 0
    buffer_load_dwordx4 v253, s[32:35], m0 offen sc1 lds
    s_add_u32 m0, s15, 155648
    s_nop 0
    buffer_load_dwordx4 v253, s[32:35], m0 offen sc1 lds
    s_add_u32 m0, s15, 159744
    s_nop 0
    buffer_load_dwordx4 v253, s[32:35], m0 offen sc1 lds
    s_add_u32 m0, s15, 0
    s_add_u32 s16, s13, 61440
    v_add_u32 v253, s16, v1
    buffer_load_dwordx4 v253, s[32:35], m0 offen sc1 lds
    s_add_u32 m0, s15, 4096
    s_nop 0
    buffer_load_dwordx4 v253, s[32:35], m0 offen sc1 lds
    s_add_u32 m0, s15, 8192
    s_nop 0
    buffer_load_dwordx4 v253, s[32:35], m0 offen sc1 lds
    s_add_u32 m0, s15, 12288
    s_nop 0
    buffer_load_dwordx4 v253, s[32:35], m0 offen sc1 lds
    s_add_u32 m0, s15, 16384
    s_nop 0
    buffer_load_dwordx4 v253, s[32:35], m0 offen sc1 lds
    s_add_u32 m0, s15, 20480
    s_mul_i32 s76, s68, 40960
    s_add_u32 s76, s76, 9961472
    s_add_u32 s77, s76, 20480
    s_mul_i32 s78, s68, 114688
    s_add_u32 s78, s78, 20971520
    s_lshr_b32 s68, s64, 2
    s_mul_i32 s68, s68, 14336
    s_add_u32 s78, s78, s68
    s_bfe_u32 s68, s64, 0x10001
    s_mul_i32 s68, s68, 11
    s_and_b32 s69, s64, 1
    s_mul_i32 s70, s69, 6
    s_add_u32 s68, s68, s70
    s_add_u32 s68, s68, 32
    s_lshl_b32 s68, s68, 8
    s_add_u32 s79, s78, s68
    s_and_b32 s68, s64, 3
    s_lshl_b32 s68, s68, 11
    s_add_u32 s78, s78, s68
    s_waitcnt vmcnt(10)
    buffer_load_dwordx2 v[14:15], v7, s[32:35], s82 offen sc1
    buffer_load_dwordx4 v253, s[32:35], m0 offen sc1 lds
    s_add_u32 m0, s15, 24576
    s_nop 0
    buffer_load_dwordx4 v253, s[32:35], m0 offen sc1 lds
    s_add_u32 m0, s15, 28672
    s_nop 0
    buffer_load_dwordx4 v253, s[32:35], m0 offen sc1 lds
    s_add_u32 m0, s15, 32768
    s_nop 0
    buffer_load_dwordx4 v253, s[32:35], m0 offen sc1 lds
    s_add_u32 m0, s15, 36864
    s_nop 0
    buffer_load_dwordx4 v253, s[32:35], m0 offen sc1 lds
    s_add_u32 m0, s15, 40960
    s_nop 0
    buffer_load_dwordx4 v253, s[32:35], m0 offen sc1 lds
    s_add_u32 m0, s15, 45056
    s_nop 0
    buffer_load_dwordx4 v253, s[32:35], m0 offen sc1 lds
    s_add_u32 m0, s15, 49152
    s_nop 0
    buffer_load_dwordx4 v253, s[32:35], m0 offen sc1 lds
    s_add_u32 m0, s15, 53248
    s_nop 0
    buffer_load_dwordx4 v253, s[32:35], m0 offen sc1 lds
    s_add_u32 m0, s15, 57344
    s_nop 0
    buffer_load_dwordx4 v253, s[32:35], m0 offen sc1 lds
    s_add_u32 m0, s15, 61440
    v_add_u32 v44, 57344, v1
    v_bfe_u32 v9, v0, 4, 1
    v_mul_u32_u24 v9, 57344, v9
    v_and_b32 v11, 0xf0, v1
    v_add_u32 v9, v9, v11
    v_lshrrev_b32 v11, 5, v0
    v_lshl_add_u32 v9, v11, 8, v9
    s_cmp_eq_u32 s69, 1
    s_cselect_b32 s71, 32, 64
    v_mov_b32 v11, s3
    v_cmp_gt_u32 vcc, s71, v0
    s_nop 1
    v_cndmask_b32 v45, v11, v9, vcc
    v_cmp_gt_u32 vcc, 32, v0
    s_nop 1
    v_cndmask_b32 v46, v11, v1, vcc
    s_mul_i32 s80, s63, 16
    s_add_u32 s80, s80, s64
    s_lshl_b32 s80, s80, 7
    s_add_u32 s80, s80, 589824
    s_cmp_eq_u32 s56, 0
    s_cselect_b32 s80, s80, s3
    s_add_u32 s81, s80, 131072
    s_lshl_b32 s70, s61, 2
    s_add_u32 s70, s70, s56
    s_mul_i32 s72, s56, 14336
    s_add_u32 s72, s72, 20971520
    s_xor_b32 s71, s70, 0
    s_mul_i32 s4, s71, 57344
    s_add_u32 s4, s4, s72
    s_xor_b32 s71, s70, 1
    s_mul_i32 s5, s71, 57344
    s_add_u32 s5, s5, s72
    s_xor_b32 s71, s70, 2
    s_mul_i32 s6, s71, 57344
    s_add_u32 s6, s6, s72
    s_xor_b32 s71, s70, 3
    s_mul_i32 s7, s71, 57344
    s_add_u32 s7, s7, s72
    s_lshl_b32 s68, s56, 9
    s_add_u32 s18, s18, s68
    v_add_u32 v4, s15, v36
    v_add_u32 v5, s15, v37
    v_add_u32 v6, s15, v38
    s_mov_b32 s52, s24
    s_mov_b32 s53, s25
    s_mov_b32 s54, 2621440
    s_mov_b32 s55, 0x20000
    s_waitcnt vmcnt(10)
    v_cmp_ne_u64 vcc, s[30:31], v[14:15]
    s_cbranch_vccz L_polled_24
    s_mov_b32 s65, 200000
L_poll_23:
    buffer_load_dwordx2 v[14:15], v7, s[32:35], s82 offen sc1
    s_waitcnt vmcnt(0)
    v_cmp_ne_u64 vcc, s[30:31], v[14:15]
    s_cbranch_vccz L_polled_24
    s_sub_u32 s65, s65, 1
    s_cmp_lg_u32 s65, 0
    s_cbranch_scc1 L_poll_23
L_polled_24:
    v_and_b32 v7, 0x180, v7
    buffer_load_dwordx4 a[0:3], v1, s[32:35], s76 offen offset:0 sc1
    buffer_load_dwordx4 a[4:7], v1, s[32:35], s77 offen offset:0 sc1
    buffer_load_dwordx4 a[8:11], v1, s[32:35], s76 offen offset:1024 sc1
    buffer_load_dwordx4 a[12:15], v1, s[32:35], s77 offen offset:1024 sc1
    buffer_load_dwordx4 a[16:19], v1, s[32:35], s76 offen offset:2048 sc1
    buffer_load_dwordx4 a[20:23], v1, s[32:35], s77 offen offset:2048 sc1
    buffer_load_dwordx4 a[24:27], v1, s[32:35], s76 offen offset:3072 sc1
    buffer_load_dwordx4 a[28:31], v1, s[32:35], s77 offen offset:3072 sc1
    s_add_u32 s76, s76, 4096
    buffer_load_dwordx4 a[32:35], v1, s[32:35], s76 offen offset:0 sc1
    s_add_u32 s77, s77, 4096
    buffer_load_dwordx4 a[36:39], v1, s[32:35], s77 offen offset:0 sc1
    s_barrier
    ds_read_b128 a[176:179], v37 offset:36864
    ds_read_b128 a[180:183], v37 offset:37888
    ds_read_b128 a[184:187], v37 offset:38912
    ds_read_b128 a[188:191], v37 offset:39936
    ds_read_b128 a[160:163], v37 offset:40960
    ds_read_b128 a[164:167], v37 offset:41984
    s_waitcnt vmcnt(8) lgkmcnt(4)
    v_mfma_f32_16x16x32_bf16 v[48:51], a[176:179], a[0:3], 0
    ds_read_b128 a[168:171], v37 offset:43008
    v_mfma_f32_16x16x32_bf16 v[80:83], a[176:179], a[4:7], 0
    buffer_load_dwordx4 a[40:43], v1, s[32:35], s76 offen offset:1024 sc1
    v_mfma_f32_16x16x32_bf16 v[52:55], a[180:183], a[0:3], 0
    ds_read_b128 a[172:175], v37 offset:44032
    v_mfma_f32_16x16x32_bf16 v[84:87], a[180:183], a[4:7], 0
    s_waitcnt lgkmcnt(4)
    v_mfma_f32_16x16x32_bf16 v[56:59], a[184:187], a[0:3], 0
    ds_read_b128 a[176:179], v37 offset:45056
    v_mfma_f32_16x16x32_bf16 v[88:91], a[184:187], a[4:7], 0
    buffer_load_dwordx4 a[44:47], v1, s[32:35], s77 offen offset:1024 sc1
    v_mfma_f32_16x16x32_bf16 v[60:63], a[188:191], a[0:3], 0
    ds_read_b128 a[180:183], v37 offset:46080
    v_mfma_f32_16x16x32_bf16 v[92:95], a[188:191], a[4:7], 0
    s_waitcnt lgkmcnt(4)
    v_mfma_f32_16x16x32_bf16 v[64:67], a[160:163], a[0:3], 0
    ds_read_b128 a[184:187], v37 offset:47104
    v_mfma_f32_16x16x32_bf16 v[96:99], a[160:163], a[4:7], 0
    buffer_load_dwordx4 a[48:51], v1, s[32:35], s76 offen offset:2048 sc1
    v_mfma_f32_16x16x32_bf16 v[68:71], a[164:167], a[0:3], 0
    ds_read_b128 a[188:191], v37 offset:48128
    v_mfma_f32_16x16x32_bf16 v[100:103], a[164:167], a[4:7], 0
    s_waitcnt lgkmcnt(4)
    v_mfma_f32_16x16x32_bf16 v[72:75], a[168:171], a[0:3], 0
    ds_read_b128 a[160:163], v37 offset:49152
    v_mfma_f32_16x16x32_bf16 v[104:107], a[168:171], a[4:7], 0
    buffer_load_dwordx4 a[52:55], v1, s[32:35], s77 offen offset:2048 sc1
    v_mfma_f32_16x16x32_bf16 v[76:79], a[172:175], a[0:3], 0
    ds_read_b128 a[164:167], v37 offset:50176
    v_mfma_f32_16x16x32_bf16 v[108:111], a[172:175], a[4:7], 0
    s_waitcnt vmcnt(10) lgkmcnt(4)
    v_mfma_f32_16x16x32_bf16 v[48:51], a[176:179], a[8:11], v[48:51]
    ds_read_b128 a[168:171], v37 offset:51200
    v_mfma_f32_16x16x32_bf16 v[80:83], a[176:179], a[12:15], v[80:83]
    buffer_load_dwordx4 a[56:59], v1, s[32:35], s76 offen offset:3072 sc1
    v_mfma_f32_16x16x32_bf16 v[52:55], a[180:183], a[8:11], v[52:55]
    ds_read_b128 a[172:175], v37 offset:52224
    v_mfma_f32_16x16x32_bf16 v[84:87], a[180:183], a[12:15], v[84:87]
    s_waitcnt lgkmcnt(4)
    v_mfma_f32_16x16x32_bf16 v[56:59], a[184:187], a[8:11], v[56:59]
    ds_read_b128 a[176:179], v37 offset:53248
    v_mfma_f32_16x16x32_bf16 v[88:91], a[184:187], a[12:15], v[88:91]
    buffer_load_dwordx4 a[60:63], v1, s[32:35], s77 offen offset:3072 sc1
    v_mfma_f32_16x16x32_bf16 v[60:63], a[188:191], a[8:11], v[60:63]
    ds_read_b128 a[180:183], v37 offset:54272
    v_mfma_f32_16x16x32_bf16 v[92:95], a[188:191], a[12:15], v[92:95]
    s_waitcnt lgkmcnt(4)
    v_mfma_f32_16x16x32_bf16 v[64:67], a[160:163], a[8:11], v[64:67]
    ds_read_b128 a[184:187], v37 offset:55296
    v_mfma_f32_16x16x32_bf16 v[96:99], a[160:163], a[12:15], v[96:99]
    s_add_u32 s76, s76, 4096
    buffer_load_dwordx4 a[64:67], v1, s[32:35], s76 offen offset:0 sc1
    v_mfma_f32_16x16x32_bf16 v[68:71], a[164:167], a[8:11], v[68:71]
    ds_read_b128 a[188:191], v37 offset:56320
    v_mfma_f32_16x16x32_bf16 v[100:103], a[164:167], a[12:15], v[100:103]
    s_waitcnt lgkmcnt(4)
    v_mfma_f32_16x16x32_bf16 v[72:75], a[168:171], a[8:11], v[72:75]
    ds_read_b128 a[160:163], v37 offset:57344
    v_mfma_f32_16x16x32_bf16 v[104:107], a[168:171], a[12:15], v[104:107]
    s_add_u32 s77, s77, 4096
    buffer_load_dwordx4 a[68:71], v1, s[32:35], s77 offen offset:0 sc1
    v_mfma_f32_16x16x32_bf16 v[76:79], a[172:175], a[8:11], v[76:79]
    ds_read_b128 a[164:167], v37 offset:58368
    v_mfma_f32_16x16x32_bf16 v[108:111], a[172:175], a[12:15], v[108:111]
    s_waitcnt vmcnt(12) lgkmcnt(4)
    v_mfma_f32_16x16x32_bf16 v[48:51], a[176:179], a[16:19], v[48:51]
    ds_read_b128 a[168:171], v37 offset:59392
    v_mfma_f32_16x16x32_bf16 v[80:83], a[176:179], a[20:23], v[80:83]
    buffer_load_dwordx4 a[72:75], v1, s[32:35], s76 offen offset:1024 sc1
    v_mfma_f32_16x16x32_bf16 v[52:55], a[180:183], a[16:19], v[52:55]
    ds_read_b128 a[172:175], v37 offset:60416
    v_mfma_f32_16x16x32_bf16 v[84:87], a[180:183], a[20:23], v[84:87]
    s_waitcnt lgkmcnt(4)
    v_mfma_f32_16x16x32_bf16 v[56:59], a[184:187], a[16:19], v[56:59]
    ds_read_b128 a[176:179], v37 offset:61440
    v_mfma_f32_16x16x32_bf16 v[88:91], a[184:187], a[20:23], v[88:91]
    buffer_load_dwordx4 a[76:79], v1, s[32:35], s77 offen offset:1024 sc1
    v_mfma_f32_16x16x32_bf16 v[60:63], a[188:191], a[16:19], v[60:63]
    ds_read_b128 a[180:183], v37 offset:62464
    v_mfma_f32_16x16x32_bf16 v[92:95], a[188:191], a[20:23], v[92:95]
    s_waitcnt lgkmcnt(4)
    v_mfma_f32_16x16x32_bf16 v[64:67], a[160:163], a[16:19], v[64:67]
    ds_read_b128 a[184:187], v37 offset:63488
    v_mfma_f32_16x16x32_bf16 v[96:99], a[160:163], a[20:23], v[96:99]
    buffer_load_dwordx4 a[80:83], v1, s[32:35], s76 offen offset:2048 sc1
    v_mfma_f32_16x16x32_bf16 v[68:71], a[164:167], a[16:19], v[68:71]
    ds_read_b128 a[188:191], v37 offset:64512
    v_mfma_f32_16x16x32_bf16 v[100:103], a[164:167], a[20:23], v[100:103]
    s_waitcnt lgkmcnt(4)
    v_mfma_f32_16x16x32_bf16 v[72:75], a[168:171], a[16:19], v[72:75]
    ds_read_b128 a[160:163], v38 offset:0
    v_mfma_f32_16x16x32_bf16 v[104:107], a[168:171], a[20:23], v[104:107]
    buffer_load_dwordx4 a[84:87], v1, s[32:35], s77 offen offset:2048 sc1
    v_mfma_f32_16x16x32_bf16 v[76:79], a[172:175], a[16:19], v[76:79]
    ds_read_b128 a[164:167], v38 offset:1024
    v_mfma_f32_16x16x32_bf16 v[108:111], a[172:175], a[20:23], v[108:111]
    s_barrier
    s_waitcnt vmcnt(14) lgkmcnt(4)
    v_mfma_f32_16x16x32_bf16 v[48:51], a[176:179], a[24:27], v[48:51]
    ds_read_b128 a[168:171], v38 offset:2048
    v_mfma_f32_16x16x32_bf16 v[80:83], a[176:179], a[28:31], v[80:83]
    buffer_load_dwordx4 a[88:91], v1, s[32:35], s76 offen offset:3072 sc1
    v_mfma_f32_16x16x32_bf16 v[52:55], a[180:183], a[24:27], v[52:55]
    ds_read_b128 a[172:175], v38 offset:3072
    v_mfma_f32_16x16x32_bf16 v[84:87], a[180:183], a[28:31], v[84:87]
    s_waitcnt lgkmcnt(4)
    v_mfma_f32_16x16x32_bf16 v[56:59], a[184:187], a[24:27], v[56:59]
    ds_read_b128 a[176:179], v38 offset:4096
    v_mfma_f32_16x16x32_bf16 v[88:91], a[184:187], a[28:31], v[88:91]
    buffer_load_dwordx4 a[92:95], v1, s[32:35], s77 offen offset:3072 sc1
    v_mfma_f32_16x16x32_bf16 v[60:63], a[188:191], a[24:27], v[60:63]
    ds_read_b128 a[180:183], v38 offset:5120
    v_mfma_f32_16x16x32_bf16 v[92:95], a[188:191], a[28:31], v[92:95]
    s_waitcnt lgkmcnt(4)
    v_mfma_f32_16x16x32_bf16 v[64:67], a[160:163], a[24:27], v[64:67]
    ds_read_b128 a[184:187], v38 offset:6144
    v_mfma_f32_16x16x32_bf16 v[96:99], a[160:163], a[28:31], v[96:99]
    s_add_u32 s76, s76, 4096
    buffer_load_dwordx4 a[96:99], v1, s[32:35], s76 offen offset:0 sc1
    v_mfma_f32_16x16x32_bf16 v[68:71], a[164:167], a[24:27], v[68:71]
    ds_read_b128 a[188:191], v38 offset:7168
    v_mfma_f32_16x16x32_bf16 v[100:103], a[164:167], a[28:31], v[100:103]
    s_waitcnt lgkmcnt(4)
    v_mfma_f32_16x16x32_bf16 v[72:75], a[168:171], a[24:27], v[72:75]
    ds_read_b128 a[160:163], v38 offset:8192
    v_mfma_f32_16x16x32_bf16 v[104:107], a[168:171], a[28:31], v[104:107]
    s_add_u32 s77, s77, 4096
    buffer_load_dwordx4 a[100:103], v1, s[32:35], s77 offen offset:0 sc1
    v_mfma_f32_16x16x32_bf16 v[76:79], a[172:175], a[24:27], v[76:79]
    ds_read_b128 a[164:167], v38 offset:9216
    v_mfma_f32_16x16x32_bf16 v[108:111], a[172:175], a[28:31], v[108:111]
    s_waitcnt vmcnt(16) lgkmcnt(4)
    v_mfma_f32_16x16x32_bf16 v[48:51], a[176:179], a[32:35], v[48:51]
    ds_read_b128 a[168:171], v38 offset:10240
    v_mfma_f32_16x16x32_bf16 v[80:83], a[176:179], a[36:39], v[80:83]
    buffer_load_dwordx4 a[104:107], v1, s[32:35], s76 offen offset:1024 sc1
    v_mfma_f32_16x16x32_bf16 v[52:55], a[180:183], a[32:35], v[52:55]
    ds_read_b128 a[172:175], v38 offset:11264
    v_mfma_f32_16x16x32_bf16 v[84:87], a[180:183], a[36:39], v[84:87]
    s_waitcnt lgkmcnt(4)
    v_mfma_f32_16x16x32_bf16 v[56:59], a[184:187], a[32:35], v[56:59]
    ds_read_b128 a[176:179], v38 offset:12288
    v_mfma_f32_16x16x32_bf16 v[88:91], a[184:187], a[36:39], v[88:91]
    buffer_load_dwordx4 a[108:111], v1, s[32:35], s77 offen offset:1024 sc1
    v_mfma_f32_16x16x32_bf16 v[60:63], a[188:191], a[32:35], v[60:63]
    ds_read_b128 a[180:183], v38 offset:13312
    v_mfma_f32_16x16x32_bf16 v[92:95], a[188:191], a[36:39], v[92:95]
    s_waitcnt lgkmcnt(4)
    v_mfma_f32_16x16x32_bf16 v[64:67], a[160:163], a[32:35], v[64:67]
    ds_read_b128 a[184:187], v38 offset:14336
    v_mfma_f32_16x16x32_bf16 v[96:99], a[160:163], a[36:39], v[96:99]
    buffer_load_dwordx4 a[112:115], v1, s[32:35], s76 offen offset:2048 sc1
    v_mfma_f32_16x16x32_bf16 v[68:71], a[164:167], a[32:35], v[68:71]
    ds_read_b128 a[188:191], v38 offset:15360
    v_mfma_f32_16x16x32_bf16 v[100:103], a[164:167], a[36:39], v[100:103]
    s_waitcnt lgkmcnt(4)
    v_mfma_f32_16x16x32_bf16 v[72:75], a[168:171], a[32:35], v[72:75]
    ds_read_b128 a[160:163], v38 offset:16384
    v_mfma_f32_16x16x32_bf16 v[104:107], a[168:171], a[36:39], v[104:107]
    buffer_load_dwordx4 a[116:119], v1, s[32:35], s77 offen offset:2048 sc1
    v_mfma_f32_16x16x32_bf16 v[76:79], a[172:175], a[32:35], v[76:79]
    ds_read_b128 a[164:167], v38 offset:17408
    v_mfma_f32_16x16x32_bf16 v[108:111], a[172:175], a[36:39], v[108:111]
    s_waitcnt vmcnt(18) lgkmcnt(4)
    v_mfma_f32_16x16x32_bf16 v[48:51], a[176:179], a[40:43], v[48:51]
    ds_read_b128 a[168:171], v38 offset:18432
    v_mfma_f32_16x16x32_bf16 v[80:83], a[176:179], a[44:47], v[80:83]
    buffer_load_dwordx4 a[120:123], v1, s[32:35], s76 offen offset:3072 sc1
    v_mfma_f32_16x16x32_bf16 v[52:55], a[180:183], a[40:43], v[52:55]
    ds_read_b128 a[172:175], v38 offset:19456
    v_mfma_f32_16x16x32_bf16 v[84:87], a[180:183], a[44:47], v[84:87]
    s_waitcnt lgkmcnt(4)
    v_mfma_f32_16x16x32_bf16 v[56:59], a[184:187], a[40:43], v[56:59]
    ds_read_b128 a[176:179], v38 offset:20480
    v_mfma_f32_16x16x32_bf16 v[88:91], a[184:187], a[44:47], v[88:91]
    buffer_load_dwordx4 v253, s[32:35], m0 offen sc1 lds
    s_add_u32 m0, s15, 65536
    v_mfma_f32_16x16x32_bf16 v[60:63], a[188:191], a[40:43], v[60:63]
    ds_read_b128 a[180:183], v38 offset:21504
    v_mfma_f32_16x16x32_bf16 v[92:95], a[188:191], a[44:47], v[92:95]
    s_waitcnt lgkmcnt(4)
    v_mfma_f32_16x16x32_bf16 v[64:67], a[160:163], a[40:43], v[64:67]
    ds_read_b128 a[184:187], v38 offset:22528
    v_mfma_f32_16x16x32_bf16 v[96:99], a[160:163], a[44:47], v[96:99]
    buffer_load_dwordx4 a[124:127], v1, s[32:35], s77 offen offset:3072 sc1
    v_mfma_f32_16x16x32_bf16 v[68:71], a[164:167], a[40:43], v[68:71]
    ds_read_b128 a[188:191], v38 offset:23552
    v_mfma_f32_16x16x32_bf16 v[100:103], a[164:167], a[44:47], v[100:103]
    s_waitcnt lgkmcnt(4)
    v_mfma_f32_16x16x32_bf16 v[72:75], a[168:171], a[40:43], v[72:75]
    ds_read_b128 a[160:163], v38 offset:24576
    v_mfma_f32_16x16x32_bf16 v[104:107], a[168:171], a[44:47], v[104:107]
    buffer_load_dwordx4 v253, s[32:35], m0 offen sc1 lds
    s_add_u32 m0, s15, 69632
    v_mfma_f32_16x16x32_bf16 v[76:79], a[172:175], a[40:43], v[76:79]
    ds_read_b128 a[164:167], v38 offset:25600
    v_mfma_f32_16x16x32_bf16 v[108:111], a[172:175], a[44:47], v[108:111]
    s_barrier
    s_waitcnt vmcnt(20) lgkmcnt(4)
    v_mfma_f32_16x16x32_bf16 v[48:51], a[176:179], a[48:51], v[48:51]
    ds_read_b128 a[168:171], v38 offset:26624
    v_mfma_f32_16x16x32_bf16 v[80:83], a[176:179], a[52:55], v[80:83]
    s_add_u32 s76, s76, 4096
    buffer_load_dwordx4 a[128:131], v1, s[32:35], s76 offen offset:0 sc1
    v_mfma_f32_16x16x32_bf16 v[52:55], a[180:183], a[48:51], v[52:55]
    ds_read_b128 a[172:175], v38 offset:27648
    v_mfma_f32_16x16x32_bf16 v[84:87], a[180:183], a[52:55], v[84:87]
    s_waitcnt lgkmcnt(4)
    v_mfma_f32_16x16x32_bf16 v[56:59], a[184:187], a[48:51], v[56:59]
    ds_read_b128 a[176:179], v38 offset:28672
    v_mfma_f32_16x16x32_bf16 v[88:91], a[184:187], a[52:55], v[88:91]
    buffer_load_dwordx4 v253, s[32:35], m0 offen sc1 lds
    s_add_u32 m0, s15, 73728
    v_mfma_f32_16x16x32_bf16 v[60:63], a[188:191], a[48:51], v[60:63]
    ds_read_b128 a[180:183], v38 offset:29696
    v_mfma_f32_16x16x32_bf16 v[92:95], a[188:191], a[52:55], v[92:95]
    s_waitcnt lgkmcnt(4)
    v_mfma_f32_16x16x32_bf16 v[64:67], a[160:163], a[48:51], v[64:67]
    ds_read_b128 a[184:187], v38 offset:30720
    v_mfma_f32_16x16x32_bf16 v[96:99], a[160:163], a[52:55], v[96:99]
    s_add_u32 s77, s77, 4096
    buffer_load_dwordx4 a[132:135], v1, s[32:35], s77 offen offset:0 sc1
    v_mfma_f32_16x16x32_bf16 v[68:71], a[164:167], a[48:51], v[68:71]
    ds_read_b128 a[188:191], v38 offset:31744
    v_mfma_f32_16x16x32_bf16 v[100:103], a[164:167], a[52:55], v[100:103]
    s_waitcnt lgkmcnt(4)
    v_mfma_f32_16x16x32_bf16 v[72:75], a[168:171], a[48:51], v[72:75]
    ds_read_b128 a[160:163], v36 offset:0
    v_mfma_f32_16x16x32_bf16 v[104:107], a[168:171], a[52:55], v[104:107]
    buffer_load_dwordx4 v253, s[32:35], m0 offen sc1 lds
    s_add_u32 m0, s15, 77824
    v_mfma_f32_16x16x32_bf16 v[76:79], a[172:175], a[48:51], v[76:79]
    ds_read_b128 a[164:167], v36 offset:1024
    v_mfma_f32_16x16x32_bf16 v[108:111], a[172:175], a[52:55], v[108:111]
    s_waitcnt vmcnt(22) lgkmcnt(4)
    v_mfma_f32_16x16x32_bf16 v[48:51], a[176:179], a[56:59], v[48:51]
    ds_read_b128 a[168:171], v36 offset:2048
    v_mfma_f32_16x16x32_bf16 v[80:83], a[176:179], a[60:63], v[80:83]
    buffer_load_dwordx4 a[136:139], v1, s[32:35], s76 offen offset:1024 sc1
    v_mfma_f32_16x16x32_bf16 v[52:55], a[180:183], a[56:59], v[52:55]
    ds_read_b128 a[172:175], v36 offset:3072
    v_mfma_f32_16x16x32_bf16 v[84:87], a[180:183], a[60:63], v[84:87]
    s_waitcnt lgkmcnt(4)
    v_mfma_f32_16x16x32_bf16 v[56:59], a[184:187], a[56:59], v[56:59]
    ds_read_b128 a[176:179], v36 offset:4096
    v_mfma_f32_16x16x32_bf16 v[88:91], a[184:187], a[60:63], v[88:91]
    buffer_load_dwordx4 v253, s[32:35], m0 offen sc1 lds
    s_add_u32 m0, s15, 81920
    v_mfma_f32_16x16x32_bf16 v[60:63], a[188:191], a[56:59], v[60:63]
    ds_read_b128 a[180:183], v36 offset:5120
    v_mfma_f32_16x16x32_bf16 v[92:95], a[188:191], a[60:63], v[92:95]
    s_waitcnt lgkmcnt(4)
    v_mfma_f32_16x16x32_bf16 v[64:67], a[160:163], a[56:59], v[64:67]
    ds_read_b128 a[184:187], v36 offset:6144
    v_mfma_f32_16x16x32_bf16 v[96:99], a[160:163], a[60:63], v[96:99]
    buffer_load_dwordx4 a[140:143], v1, s[32:35], s77 offen offset:1024 sc1
    v_mfma_f32_16x16x32_bf16 v[68:71], a[164:167], a[56:59], v[68:71]
    ds_read_b128 a[188:191], v36 offset:7168
    v_mfma_f32_16x16x32_bf16 v[100:103], a[164:167], a[60:63], v[100:103]
    s_waitcnt lgkmcnt(4)
    v_mfma_f32_16x16x32_bf16 v[72:75], a[168:171], a[56:59], v[72:75]
    ds_read_b128 a[160:163], v36 offset:8192
    v_mfma_f32_16x16x32_bf16 v[104:107], a[168:171], a[60:63], v[104:107]
    buffer_load_dwordx4 v253, s[32:35], m0 offen sc1 lds
    s_add_u32 m0, s15, 86016
    v_mfma_f32_16x16x32_bf16 v[76:79], a[172:175], a[56:59], v[76:79]
    ds_read_b128 a[164:167], v36 offset:9216
    v_mfma_f32_16x16x32_bf16 v[108:111], a[172:175], a[60:63], v[108:111]
    s_waitcnt vmcnt(24) lgkmcnt(4)
    v_mfma_f32_16x16x32_bf16 v[48:51], a[176:179], a[64:67], v[48:51]
    ds_read_b128 a[168:171], v36 offset:10240
    v_mfma_f32_16x16x32_bf16 v[80:83], a[176:179], a[68:71], v[80:83]
    buffer_load_dwordx4 a[144:147], v1, s[32:35], s76 offen offset:2048 sc1
    v_mfma_f32_16x16x32_bf16 v[52:55], a[180:183], a[64:67], v[52:55]
    ds_read_b128 a[172:175], v36 offset:11264
    v_mfma_f32_16x16x32_bf16 v[84:87], a[180:183], a[68:71], v[84:87]
    s_waitcnt lgkmcnt(4)
    v_mfma_f32_16x16x32_bf16 v[56:59], a[184:187], a[64:67], v[56:59]
    ds_read_b128 a[176:179], v36 offset:12288
    v_mfma_f32_16x16x32_bf16 v[88:91], a[184:187], a[68:71], v[88:91]
    buffer_load_dwordx4 v253, s[32:35], m0 offen sc1 lds
    s_add_u32 m0, s15, 90112
    v_mfma_f32_16x16x32_bf16 v[60:63], a[188:191], a[64:67], v[60:63]
    ds_read_b128 a[180:183], v36 offset:13312
    v_mfma_f32_16x16x32_bf16 v[92:95], a[188:191], a[68:71], v[92:95]
    s_waitcnt lgkmcnt(4)
    v_mfma_f32_16x16x32_bf16 v[64:67], a[160:163], a[64:67], v[64:67]
    ds_read_b128 a[184:187], v36 offset:14336
    v_mfma_f32_16x16x32_bf16 v[96:99], a[160:163], a[68:71], v[96:99]
    buffer_load_dwordx4 a[148:151], v1, s[32:35], s77 offen offset:2048 sc1
    v_mfma_f32_16x16x32_bf16 v[68:71], a[164:167], a[64:67], v[68:71]
    ds_read_b128 a[188:191], v36 offset:15360
    v_mfma_f32_16x16x32_bf16 v[100:103], a[164:167], a[68:71], v[100:103]
    s_waitcnt lgkmcnt(4)
    v_mfma_f32_16x16x32_bf16 v[72:75], a[168:171], a[64:67], v[72:75]
    ds_read_b128 a[160:163], v36 offset:16384
    v_mfma_f32_16x16x32_bf16 v[104:107], a[168:171], a[68:71], v[104:107]
    buffer_load_dwordx4 v253, s[32:35], m0 offen sc1 lds
    s_add_u32 m0, s15, 94208
    v_mfma_f32_16x16x32_bf16 v[76:79], a[172:175], a[64:67], v[76:79]
    ds_read_b128 a[164:167], v36 offset:17408
    v_mfma_f32_16x16x32_bf16 v[108:111], a[172:175], a[68:71], v[108:111]
    s_barrier
    s_waitcnt vmcnt(26) lgkmcnt(4)
    v_mfma_f32_16x16x32_bf16 v[48:51], a[176:179], a[72:75], v[48:51]
    ds_read_b128 a[168:171], v36 offset:18432
    v_mfma_f32_16x16x32_bf16 v[80:83], a[176:179], a[76:79], v[80:83]
    buffer_load_dwordx4 a[152:155], v1, s[32:35], s76 offen offset:3072 sc1
    v_mfma_f32_16x16x32_bf16 v[52:55], a[180:183], a[72:75], v[52:55]
    ds_read_b128 a[172:175], v36 offset:19456
    v_mfma_f32_16x16x32_bf16 v[84:87], a[180:183], a[76:79], v[84:87]
    s_waitcnt lgkmcnt(4)
    v_mfma_f32_16x16x32_bf16 v[56:59], a[184:187], a[72:75], v[56:59]
    ds_read_b128 a[176:179], v36 offset:20480
    v_mfma_f32_16x16x32_bf16 v[88:91], a[184:187], a[76:79], v[88:91]
    buffer_load_dwordx4 v253, s[32:35], m0 offen sc1 lds
    s_add_u32 m0, s15, 98304
    v_mfma_f32_16x16x32_bf16 v[60:63], a[188:191], a[72:75], v[60:63]
    ds_read_b128 a[180:183], v36 offset:21504
    v_mfma_f32_16x16x32_bf16 v[92:95], a[188:191], a[76:79], v[92:95]
    s_waitcnt lgkmcnt(4)
    v_mfma_f32_16x16x32_bf16 v[64:67], a[160:163], a[72:75], v[64:67]
    ds_read_b128 a[184:187], v36 offset:22528
    v_mfma_f32_16x16x32_bf16 v[96:99], a[160:163], a[76:79], v[96:99]
    buffer_load_dwordx4 a[156:159], v1, s[32:35], s77 offen offset:3072 sc1
    v_mfma_f32_16x16x32_bf16 v[68:71], a[164:167], a[72:75], v[68:71]
    ds_read_b128 a[188:191], v36 offset:23552
    v_mfma_f32_16x16x32_bf16 v[100:103], a[164:167], a[76:79], v[100:103]
    s_waitcnt lgkmcnt(4)
    v_mfma_f32_16x16x32_bf16 v[72:75], a[168:171], a[72:75], v[72:75]
    ds_read_b128 a[160:163], v36 offset:24576
    v_mfma_f32_16x16x32_bf16 v[104:107], a[168:171], a[76:79], v[104:107]
    buffer_load_dwordx4 v253, s[32:35], m0 offen sc1 lds
    s_add_u32 m0, s15, 102400
    v_mfma_f32_16x16x32_bf16 v[76:79], a[172:175], a[72:75], v[76:79]
    ds_read_b128 a[164:167], v36 offset:25600
    v_mfma_f32_16x16x32_bf16 v[108:111], a[172:175], a[76:79], v[108:111]
    s_waitcnt vmcnt(28) lgkmcnt(4)
    v_mfma_f32_16x16x32_bf16 v[48:51], a[176:179], a[80:83], v[48:51]
    ds_read_b128 a[168:171], v36 offset:26624
    v_mfma_f32_16x16x32_bf16 v[80:83], a[176:179], a[84:87], v[80:83]
    buffer_load_dwordx4 v253, s[32:35], m0 offen sc1 lds
    s_add_u32 m0, s15, 106496
    v_mfma_f32_16x16x32_bf16 v[52:55], a[180:183], a[80:83], v[52:55]
    ds_read_b128 a[172:175], v36 offset:27648
    v_mfma_f32_16x16x32_bf16 v[84:87], a[180:183], a[84:87], v[84:87]
    s_waitcnt lgkmcnt(4)
    v_mfma_f32_16x16x32_bf16 v[56:59], a[184:187], a[80:83], v[56:59]
    ds_read_b128 a[176:179], v36 offset:28672
    v_mfma_f32_16x16x32_bf16 v[88:91], a[184:187], a[84:87], v[88:91]
    buffer_load_dwordx4 v253, s[32:35], m0 offen sc1 lds
    s_add_u32 m0, s15, 110592
    v_mfma_f32_16x16x32_bf16 v[60:63], a[188:191], a[80:83], v[60:63]
    ds_read_b128 a[180:183], v36 offset:29696
    v_mfma_f32_16x16x32_bf16 v[92:95], a[188:191], a[84:87], v[92:95]
    s_waitcnt lgkmcnt(4)
    v_mfma_f32_16x16x32_bf16 v[64:67], a[160:163], a[80:83], v[64:67]
    ds_read_b128 a[184:187], v36 offset:30720
    v_mfma_f32_16x16x32_bf16 v[96:99], a[160:163], a[84:87], v[96:99]
    buffer_load_dwordx4 v253, s[32:35], m0 offen sc1 lds
    s_add_u32 m0, s15, 114688
    v_mfma_f32_16x16x32_bf16 v[68:71], a[164:167], a[80:83], v[68:71]
    ds_read_b128 a[188:191], v36 offset:31744
    v_mfma_f32_16x16x32_bf16 v[100:103], a[164:167], a[84:87], v[100:103]
    s_waitcnt lgkmcnt(4)
    v_mfma_f32_16x16x32_bf16 v[72:75], a[168:171], a[80:83], v[72:75]
    ds_read_b128 a[160:163], v36 offset:32768
    v_mfma_f32_16x16x32_bf16 v[104:107], a[168:171], a[84:87], v[104:107]
    buffer_load_dwordx4 v253, s[32:35], m0 offen sc1 lds
    s_add_u32 m0, s15, 118784
    v_mfma_f32_16x16x32_bf16 v[76:79], a[172:175], a[80:83], v[76:79]
    ds_read_b128 a[164:167], v36 offset:33792
    v_mfma_f32_16x16x32_bf16 v[108:111], a[172:175], a[84:87], v[108:111]
    s_waitcnt vmcnt(30) lgkmcnt(4)
    v_mfma_f32_16x16x32_bf16 v[48:51], a[176:179], a[88:91], v[48:51]
    ds_read_b128 a[168:171], v36 offset:34816
    v_mfma_f32_16x16x32_bf16 v[80:83], a[176:179], a[92:95], v[80:83]
    buffer_load_dwordx4 v253, s[32:35], m0 offen sc1 lds
    s_add_u32 m0, s15, 122880
    v_mfma_f32_16x16x32_bf16 v[52:55], a[180:183], a[88:91], v[52:55]
    ds_read_b128 a[172:175], v36 offset:35840
    v_mfma_f32_16x16x32_bf16 v[84:87], a[180:183], a[92:95], v[84:87]
    s_waitcnt lgkmcnt(4)
    v_mfma_f32_16x16x32_bf16 v[56:59], a[184:187], a[88:91], v[56:59]
    ds_read_b128 a[176:179], v36 offset:36864
    v_mfma_f32_16x16x32_bf16 v[88:91], a[184:187], a[92:95], v[88:91]
    buffer_load_dwordx4 v253, s[32:35], m0 offen sc1 lds
    s_add_u32 m0, s15, 126976
    v_mfma_f32_16x16x32_bf16 v[60:63], a[188:191], a[88:91], v[60:63]
    ds_read_b128 a[180:183], v36 offset:37888
    v_mfma_f32_16x16x32_bf16 v[92:95], a[188:191], a[92:95], v[92:95]
    s_waitcnt lgkmcnt(4)
    v_mfma_f32_16x16x32_bf16 v[64:67], a[160:163], a[88:91], v[64:67]
    ds_read_b128 a[184:187], v36 offset:38912
    v_mfma_f32_16x16x32_bf16 v[96:99], a[160:163], a[92:95], v[96:99]
    buffer_load_dwordx4 v253, s[32:35], m0 offen sc1 lds
    s_add_u32 m0, s15, 131072
    v_mfma_f32_16x16x32_bf16 v[68:71], a[164:167], a[88:91], v[68:71]
    ds_read_b128 a[188:191], v36 offset:39936
    v_mfma_f32_16x16x32_bf16 v[100:103], a[164:167], a[92:95], v[100:103]
    s_waitcnt lgkmcnt(4)
    v_mfma_f32_16x16x32_bf16 v[72:75], a[168:171], a[88:91], v[72:75]
    ds_read_b128 a[160:163], v36 offset:40960
    v_mfma_f32_16x16x32_bf16 v[104:107], a[168:171], a[92:95], v[104:107]
    buffer_load_dwordx4 v253, s[32:35], m0 offen sc1 lds
    s_add_u32 m0, s15, 135168
    v_mfma_f32_16x16x32_bf16 v[76:79], a[172:175], a[88:91], v[76:79]
    ds_read_b128 a[164:167], v36 offset:41984
    v_mfma_f32_16x16x32_bf16 v[108:111], a[172:175], a[92:95], v[108:111]
    s_waitcnt vmcnt(22)
    s_barrier
    s_waitcnt lgkmcnt(4)
    v_mfma_f32_16x16x32_bf16 v[48:51], a[176:179], a[96:99], v[48:51]
    ds_read_b128 a[168:171], v36 offset:43008
    v_mfma_f32_16x16x32_bf16 v[80:83], a[176:179], a[100:103], v[80:83]
    buffer_load_dwordx4 v253, s[32:35], m0 offen sc1 lds
    s_add_u32 m0, s15, 139264
    v_mfma_f32_16x16x32_bf16 v[52:55], a[180:183], a[96:99], v[52:55]
    ds_read_b128 a[172:175], v36 offset:44032
    v_mfma_f32_16x16x32_bf16 v[84:87], a[180:183], a[100:103], v[84:87]
    s_waitcnt lgkmcnt(4)
    v_mfma_f32_16x16x32_bf16 v[56:59], a[184:187], a[96:99], v[56:59]
    ds_read_b128 a[176:179], v36 offset:45056
    v_mfma_f32_16x16x32_bf16 v[88:91], a[184:187], a[100:103], v[88:91]
    buffer_load_dwordx4 v253, s[32:35], m0 offen sc1 lds
    s_add_u32 m0, s15, 143360
    v_mfma_f32_16x16x32_bf16 v[60:63], a[188:191], a[96:99], v[60:63]
    ds_read_b128 a[180:183], v36 offset:46080
    v_mfma_f32_16x16x32_bf16 v[92:95], a[188:191], a[100:103], v[92:95]
    s_waitcnt lgkmcnt(4)
    v_mfma_f32_16x16x32_bf16 v[64:67], a[160:163], a[96:99], v[64:67]
    ds_read_b128 a[184:187], v36 offset:47104
    v_mfma_f32_16x16x32_bf16 v[96:99], a[160:163], a[100:103], v[96:99]
    buffer_load_dwordx4 v253, s[32:35], m0 offen sc1 lds
    s_add_u32 m0, s15, 147456
    v_mfma_f32_16x16x32_bf16 v[68:71], a[164:167], a[96:99], v[68:71]
    ds_read_b128 a[188:191], v36 offset:48128
    v_mfma_f32_16x16x32_bf16 v[100:103], a[164:167], a[100:103], v[100:103]
    s_waitcnt lgkmcnt(4)
    v_mfma_f32_16x16x32_bf16 v[72:75], a[168:171], a[96:99], v[72:75]
    ds_read_b128 a[160:163], v36 offset:49152
    v_mfma_f32_16x16x32_bf16 v[104:107], a[168:171], a[100:103], v[104:107]
    buffer_load_dwordx4 v253, s[32:35], m0 offen sc1 lds
    s_add_u32 m0, s15, 151552
    v_mfma_f32_16x16x32_bf16 v[76:79], a[172:175], a[96:99], v[76:79]
    ds_read_b128 a[164:167], v36 offset:50176
    v_mfma_f32_16x16x32_bf16 v[108:111], a[172:175], a[100:103], v[108:111]
    s_waitcnt lgkmcnt(4)
    v_mfma_f32_16x16x32_bf16 v[48:51], a[176:179], a[104:107], v[48:51]
    ds_read_b128 a[168:171], v36 offset:51200
    v_mfma_f32_16x16x32_bf16 v[80:83], a[176:179], a[108:111], v[80:83]
    buffer_load_dwordx4 v253, s[32:35], m0 offen sc1 lds
    s_add_u32 m0, s15, 155648
    v_mfma_f32_16x16x32_bf16 v[52:55], a[180:183], a[104:107], v[52:55]
    ds_read_b128 a[172:175], v36 offset:52224
    v_mfma_f32_16x16x32_bf16 v[84:87], a[180:183], a[108:111], v[84:87]
    s_waitcnt lgkmcnt(4)
    v_mfma_f32_16x16x32_bf16 v[56:59], a[184:187], a[104:107], v[56:59]
    ds_read_b128 a[176:179], v36 offset:53248
    v_mfma_f32_16x16x32_bf16 v[88:91], a[184:187], a[108:111], v[88:91]
    buffer_load_dwordx4 v253, s[32:35], m0 offen sc1 lds
    s_add_u32 m0, s15, 159744
    v_mfma_f32_16x16x32_bf16 v[60:63], a[188:191], a[104:107], v[60:63]
    ds_read_b128 a[180:183], v36 offset:54272
    v_mfma_f32_16x16x32_bf16 v[92:95], a[188:191], a[108:111], v[92:95]
    s_waitcnt lgkmcnt(4)
    v_mfma_f32_16x16x32_bf16 v[64:67], a[160:163], a[104:107], v[64:67]
    ds_read_b128 a[184:187], v36 offset:55296
    v_mfma_f32_16x16x32_bf16 v[96:99], a[160:163], a[108:111], v[96:99]
    buffer_load_dwordx4 v253, s[32:35], m0 offen sc1 lds
    s_add_u32 m0, s15, 0
    v_mfma_f32_16x16x32_bf16 v[68:71], a[164:167], a[104:107], v[68:71]
    ds_read_b128 a[188:191], v36 offset:56320
    v_mfma_f32_16x16x32_bf16 v[100:103], a[164:167], a[108:111], v[100:103]
    s_waitcnt lgkmcnt(4)
    v_mfma_f32_16x16x32_bf16 v[72:75], a[168:171], a[104:107], v[72:75]
    ds_read_b128 a[160:163], v36 offset:57344
    v_mfma_f32_16x16x32_bf16 v[104:107], a[168:171], a[108:111], v[104:107]
    s_add_u32 s16, s13, 225280
    v_add_u32 v253, s16, v1
    buffer_load_dwordx4 v253, s[32:35], m0 offen sc1 lds
    s_add_u32 m0, s15, 4096
    v_mfma_f32_16x16x32_bf16 v[76:79], a[172:175], a[104:107], v[76:79]
    ds_read_b128 a[164:167], v36 offset:58368
    v_mfma_f32_16x16x32_bf16 v[108:111], a[172:175], a[108:111], v[108:111]
    s_waitcnt lgkmcnt(4)
    v_mfma_f32_16x16x32_bf16 v[48:51], a[176:179], a[112:115], v[48:51]
    ds_read_b128 a[168:171], v36 offset:59392
    v_mfma_f32_16x16x32_bf16 v[80:83], a[176:179], a[116:119], v[80:83]
    buffer_load_dwordx4 v253, s[32:35], m0 offen sc1 lds
    s_add_u32 m0, s15, 8192
    v_mfma_f32_16x16x32_bf16 v[52:55], a[180:183], a[112:115], v[52:55]
    ds_read_b128 a[172:175], v36 offset:60416
    v_mfma_f32_16x16x32_bf16 v[84:87], a[180:183], a[116:119], v[84:87]
    s_waitcnt lgkmcnt(4)
    v_mfma_f32_16x16x32_bf16 v[56:59], a[184:187], a[112:115], v[56:59]
    ds_read_b128 a[176:179], v36 offset:61440
    v_mfma_f32_16x16x32_bf16 v[88:91], a[184:187], a[116:119], v[88:91]
    buffer_load_dwordx4 v253, s[32:35], m0 offen sc1 lds
    s_add_u32 m0, s15, 12288
    v_mfma_f32_16x16x32_bf16 v[60:63], a[188:191], a[112:115], v[60:63]
    ds_read_b128 a[180:183], v36 offset:62464
    v_mfma_f32_16x16x32_bf16 v[92:95], a[188:191], a[116:119], v[92:95]
    s_waitcnt lgkmcnt(4)
    v_mfma_f32_16x16x32_bf16 v[64:67], a[160:163], a[112:115], v[64:67]
    ds_read_b128 a[184:187], v36 offset:63488
    v_mfma_f32_16x16x32_bf16 v[96:99], a[160:163], a[116:119], v[96:99]
    buffer_load_dwordx4 v253, s[32:35], m0 offen sc1 lds
    s_add_u32 m0, s15, 16384
    v_mfma_f32_16x16x32_bf16 v[68:71], a[164:167], a[112:115], v[68:71]
    ds_read_b128 a[188:191], v36 offset:64512
    v_mfma_f32_16x16x32_bf16 v[100:103], a[164:167], a[116:119], v[100:103]
    s_waitcnt lgkmcnt(4)
    v_mfma_f32_16x16x32_bf16 v[72:75], a[168:171], a[112:115], v[72:75]
    ds_read_b128 a[160:163], v37 offset:0
    v_mfma_f32_16x16x32_bf16 v[104:107], a[168:171], a[116:119], v[104:107]
    buffer_load_dwordx4 v253, s[32:35], m0 offen sc1 lds
    s_add_u32 m0, s15, 20480
    v_mfma_f32_16x16x32_bf16 v[76:79], a[172:175], a[112:115], v[76:79]
    ds_read_b128 a[164:167], v37 offset:1024
    v_mfma_f32_16x16x32_bf16 v[108:111], a[172:175], a[116:119], v[108:111]
    s_waitcnt vmcnt(22)
    s_barrier
    s_waitcnt lgkmcnt(4)
    v_mfma_f32_16x16x32_bf16 v[48:51], a[176:179], a[120:123], v[48:51]
    ds_read_b128 a[168:171], v37 offset:2048
    v_mfma_f32_16x16x32_bf16 v[80:83], a[176:179], a[124:127], v[80:83]
    buffer_load_dwordx4 v253, s[32:35], m0 offen sc1 lds
    s_add_u32 m0, s15, 24576
    v_mfma_f32_16x16x32_bf16 v[52:55], a[180:183], a[120:123], v[52:55]
    ds_read_b128 a[172:175], v37 offset:3072
    v_mfma_f32_16x16x32_bf16 v[84:87], a[180:183], a[124:127], v[84:87]
    s_waitcnt lgkmcnt(4)
    v_mfma_f32_16x16x32_bf16 v[56:59], a[184:187], a[120:123], v[56:59]
    ds_read_b128 a[176:179], v37 offset:4096
    v_mfma_f32_16x16x32_bf16 v[88:91], a[184:187], a[124:127], v[88:91]
    buffer_load_dwordx4 v253, s[32:35], m0 offen sc1 lds
    s_add_u32 m0, s15, 28672
    v_mfma_f32_16x16x32_bf16 v[60:63], a[188:191], a[120:123], v[60:63]
    ds_read_b128 a[180:183], v37 offset:5120
    v_mfma_f32_16x16x32_bf16 v[92:95], a[188:191], a[124:127], v[92:95]
    s_waitcnt lgkmcnt(4)
    v_mfma_f32_16x16x32_bf16 v[64:67], a[160:163], a[120:123], v[64:67]
    ds_read_b128 a[184:187], v37 offset:6144
    v_mfma_f32_16x16x32_bf16 v[96:99], a[160:163], a[124:127], v[96:99]
    buffer_load_dwordx4 v253, s[32:35], m0 offen sc1 lds
    s_add_u32 m0, s15, 32768
    v_mfma_f32_16x16x32_bf16 v[68:71], a[164:167], a[120:123], v[68:71]
    ds_read_b128 a[188:191], v37 offset:7168
    v_mfma_f32_16x16x32_bf16 v[100:103], a[164:167], a[124:127], v[100:103]
    s_waitcnt lgkmcnt(4)
    v_mfma_f32_16x16x32_bf16 v[72:75], a[168:171], a[120:123], v[72:75]
    ds_read_b128 a[160:163], v37 offset:8192
    v_mfma_f32_16x16x32_bf16 v[104:107], a[168:171], a[124:127], v[104:107]
    buffer_load_dwordx4 v253, s[32:35], m0 offen sc1 lds
    s_add_u32 m0, s15, 36864
    v_mfma_f32_16x16x32_bf16 v[76:79], a[172:175], a[120:123], v[76:79]
    ds_read_b128 a[164:167], v37 offset:9216
    v_mfma_f32_16x16x32_bf16 v[108:111], a[172:175], a[124:127], v[108:111]
    s_waitcnt lgkmcnt(4)
    v_mfma_f32_16x16x32_bf16 v[48:51], a[176:179], a[128:131], v[48:51]
    ds_read_b128 a[168:171], v37 offset:10240
    v_mfma_f32_16x16x32_bf16 v[80:83], a[176:179], a[132:135], v[80:83]
    buffer_load_dwordx4 v253, s[32:35], m0 offen sc1 lds
    s_add_u32 m0, s15, 40960
    v_mfma_f32_16x16x32_bf16 v[52:55], a[180:183], a[128:131], v[52:55]
    ds_read_b128 a[172:175], v37 offset:11264
    v_mfma_f32_16x16x32_bf16 v[84:87], a[180:183], a[132:135], v[84:87]
    s_waitcnt lgkmcnt(4)
    v_mfma_f32_16x16x32_bf16 v[56:59], a[184:187], a[128:131], v[56:59]
    ds_read_b128 a[176:179], v37 offset:12288
    v_mfma_f32_16x16x32_bf16 v[88:91], a[184:187], a[132:135], v[88:91]
    buffer_load_dwordx4 v253, s[32:35], m0 offen sc1 lds
    s_add_u32 m0, s15, 45056
    v_mfma_f32_16x16x32_bf16 v[60:63], a[188:191], a[128:131], v[60:63]
    ds_read_b128 a[180:183], v37 offset:13312
    v_mfma_f32_16x16x32_bf16 v[92:95], a[188:191], a[132:135], v[92:95]
    s_waitcnt lgkmcnt(4)
    v_mfma_f32_16x16x32_bf16 v[64:67], a[160:163], a[128:131], v[64:67]
    ds_read_b128 a[184:187], v37 offset:14336
    v_mfma_f32_16x16x32_bf16 v[96:99], a[160:163], a[132:135], v[96:99]
    buffer_load_dwordx4 v253, s[32:35], m0 offen sc1 lds
    s_add_u32 m0, s15, 49152
    v_mfma_f32_16x16x32_bf16 v[68:71], a[164:167], a[128:131], v[68:71]
    ds_read_b128 a[188:191], v37 offset:15360
    v_mfma_f32_16x16x32_bf16 v[100:103], a[164:167], a[132:135], v[100:103]
    s_waitcnt lgkmcnt(4)
    v_mfma_f32_16x16x32_bf16 v[72:75], a[168:171], a[128:131], v[72:75]
    ds_read_b128 a[160:163], v37 offset:16384
    v_mfma_f32_16x16x32_bf16 v[104:107], a[168:171], a[132:135], v[104:107]
    buffer_load_dwordx4 v253, s[32:35], m0 offen sc1 lds
    s_add_u32 m0, s15, 53248
    v_mfma_f32_16x16x32_bf16 v[76:79], a[172:175], a[128:131], v[76:79]
    ds_read_b128 a[164:167], v37 offset:17408
    v_mfma_f32_16x16x32_bf16 v[108:111], a[172:175], a[132:135], v[108:111]
    s_waitcnt lgkmcnt(4)
    v_mfma_f32_16x16x32_bf16 v[48:51], a[176:179], a[136:139], v[48:51]
    ds_read_b128 a[168:171], v37 offset:18432
    v_mfma_f32_16x16x32_bf16 v[80:83], a[176:179], a[140:143], v[80:83]
    buffer_load_dwordx4 v253, s[32:35], m0 offen sc1 lds
    s_add_u32 m0, s15, 57344
    v_mfma_f32_16x16x32_bf16 v[52:55], a[180:183], a[136:139], v[52:55]
    ds_read_b128 a[172:175], v37 offset:19456
    v_mfma_f32_16x16x32_bf16 v[84:87], a[180:183], a[140:143], v[84:87]
    s_waitcnt lgkmcnt(4)
    v_mfma_f32_16x16x32_bf16 v[56:59], a[184:187], a[136:139], v[56:59]
    ds_read_b128 a[176:179], v37 offset:20480
    v_mfma_f32_16x16x32_bf16 v[88:91], a[184:187], a[140:143], v[88:91]
    buffer_load_dwordx4 v253, s[32:35], m0 offen sc1 lds
    s_add_u32 m0, s15, 61440
    v_mfma_f32_16x16x32_bf16 v[60:63], a[188:191], a[136:139], v[60:63]
    ds_read_b128 a[180:183], v37 offset:21504
    v_mfma_f32_16x16x32_bf16 v[92:95], a[188:191], a[140:143], v[92:95]
    s_waitcnt lgkmcnt(4)
    v_mfma_f32_16x16x32_bf16 v[64:67], a[160:163], a[136:139], v[64:67]
    ds_read_b128 a[184:187], v37 offset:22528
    v_mfma_f32_16x16x32_bf16 v[96:99], a[160:163], a[140:143], v[96:99]
    v_mfma_f32_16x16x32_bf16 v[68:71], a[164:167], a[136:139], v[68:71]
    ds_read_b128 a[188:191], v37 offset:23552
    v_mfma_f32_16x16x32_bf16 v[100:103], a[164:167], a[140:143], v[100:103]
    s_waitcnt lgkmcnt(4)
    v_mfma_f32_16x16x32_bf16 v[72:75], a[168:171], a[136:139], v[72:75]
    ds_read_b128 a[160:163], v37 offset:24576
    v_mfma_f32_16x16x32_bf16 v[104:107], a[168:171], a[140:143], v[104:107]
    v_mfma_f32_16x16x32_bf16 v[76:79], a[172:175], a[136:139], v[76:79]
    ds_read_b128 a[164:167], v37 offset:25600
    v_mfma_f32_16x16x32_bf16 v[108:111], a[172:175], a[140:143], v[108:111]
    s_waitcnt vmcnt(25)
    s_barrier
    s_waitcnt lgkmcnt(4)
    v_mfma_f32_16x16x32_bf16 v[48:51], a[176:179], a[144:147], v[48:51]
    ds_read_b128 a[168:171], v37 offset:26624
    v_mfma_f32_16x16x32_bf16 v[80:83], a[176:179], a[148:151], v[80:83]
    buffer_load_dwordx4 v1, s[32:35], s14 offen sc1 lds
    s_add_u32 s14, s14, 1024
    s_add_u32 m0, s15, 65536
    v_mfma_f32_16x16x32_bf16 v[52:55], a[180:183], a[144:147], v[52:55]
    ds_read_b128 a[172:175], v37 offset:27648
    v_mfma_f32_16x16x32_bf16 v[84:87], a[180:183], a[148:151], v[84:87]
    s_waitcnt lgkmcnt(4)
    v_mfma_f32_16x16x32_bf16 v[56:59], a[184:187], a[144:147], v[56:59]
    ds_read_b128 a[176:179], v37 offset:28672
    v_mfma_f32_16x16x32_bf16 v[88:91], a[184:187], a[148:151], v[88:91]
    buffer_load_dwordx4 v1, s[32:35], s14 offen sc1 lds
    s_add_u32 s14, s14, 1024
    s_add_u32 m0, s15, 69632
    v_mfma_f32_16x16x32_bf16 v[60:63], a[188:191], a[144:147], v[60:63]
    ds_read_b128 a[180:183], v37 offset:29696
    v_mfma_f32_16x16x32_bf16 v[92:95], a[188:191], a[148:151], v[92:95]
    s_waitcnt lgkmcnt(4)
    v_mfma_f32_16x16x32_bf16 v[64:67], a[160:163], a[144:147], v[64:67]
    ds_read_b128 a[184:187], v37 offset:30720
    v_mfma_f32_16x16x32_bf16 v[96:99], a[160:163], a[148:151], v[96:99]
    buffer_load_dwordx4 v1, s[32:35], s14 offen sc1 lds
    s_add_u32 s14, s14, 1024
    s_add_u32 m0, s15, 73728
    v_mfma_f32_16x16x32_bf16 v[68:71], a[164:167], a[144:147], v[68:71]
    ds_read_b128 a[188:191], v37 offset:31744
    v_mfma_f32_16x16x32_bf16 v[100:103], a[164:167], a[148:151], v[100:103]
    s_waitcnt lgkmcnt(4)
    v_mfma_f32_16x16x32_bf16 v[72:75], a[168:171], a[144:147], v[72:75]
    ds_read_b128 a[160:163], v37 offset:32768
    v_mfma_f32_16x16x32_bf16 v[104:107], a[168:171], a[148:151], v[104:107]
    buffer_load_dwordx4 v1, s[32:35], s14 offen sc1 lds
    s_add_u32 s14, s14, 1024
    s_add_u32 m0, s15, 77824
    v_mfma_f32_16x16x32_bf16 v[76:79], a[172:175], a[144:147], v[76:79]
    ds_read_b128 a[164:167], v37 offset:33792
    v_mfma_f32_16x16x32_bf16 v[108:111], a[172:175], a[148:151], v[108:111]
    s_waitcnt lgkmcnt(4)
    v_mfma_f32_16x16x32_bf16 v[48:51], a[176:179], a[152:155], v[48:51]
    ds_read_b128 a[168:171], v37 offset:34816
    v_mfma_f32_16x16x32_bf16 v[80:83], a[176:179], a[156:159], v[80:83]
    buffer_load_dwordx4 v1, s[32:35], s14 offen sc1 lds
    s_add_u32 s14, s14, 1024
    s_add_u32 m0, s15, 81920
    v_mfma_f32_16x16x32_bf16 v[52:55], a[180:183], a[152:155], v[52:55]
    ds_read_b128 a[172:175], v37 offset:35840
    v_mfma_f32_16x16x32_bf16 v[84:87], a[180:183], a[156:159], v[84:87]
    s_waitcnt lgkmcnt(4)
    v_mfma_f32_16x16x32_bf16 v[56:59], a[184:187], a[152:155], v[56:59]
    ds_read_b128 a[176:179], v37 offset:36864
    v_mfma_f32_16x16x32_bf16 v[88:91], a[184:187], a[156:159], v[88:91]
    buffer_load_dwordx4 v1, s[32:35], s14 offen sc1 lds
    s_add_u32 s14, s14, 1024
    s_add_u32 m0, s15, 86016
    v_mfma_f32_16x16x32_bf16 v[60:63], a[188:191], a[152:155], v[60:63]
    ds_read_b128 a[180:183], v37 offset:37888
    v_mfma_f32_16x16x32_bf16 v[92:95], a[188:191], a[156:159], v[92:95]
    s_waitcnt lgkmcnt(4)
    v_mfma_f32_16x16x32_bf16 v[64:67], a[160:163], a[152:155], v[64:67]
    ds_read_b128 a[184:187], v37 offset:38912
    v_mfma_f32_16x16x32_bf16 v[96:99], a[160:163], a[156:159], v[96:99]
    v_mfma_f32_16x16x32_bf16 v[68:71], a[164:167], a[152:155], v[68:71]
    ds_read_b128 a[188:191], v37 offset:39936
    v_mfma_f32_16x16x32_bf16 v[100:103], a[164:167], a[156:159], v[100:103]
    s_waitcnt lgkmcnt(4)
    v_mfma_f32_16x16x32_bf16 v[72:75], a[168:171], a[152:155], v[72:75]
    ds_read_b128 a[160:163], v37 offset:40960
    v_mfma_f32_16x16x32_bf16 v[104:107], a[168:171], a[156:159], v[104:107]
    v_mfma_f32_16x16x32_bf16 v[76:79], a[172:175], a[152:155], v[76:79]
    ds_read_b128 a[164:167], v37 offset:41984
    v_mfma_f32_16x16x32_bf16 v[108:111], a[172:175], a[156:159], v[108:111]
    v_pk_mul_f32 v[160:161], v[48:49], s[66:67] neg_lo:[1,0] neg_hi:[1,0]
    v_pk_mul_f32 v[162:163], v[50:51], s[66:67] neg_lo:[1,0] neg_hi:[1,0]
    v_pk_mul_f32 v[164:165], v[56:57], s[66:67] neg_lo:[1,0] neg_hi:[1,0]
    v_pk_mul_f32 v[166:167], v[58:59], s[66:67] neg_lo:[1,0] neg_hi:[1,0]
    v_exp_f32 v160, v160
    v_exp_f32 v161, v161
    v_exp_f32 v162, v162
    v_exp_f32 v163, v163
    v_exp_f32 v164, v164
    v_exp_f32 v165, v165
    v_exp_f32 v166, v166
    v_exp_f32 v167, v167
    v_pk_mul_f32 v[48:49], v[48:49], v[52:53]
    v_pk_mul_f32 v[50:51], v[50:51], v[54:55]
    v_pk_mul_f32 v[56:57], v[56:57], v[60:61]
    v_pk_mul_f32 v[58:59], v[58:59], v[62:63]
    v_pk_add_f32 v[160:161], v[160:161], 1.0 op_sel_hi:[1,0]
    v_pk_add_f32 v[162:163], v[162:163], 1.0 op_sel_hi:[1,0]
    v_pk_add_f32 v[164:165], v[164:165], 1.0 op_sel_hi:[1,0]
    v_pk_add_f32 v[166:167], v[166:167], 1.0 op_sel_hi:[1,0]
    v_rcp_f32 v160, v160
    v_rcp_f32 v161, v161
    v_rcp_f32 v162, v162
    v_rcp_f32 v163, v163
    v_rcp_f32 v164, v164
    v_rcp_f32 v165, v165
    v_rcp_f32 v166, v166
    v_rcp_f32 v167, v167
    v_pk_mul_f32 v[48:49], v[48:49], v[160:161]
    v_pk_mul_f32 v[50:51], v[50:51], v[162:163]
    v_pk_mul_f32 v[56:57], v[56:57], v[164:165]
    v_pk_mul_f32 v[58:59], v[58:59], v[166:167]
    v_cvt_pk_bf16_f32 v52, v48, v49
    v_cvt_pk_bf16_f32 v53, v50, v51
    v_cvt_pk_bf16_f32 v54, v56, v57
    v_cvt_pk_bf16_f32 v55, v58, v59
    buffer_store_dwordx4 v[52:55], v1, s[32:35], s78 offen offset:0 sc1
    v_pk_mul_f32 v[168:169], v[64:65], s[66:67] neg_lo:[1,0] neg_hi:[1,0]
    v_pk_mul_f32 v[170:171], v[66:67], s[66:67] neg_lo:[1,0] neg_hi:[1,0]
    v_pk_mul_f32 v[172:173], v[72:73], s[66:67] neg_lo:[1,0] neg_hi:[1,0]
    v_pk_mul_f32 v[174:175], v[74:75], s[66:67] neg_lo:[1,0] neg_hi:[1,0]
    v_exp_f32 v168, v168
    v_exp_f32 v169, v169
    v_exp_f32 v170, v170
    v_exp_f32 v171, v171
    v_exp_f32 v172, v172
    v_exp_f32 v173, v173
    v_exp_f32 v174, v174
    v_exp_f32 v175, v175
    v_pk_mul_f32 v[64:65], v[64:65], v[68:69]
    v_pk_mul_f32 v[66:67], v[66:67], v[70:71]
    v_pk_mul_f32 v[72:73], v[72:73], v[76:77]
    v_pk_mul_f32 v[74:75], v[74:75], v[78:79]
    v_pk_add_f32 v[168:169], v[168:169], 1.0 op_sel_hi:[1,0]
    v_pk_add_f32 v[170:171], v[170:171], 1.0 op_sel_hi:[1,0]
    v_pk_add_f32 v[172:173], v[172:173], 1.0 op_sel_hi:[1,0]
    v_pk_add_f32 v[174:175], v[174:175], 1.0 op_sel_hi:[1,0]
    v_rcp_f32 v168, v168
    v_rcp_f32 v169, v169
    v_rcp_f32 v170, v170
    v_rcp_f32 v171, v171
    v_rcp_f32 v172, v172
    v_rcp_f32 v173, v173
    v_rcp_f32 v174, v174
    v_rcp_f32 v175, v175
    v_pk_mul_f32 v[64:65], v[64:65], v[168:169]
    v_pk_mul_f32 v[66:67], v[66:67], v[170:171]
    v_pk_mul_f32 v[72:73], v[72:73], v[172:173]
    v_pk_mul_f32 v[74:75], v[74:75], v[174:175]
    v_cvt_pk_bf16_f32 v68, v64, v65
    v_cvt_pk_bf16_f32 v69, v66, v67
    v_cvt_pk_bf16_f32 v70, v72, v73
    v_cvt_pk_bf16_f32 v71, v74, v75
    buffer_store_dwordx4 v[68:71], v1, s[32:35], s78 offen offset:1024 sc1
    v_pk_mul_f32 v[160:161], v[80:81], s[66:67] neg_lo:[1,0] neg_hi:[1,0]
    v_pk_mul_f32 v[162:163], v[82:83], s[66:67] neg_lo:[1,0] neg_hi:[1,0]
    v_pk_mul_f32 v[164:165], v[88:89], s[66:67] neg_lo:[1,0] neg_hi:[1,0]
    v_pk_mul_f32 v[166:167], v[90:91], s[66:67] neg_lo:[1,0] neg_hi:[1,0]
    v_exp_f32 v160, v160
    v_exp_f32 v161, v161
    v_exp_f32 v162, v162
    v_exp_f32 v163, v163
    v_exp_f32 v164, v164
    v_exp_f32 v165, v165
    v_exp_f32 v166, v166
    v_exp_f32 v167, v167
    v_pk_mul_f32 v[80:81], v[80:81], v[84:85]
    v_pk_mul_f32 v[82:83], v[82:83], v[86:87]
    v_pk_mul_f32 v[88:89], v[88:89], v[92:93]
    v_pk_mul_f32 v[90:91], v[90:91], v[94:95]
    v_pk_add_f32 v[160:161], v[160:161], 1.0 op_sel_hi:[1,0]
    v_pk_add_f32 v[162:163], v[162:163], 1.0 op_sel_hi:[1,0]
    v_pk_add_f32 v[164:165], v[164:165], 1.0 op_sel_hi:[1,0]
    v_pk_add_f32 v[166:167], v[166:167], 1.0 op_sel_hi:[1,0]
    v_rcp_f32 v160, v160
    v_rcp_f32 v161, v161
    v_rcp_f32 v162, v162
    v_rcp_f32 v163, v163
    v_rcp_f32 v164, v164
    v_rcp_f32 v165, v165
    v_rcp_f32 v166, v166
    v_rcp_f32 v167, v167
    v_pk_mul_f32 v[80:81], v[80:81], v[160:161]
    v_pk_mul_f32 v[82:83], v[82:83], v[162:163]
    v_pk_mul_f32 v[88:89], v[88:89], v[164:165]
    v_pk_mul_f32 v[90:91], v[90:91], v[166:167]
    v_cvt_pk_bf16_f32 v84, v80, v81
    v_cvt_pk_bf16_f32 v85, v82, v83
    v_cvt_pk_bf16_f32 v86, v88, v89
    v_cvt_pk_bf16_f32 v87, v90, v91
    buffer_store_dwordx4 v[84:87], v44, s[32:35], s78 offen offset:0 sc1
    v_pk_mul_f32 v[168:169], v[96:97], s[66:67] neg_lo:[1,0] neg_hi:[1,0]
    v_pk_mul_f32 v[170:171], v[98:99], s[66:67] neg_lo:[1,0] neg_hi:[1,0]
    v_pk_mul_f32 v[172:173], v[104:105], s[66:67] neg_lo:[1,0] neg_hi:[1,0]
    v_pk_mul_f32 v[174:175], v[106:107], s[66:67] neg_lo:[1,0] neg_hi:[1,0]
    v_exp_f32 v168, v168
    v_exp_f32 v169, v169
    v_exp_f32 v170, v170
    v_exp_f32 v171, v171
    v_exp_f32 v172, v172
    v_exp_f32 v173, v173
    v_exp_f32 v174, v174
    v_exp_f32 v175, v175
    v_pk_mul_f32 v[96:97], v[96:97], v[100:101]
    v_pk_mul_f32 v[98:99], v[98:99], v[102:103]
    v_pk_mul_f32 v[104:105], v[104:105], v[108:109]
    v_pk_mul_f32 v[106:107], v[106:107], v[110:111]
    v_pk_add_f32 v[168:169], v[168:169], 1.0 op_sel_hi:[1,0]
    v_pk_add_f32 v[170:171], v[170:171], 1.0 op_sel_hi:[1,0]
    v_pk_add_f32 v[172:173], v[172:173], 1.0 op_sel_hi:[1,0]
    v_pk_add_f32 v[174:175], v[174:175], 1.0 op_sel_hi:[1,0]
    v_rcp_f32 v168, v168
    v_rcp_f32 v169, v169
    v_rcp_f32 v170, v170
    v_rcp_f32 v171, v171
    v_rcp_f32 v172, v172
    v_rcp_f32 v173, v173
    v_rcp_f32 v174, v174
    v_rcp_f32 v175, v175
    v_pk_mul_f32 v[96:97], v[96:97], v[168:169]
    v_pk_mul_f32 v[98:99], v[98:99], v[170:171]
    v_pk_mul_f32 v[104:105], v[104:105], v[172:173]
    v_pk_mul_f32 v[106:107], v[106:107], v[174:175]
    v_cvt_pk_bf16_f32 v100, v96, v97
    v_cvt_pk_bf16_f32 v101, v98, v99
    v_cvt_pk_bf16_f32 v102, v104, v105
    v_cvt_pk_bf16_f32 v103, v106, v107
    buffer_store_dwordx4 v[100:103], v44, s[32:35], s78 offen offset:1024 sc1
    s_waitcnt lgkmcnt(4)
    v_mfma_f32_16x16x32_bf16 v[112:115], a[176:179], a[0:3], 0
    ds_read_b128 a[168:171], v37 offset:43008
    v_mfma_f32_16x16x32_bf16 v[136:139], a[176:179], a[4:7], 0
    v_mfma_f32_16x16x32_bf16 v[116:119], a[180:183], a[0:3], 0
    ds_read_b128 a[172:175], v37 offset:44032
    v_mfma_f32_16x16x32_bf16 v[140:143], a[180:183], a[4:7], 0
    s_waitcnt lgkmcnt(4)
    v_mfma_f32_16x16x32_bf16 v[120:123], a[184:187], a[0:3], 0
    ds_read_b128 a[176:179], v37 offset:45056
    v_mfma_f32_16x16x32_bf16 v[144:147], a[184:187], a[4:7], 0
    v_mfma_f32_16x16x32_bf16 v[124:127], a[188:191], a[0:3], 0
    ds_read_b128 a[180:183], v37 offset:46080
    v_mfma_f32_16x16x32_bf16 v[148:151], a[188:191], a[4:7], 0
    s_waitcnt lgkmcnt(4)
    v_mfma_f32_16x16x32_bf16 v[128:131], a[160:163], a[0:3], 0
    ds_read_b128 a[184:187], v37 offset:47104
    v_mfma_f32_16x16x32_bf16 v[152:155], a[160:163], a[4:7], 0
    v_mfma_f32_16x16x32_bf16 v[132:135], a[164:167], a[0:3], 0
    ds_read_b128 a[188:191], v37 offset:48128
    v_mfma_f32_16x16x32_bf16 v[156:159], a[164:167], a[4:7], 0
    s_waitcnt lgkmcnt(4)
    v_mfma_f32_16x16x32_bf16 v[112:115], a[168:171], a[8:11], v[112:115]
    ds_read_b128 a[160:163], v37 offset:49152
    v_mfma_f32_16x16x32_bf16 v[136:139], a[168:171], a[12:15], v[136:139]
    v_mfma_f32_16x16x32_bf16 v[116:119], a[172:175], a[8:11], v[116:119]
    ds_read_b128 a[164:167], v37 offset:50176
    v_mfma_f32_16x16x32_bf16 v[140:143], a[172:175], a[12:15], v[140:143]
    s_waitcnt vmcnt(29)
    s_barrier
    s_waitcnt lgkmcnt(4)
    v_mfma_f32_16x16x32_bf16 v[120:123], a[176:179], a[8:11], v[120:123]
    ds_read_b128 a[168:171], v37 offset:51200
    v_mfma_f32_16x16x32_bf16 v[144:147], a[176:179], a[12:15], v[144:147]
    buffer_load_dwordx4 v1, s[32:35], s14 offen sc1 lds
    s_add_u32 s14, s14, 1024
    s_add_u32 m0, s15, 90112
    v_mfma_f32_16x16x32_bf16 v[124:127], a[180:183], a[8:11], v[124:127]
    ds_read_b128 a[172:175], v37 offset:52224
    v_mfma_f32_16x16x32_bf16 v[148:151], a[180:183], a[12:15], v[148:151]
    s_waitcnt lgkmcnt(4)
    v_mfma_f32_16x16x32_bf16 v[128:131], a[184:187], a[8:11], v[128:131]
    ds_read_b128 a[176:179], v37 offset:53248
    v_mfma_f32_16x16x32_bf16 v[152:155], a[184:187], a[12:15], v[152:155]
    buffer_load_dwordx4 v1, s[32:35], s14 offen sc1 lds
    s_add_u32 s14, s14, 1024
    s_add_u32 m0, s15, 94208
    v_mfma_f32_16x16x32_bf16 v[132:135], a[188:191], a[8:11], v[132:135]
    ds_read_b128 a[180:183], v37 offset:54272
    v_mfma_f32_16x16x32_bf16 v[156:159], a[188:191], a[12:15], v[156:159]
    s_waitcnt lgkmcnt(4)
    v_mfma_f32_16x16x32_bf16 v[112:115], a[160:163], a[16:19], v[112:115]
    ds_read_b128 a[184:187], v37 offset:55296
    v_mfma_f32_16x16x32_bf16 v[136:139], a[160:163], a[20:23], v[136:139]
    buffer_load_dwordx4 v1, s[32:35], s14 offen sc1 lds
    s_add_u32 s14, s14, 1024
    s_add_u32 m0, s15, 98304
    v_mfma_f32_16x16x32_bf16 v[116:119], a[164:167], a[16:19], v[116:119]
    ds_read_b128 a[188:191], v37 offset:56320
    v_mfma_f32_16x16x32_bf16 v[140:143], a[164:167], a[20:23], v[140:143]
    s_waitcnt lgkmcnt(4)
    v_mfma_f32_16x16x32_bf16 v[120:123], a[168:171], a[16:19], v[120:123]
    ds_read_b128 a[160:163], v37 offset:57344
    v_mfma_f32_16x16x32_bf16 v[144:147], a[168:171], a[20:23], v[144:147]
    buffer_load_dwordx4 v1, s[32:35], s14 offen sc1 lds
    s_add_u32 s14, s14, 1024
    s_add_u32 m0, s15, 102400
    v_mfma_f32_16x16x32_bf16 v[124:127], a[172:175], a[16:19], v[124:127]
    ds_read_b128 a[164:167], v37 offset:58368
    v_mfma_f32_16x16x32_bf16 v[148:151], a[172:175], a[20:23], v[148:151]
    s_waitcnt lgkmcnt(4)
    v_mfma_f32_16x16x32_bf16 v[128:131], a[176:179], a[16:19], v[128:131]
    ds_read_b128 a[168:171], v37 offset:59392
    v_mfma_f32_16x16x32_bf16 v[152:155], a[176:179], a[20:23], v[152:155]
    buffer_load_dwordx4 v1, s[32:35], s14 offen sc1 lds
    s_add_u32 s14, s14, 1024
    s_add_u32 m0, s15, 106496
    v_mfma_f32_16x16x32_bf16 v[132:135], a[180:183], a[16:19], v[132:135]
    ds_read_b128 a[172:175], v37 offset:60416
    v_mfma_f32_16x16x32_bf16 v[156:159], a[180:183], a[20:23], v[156:159]
    s_waitcnt lgkmcnt(4)
    v_mfma_f32_16x16x32_bf16 v[112:115], a[184:187], a[24:27], v[112:115]
    ds_read_b128 a[176:179], v37 offset:61440
    v_mfma_f32_16x16x32_bf16 v[136:139], a[184:187], a[28:31], v[136:139]
    buffer_load_dwordx4 v1, s[32:35], s14 offen sc1 lds
    s_add_u32 s14, s14, 1024
    s_add_u32 m0, s15, 110592
    v_mfma_f32_16x16x32_bf16 v[116:119], a[188:191], a[24:27], v[116:119]
    ds_read_b128 a[180:183], v37 offset:62464
    v_mfma_f32_16x16x32_bf16 v[140:143], a[188:191], a[28:31], v[140:143]
    s_waitcnt lgkmcnt(4)
    v_mfma_f32_16x16x32_bf16 v[120:123], a[160:163], a[24:27], v[120:123]
    ds_read_b128 a[184:187], v37 offset:63488
    v_mfma_f32_16x16x32_bf16 v[144:147], a[160:163], a[28:31], v[144:147]
    v_mfma_f32_16x16x32_bf16 v[124:127], a[164:167], a[24:27], v[124:127]
    ds_read_b128 a[188:191], v37 offset:64512
    v_mfma_f32_16x16x32_bf16 v[148:151], a[164:167], a[28:31], v[148:151]
    s_waitcnt lgkmcnt(4)
    v_mfma_f32_16x16x32_bf16 v[128:131], a[168:171], a[24:27], v[128:131]
    ds_read_b128 a[160:163], v38 offset:0
    v_mfma_f32_16x16x32_bf16 v[152:155], a[168:171], a[28:31], v[152:155]
    v_mfma_f32_16x16x32_bf16 v[132:135], a[172:175], a[24:27], v[132:135]
    ds_read_b128 a[164:167], v38 offset:1024
    v_mfma_f32_16x16x32_bf16 v[156:159], a[172:175], a[28:31], v[156:159]
    s_waitcnt lgkmcnt(4)
    v_mfma_f32_16x16x32_bf16 v[112:115], a[176:179], a[32:35], v[112:115]
    ds_read_b128 a[168:171], v38 offset:2048
    v_mfma_f32_16x16x32_bf16 v[136:139], a[176:179], a[36:39], v[136:139]
    v_mfma_f32_16x16x32_bf16 v[116:119], a[180:183], a[32:35], v[116:119]
    ds_read_b128 a[172:175], v38 offset:3072
    v_mfma_f32_16x16x32_bf16 v[140:143], a[180:183], a[36:39], v[140:143]
    s_waitcnt lgkmcnt(4)
    v_mfma_f32_16x16x32_bf16 v[120:123], a[184:187], a[32:35], v[120:123]
    ds_read_b128 a[176:179], v38 offset:4096
    v_mfma_f32_16x16x32_bf16 v[144:147], a[184:187], a[36:39], v[144:147]
    v_mfma_f32_16x16x32_bf16 v[124:127], a[188:191], a[32:35], v[124:127]
    ds_read_b128 a[180:183], v38 offset:5120
    v_mfma_f32_16x16x32_bf16 v[148:151], a[188:191], a[36:39], v[148:151]
    s_waitcnt lgkmcnt(4)
    v_mfma_f32_16x16x32_bf16 v[128:131], a[160:163], a[32:35], v[128:131]
    ds_read_b128 a[184:187], v38 offset:6144
    v_mfma_f32_16x16x32_bf16 v[152:155], a[160:163], a[36:39], v[152:155]
    v_mfma_f32_16x16x32_bf16 v[132:135], a[164:167], a[32:35], v[132:135]
    ds_read_b128 a[188:191], v38 offset:7168
    v_mfma_f32_16x16x32_bf16 v[156:159], a[164:167], a[36:39], v[156:159]
    s_waitcnt lgkmcnt(4)
    v_mfma_f32_16x16x32_bf16 v[112:115], a[168:171], a[40:43], v[112:115]
    ds_read_b128 a[160:163], v38 offset:8192
    v_mfma_f32_16x16x32_bf16 v[136:139], a[168:171], a[44:47], v[136:139]
    v_mfma_f32_16x16x32_bf16 v[116:119], a[172:175], a[40:43], v[116:119]
    ds_read_b128 a[164:167], v38 offset:9216
    v_mfma_f32_16x16x32_bf16 v[140:143], a[172:175], a[44:47], v[140:143]
    s_waitcnt vmcnt(6)
    s_barrier
    s_mov_b64 exec, 1
    buffer_store_dwordx2 v[2:3], off, s[32:35], s80 sc1
    s_mov_b64 exec, -1
    s_waitcnt lgkmcnt(4)
    v_mfma_f32_16x16x32_bf16 v[120:123], a[176:179], a[40:43], v[120:123]
    ds_read_b128 a[168:171], v38 offset:10240
    v_mfma_f32_16x16x32_bf16 v[144:147], a[176:179], a[44:47], v[144:147]
    buffer_load_dwordx4 v1, s[32:35], s14 offen sc1 lds
    s_add_u32 s14, s14, 1024
    s_add_u32 m0, s15, 114688
    v_mfma_f32_16x16x32_bf16 v[124:127], a[180:183], a[40:43], v[124:127]
    ds_read_b128 a[172:175], v38 offset:11264
    v_mfma_f32_16x16x32_bf16 v[148:151], a[180:183], a[44:47], v[148:151]
    s_waitcnt lgkmcnt(4)
    v_mfma_f32_16x16x32_bf16 v[128:131], a[184:187], a[40:43], v[128:131]
    ds_read_b128 a[176:179], v38 offset:12288
    v_mfma_f32_16x16x32_bf16 v[152:155], a[184:187], a[44:47], v[152:155]
    buffer_load_dwordx4 v1, s[32:35], s14 offen sc1 lds
    s_add_u32 s14, s14, 1024
    s_add_u32 m0, s15, 118784
    v_mfma_f32_16x16x32_bf16 v[132:135], a[188:191], a[40:43], v[132:135]
    ds_read_b128 a[180:183], v38 offset:13312
    v_mfma_f32_16x16x32_bf16 v[156:159], a[188:191], a[44:47], v[156:159]
    s_waitcnt lgkmcnt(4)
    v_mfma_f32_16x16x32_bf16 v[112:115], a[160:163], a[48:51], v[112:115]
    ds_read_b128 a[184:187], v38 offset:14336
    v_mfma_f32_16x16x32_bf16 v[136:139], a[160:163], a[52:55], v[136:139]
    buffer_load_dwordx4 v1, s[32:35], s14 offen sc1 lds
    s_add_u32 s14, s14, 1024
    s_add_u32 m0, s15, 122880
    v_mfma_f32_16x16x32_bf16 v[116:119], a[164:167], a[48:51], v[116:119]
    ds_read_b128 a[188:191], v38 offset:15360
    v_mfma_f32_16x16x32_bf16 v[140:143], a[164:167], a[52:55], v[140:143]
    s_waitcnt lgkmcnt(4)
    v_mfma_f32_16x16x32_bf16 v[120:123], a[168:171], a[48:51], v[120:123]
    ds_read_b128 a[160:163], v38 offset:16384
    v_mfma_f32_16x16x32_bf16 v[144:147], a[168:171], a[52:55], v[144:147]
    buffer_load_dwordx4 v1, s[32:35], s14 offen sc1 lds
    s_add_u32 s14, s14, 1024
    s_add_u32 m0, s15, 126976
    v_mfma_f32_16x16x32_bf16 v[124:127], a[172:175], a[48:51], v[124:127]
    ds_read_b128 a[164:167], v38 offset:17408
    v_mfma_f32_16x16x32_bf16 v[148:151], a[172:175], a[52:55], v[148:151]
    s_waitcnt lgkmcnt(4)
    v_mfma_f32_16x16x32_bf16 v[128:131], a[176:179], a[48:51], v[128:131]
    ds_read_b128 a[168:171], v38 offset:18432
    v_mfma_f32_16x16x32_bf16 v[152:155], a[176:179], a[52:55], v[152:155]
    buffer_load_dwordx4 v1, s[32:35], s14 offen sc1 lds
    s_add_u32 s14, s14, 1024
    s_add_u32 m0, s15, 131072
    v_mfma_f32_16x16x32_bf16 v[132:135], a[180:183], a[48:51], v[132:135]
    ds_read_b128 a[172:175], v38 offset:19456
    v_mfma_f32_16x16x32_bf16 v[156:159], a[180:183], a[52:55], v[156:159]
    s_waitcnt lgkmcnt(4)
    v_mfma_f32_16x16x32_bf16 v[112:115], a[184:187], a[56:59], v[112:115]
    ds_read_b128 a[176:179], v38 offset:20480
    v_mfma_f32_16x16x32_bf16 v[136:139], a[184:187], a[60:63], v[136:139]
    buffer_load_dwordx4 v1, s[32:35], s14 offen sc1 lds
    s_add_u32 s14, s14, 1024
    s_add_u32 m0, s15, 135168
    v_mfma_f32_16x16x32_bf16 v[116:119], a[188:191], a[56:59], v[116:119]
    ds_read_b128 a[180:183], v38 offset:21504
    v_mfma_f32_16x16x32_bf16 v[140:143], a[188:191], a[60:63], v[140:143]
    s_waitcnt lgkmcnt(4)
    v_mfma_f32_16x16x32_bf16 v[120:123], a[160:163], a[56:59], v[120:123]
    ds_read_b128 a[184:187], v38 offset:22528
    v_mfma_f32_16x16x32_bf16 v[144:147], a[160:163], a[60:63], v[144:147]
    v_mfma_f32_16x16x32_bf16 v[124:127], a[164:167], a[56:59], v[124:127]
    ds_read_b128 a[188:191], v38 offset:23552
    v_mfma_f32_16x16x32_bf16 v[148:151], a[164:167], a[60:63], v[148:151]
    s_waitcnt lgkmcnt(4)
    v_mfma_f32_16x16x32_bf16 v[128:131], a[168:171], a[56:59], v[128:131]
    ds_read_b128 a[160:163], v38 offset:24576
    v_mfma_f32_16x16x32_bf16 v[152:155], a[168:171], a[60:63], v[152:155]
    v_mfma_f32_16x16x32_bf16 v[132:135], a[172:175], a[56:59], v[132:135]
    ds_read_b128 a[164:167], v38 offset:25600
    v_mfma_f32_16x16x32_bf16 v[156:159], a[172:175], a[60:63], v[156:159]
    s_waitcnt lgkmcnt(4)
    v_mfma_f32_16x16x32_bf16 v[112:115], a[176:179], a[64:67], v[112:115]
    ds_read_b128 a[168:171], v38 offset:26624
    v_mfma_f32_16x16x32_bf16 v[136:139], a[176:179], a[68:71], v[136:139]
    v_mfma_f32_16x16x32_bf16 v[116:119], a[180:183], a[64:67], v[116:119]
    ds_read_b128 a[172:175], v38 offset:27648
    v_mfma_f32_16x16x32_bf16 v[140:143], a[180:183], a[68:71], v[140:143]
    s_waitcnt lgkmcnt(4)
    v_mfma_f32_16x16x32_bf16 v[120:123], a[184:187], a[64:67], v[120:123]
    ds_read_b128 a[176:179], v38 offset:28672
    v_mfma_f32_16x16x32_bf16 v[144:147], a[184:187], a[68:71], v[144:147]
    v_mfma_f32_16x16x32_bf16 v[124:127], a[188:191], a[64:67], v[124:127]
    ds_read_b128 a[180:183], v38 offset:29696
    v_mfma_f32_16x16x32_bf16 v[148:151], a[188:191], a[68:71], v[148:151]
    s_waitcnt lgkmcnt(4)
    v_mfma_f32_16x16x32_bf16 v[128:131], a[160:163], a[64:67], v[128:131]
    ds_read_b128 a[184:187], v38 offset:30720
    v_mfma_f32_16x16x32_bf16 v[152:155], a[160:163], a[68:71], v[152:155]
    v_mfma_f32_16x16x32_bf16 v[132:135], a[164:167], a[64:67], v[132:135]
    ds_read_b128 a[188:191], v38 offset:31744
    v_mfma_f32_16x16x32_bf16 v[156:159], a[164:167], a[68:71], v[156:159]
    s_waitcnt lgkmcnt(4)
    v_mfma_f32_16x16x32_bf16 v[112:115], a[168:171], a[72:75], v[112:115]
    ds_read_b128 a[160:163], v36 offset:0
    v_mfma_f32_16x16x32_bf16 v[136:139], a[168:171], a[76:79], v[136:139]
    v_mfma_f32_16x16x32_bf16 v[116:119], a[172:175], a[72:75], v[116:119]
    ds_read_b128 a[164:167], v36 offset:1024
    v_mfma_f32_16x16x32_bf16 v[140:143], a[172:175], a[76:79], v[140:143]
    s_barrier
    s_waitcnt lgkmcnt(4)
    v_mfma_f32_16x16x32_bf16 v[120:123], a[176:179], a[72:75], v[120:123]
    ds_read_b128 a[168:171], v36 offset:2048
    v_mfma_f32_16x16x32_bf16 v[144:147], a[176:179], a[76:79], v[144:147]
    buffer_load_dwordx4 v1, s[32:35], s14 offen sc1 lds
    s_add_u32 s14, s14, 1024
    s_add_u32 m0, s15, 139264
    v_mfma_f32_16x16x32_bf16 v[124:127], a[180:183], a[72:75], v[124:127]
    ds_read_b128 a[172:175], v36 offset:3072
    v_mfma_f32_16x16x32_bf16 v[148:151], a[180:183], a[76:79], v[148:151]
    s_waitcnt lgkmcnt(4)
    v_mfma_f32_16x16x32_bf16 v[128:131], a[184:187], a[72:75], v[128:131]
    ds_read_b128 a[176:179], v36 offset:4096
    v_mfma_f32_16x16x32_bf16 v[152:155], a[184:187], a[76:79], v[152:155]
    buffer_load_dwordx4 v1, s[32:35], s14 offen sc1 lds
    s_add_u32 s14, s14, 1024
    s_add_u32 m0, s15, 143360
    v_mfma_f32_16x16x32_bf16 v[132:135], a[188:191], a[72:75], v[132:135]
    ds_read_b128 a[180:183], v36 offset:5120
    v_mfma_f32_16x16x32_bf16 v[156:159], a[188:191], a[76:79], v[156:159]
    s_waitcnt lgkmcnt(4)
    v_mfma_f32_16x16x32_bf16 v[112:115], a[160:163], a[80:83], v[112:115]
    ds_read_b128 a[184:187], v36 offset:6144
    v_mfma_f32_16x16x32_bf16 v[136:139], a[160:163], a[84:87], v[136:139]
    buffer_load_dwordx4 v1, s[32:35], s14 offen sc1 lds
    s_add_u32 s14, s14, 1024
    s_add_u32 m0, s15, 147456
    v_mfma_f32_16x16x32_bf16 v[116:119], a[164:167], a[80:83], v[116:119]
    ds_read_b128 a[188:191], v36 offset:7168
    v_mfma_f32_16x16x32_bf16 v[140:143], a[164:167], a[84:87], v[140:143]
    s_waitcnt lgkmcnt(4)
    v_mfma_f32_16x16x32_bf16 v[120:123], a[168:171], a[80:83], v[120:123]
    ds_read_b128 a[160:163], v36 offset:8192
    v_mfma_f32_16x16x32_bf16 v[144:147], a[168:171], a[84:87], v[144:147]
    buffer_load_dwordx4 v1, s[32:35], s14 offen sc1 lds
    s_add_u32 s14, s14, 1024
    s_add_u32 m0, s15, 151552
    v_mfma_f32_16x16x32_bf16 v[124:127], a[172:175], a[80:83], v[124:127]
    ds_read_b128 a[164:167], v36 offset:9216
    v_mfma_f32_16x16x32_bf16 v[148:151], a[172:175], a[84:87], v[148:151]
    s_waitcnt lgkmcnt(4)
    v_mfma_f32_16x16x32_bf16 v[128:131], a[176:179], a[80:83], v[128:131]
    ds_read_b128 a[168:171], v36 offset:10240
    v_mfma_f32_16x16x32_bf16 v[152:155], a[176:179], a[84:87], v[152:155]
    buffer_load_dwordx4 v1, s[32:35], s14 offen sc1 lds
    s_add_u32 s14, s14, 1024
    s_add_u32 m0, s15, 155648
    v_mfma_f32_16x16x32_bf16 v[132:135], a[180:183], a[80:83], v[132:135]
    ds_read_b128 a[172:175], v36 offset:11264
    v_mfma_f32_16x16x32_bf16 v[156:159], a[180:183], a[84:87], v[156:159]
    s_waitcnt lgkmcnt(4)
    v_mfma_f32_16x16x32_bf16 v[112:115], a[184:187], a[88:91], v[112:115]
    ds_read_b128 a[176:179], v36 offset:12288
    v_mfma_f32_16x16x32_bf16 v[136:139], a[184:187], a[92:95], v[136:139]
    buffer_load_dwordx4 v1, s[32:35], s14 offen sc1 lds
    s_add_u32 s14, s14, 1024
    s_add_u32 m0, s15, 159744
    s_add_u32 s82, s18, 589824
    buffer_load_dwordx2 v[14:15], v7, s[32:35], s82 offen sc1
    v_mfma_f32_16x16x32_bf16 v[116:119], a[188:191], a[88:91], v[116:119]
    ds_read_b128 a[180:183], v36 offset:13312
    v_mfma_f32_16x16x32_bf16 v[140:143], a[188:191], a[92:95], v[140:143]
    s_waitcnt lgkmcnt(4)
    v_mfma_f32_16x16x32_bf16 v[120:123], a[160:163], a[88:91], v[120:123]
    ds_read_b128 a[184:187], v36 offset:14336
    v_mfma_f32_16x16x32_bf16 v[144:147], a[160:163], a[92:95], v[144:147]
    v_mfma_f32_16x16x32_bf16 v[124:127], a[164:167], a[88:91], v[124:127]
    ds_read_b128 a[188:191], v36 offset:15360
    v_mfma_f32_16x16x32_bf16 v[148:151], a[164:167], a[92:95], v[148:151]
    s_waitcnt lgkmcnt(4)
    v_mfma_f32_16x16x32_bf16 v[128:131], a[168:171], a[88:91], v[128:131]
    ds_read_b128 a[160:163], v36 offset:16384
    v_mfma_f32_16x16x32_bf16 v[152:155], a[168:171], a[92:95], v[152:155]
    v_mfma_f32_16x16x32_bf16 v[132:135], a[172:175], a[88:91], v[132:135]
    ds_read_b128 a[164:167], v36 offset:17408
    v_mfma_f32_16x16x32_bf16 v[156:159], a[172:175], a[92:95], v[156:159]
    s_waitcnt lgkmcnt(4)
    v_mfma_f32_16x16x32_bf16 v[112:115], a[176:179], a[96:99], v[112:115]
    ds_read_b128 a[168:171], v36 offset:18432
    v_mfma_f32_16x16x32_bf16 v[136:139], a[176:179], a[100:103], v[136:139]
    v_mfma_f32_16x16x32_bf16 v[116:119], a[180:183], a[96:99], v[116:119]
    ds_read_b128 a[172:175], v36 offset:19456
    v_mfma_f32_16x16x32_bf16 v[140:143], a[180:183], a[100:103], v[140:143]
    s_waitcnt lgkmcnt(4)
    v_mfma_f32_16x16x32_bf16 v[120:123], a[184:187], a[96:99], v[120:123]
    ds_read_b128 a[176:179], v36 offset:20480
    v_mfma_f32_16x16x32_bf16 v[144:147], a[184:187], a[100:103], v[144:147]
    v_mfma_f32_16x16x32_bf16 v[124:127], a[188:191], a[96:99], v[124:127]
    ds_read_b128 a[180:183], v36 offset:21504
    v_mfma_f32_16x16x32_bf16 v[148:151], a[188:191], a[100:103], v[148:151]
    s_waitcnt lgkmcnt(4)
    v_mfma_f32_16x16x32_bf16 v[128:131], a[160:163], a[96:99], v[128:131]
    ds_read_b128 a[184:187], v36 offset:22528
    v_mfma_f32_16x16x32_bf16 v[152:155], a[160:163], a[100:103], v[152:155]
    v_mfma_f32_16x16x32_bf16 v[132:135], a[164:167], a[96:99], v[132:135]
    ds_read_b128 a[188:191], v36 offset:23552
    v_mfma_f32_16x16x32_bf16 v[156:159], a[164:167], a[100:103], v[156:159]
    s_waitcnt lgkmcnt(4)
    v_mfma_f32_16x16x32_bf16 v[112:115], a[168:171], a[104:107], v[112:115]
    ds_read_b128 a[160:163], v36 offset:24576
    v_mfma_f32_16x16x32_bf16 v[136:139], a[168:171], a[108:111], v[136:139]
    v_mfma_f32_16x16x32_bf16 v[116:119], a[172:175], a[104:107], v[116:119]
    ds_read_b128 a[164:167], v36 offset:25600
    v_mfma_f32_16x16x32_bf16 v[140:143], a[172:175], a[108:111], v[140:143]
    s_barrier
    s_waitcnt lgkmcnt(4)
    v_mfma_f32_16x16x32_bf16 v[120:123], a[176:179], a[104:107], v[120:123]
    ds_read_b128 a[168:171], v36 offset:26624
    v_mfma_f32_16x16x32_bf16 v[144:147], a[176:179], a[108:111], v[144:147]
    buffer_load_dwordx4 v1, s[32:35], s14 offen sc1 lds
    s_add_u32 s14, s14, 1024
    s_add_u32 m0, s15, 0
    v_mfma_f32_16x16x32_bf16 v[124:127], a[180:183], a[104:107], v[124:127]
    ds_read_b128 a[172:175], v36 offset:27648
    v_mfma_f32_16x16x32_bf16 v[148:151], a[180:183], a[108:111], v[148:151]
    s_waitcnt lgkmcnt(4)
    v_mfma_f32_16x16x32_bf16 v[128:131], a[184:187], a[104:107], v[128:131]
    ds_read_b128 a[176:179], v36 offset:28672
    v_mfma_f32_16x16x32_bf16 v[152:155], a[184:187], a[108:111], v[152:155]
    buffer_load_dwordx4 v1, s[32:35], s14 offen sc1 lds
    s_add_u32 s14, s14, 1024
    s_add_u32 m0, s15, 4096
    v_mfma_f32_16x16x32_bf16 v[132:135], a[188:191], a[104:107], v[132:135]
    ds_read_b128 a[180:183], v36 offset:29696
    v_mfma_f32_16x16x32_bf16 v[156:159], a[188:191], a[108:111], v[156:159]
    s_waitcnt lgkmcnt(4)
    v_mfma_f32_16x16x32_bf16 v[112:115], a[160:163], a[112:115], v[112:115]
    ds_read_b128 a[184:187], v36 offset:30720
    v_mfma_f32_16x16x32_bf16 v[136:139], a[160:163], a[116:119], v[136:139]
    buffer_load_dwordx4 v1, s[32:35], s14 offen sc1 lds
    s_add_u32 s14, s14, 1024
    s_add_u32 m0, s15, 8192
    s_waitcnt vmcnt(3)
    v_cmp_ne_u64 vcc, s[30:31], v[14:15]
    s_cbranch_vccz L_polled_26
    s_mov_b32 s65, 200000
L_poll_25:
    buffer_load_dwordx2 v[14:15], v7, s[32:35], s82 offen sc1
    s_waitcnt vmcnt(0)
    v_cmp_ne_u64 vcc, s[30:31], v[14:15]
    s_cbranch_vccz L_polled_26
    s_sub_u32 s65, s65, 1
    s_cmp_lg_u32 s65, 0
    s_cbranch_scc1 L_poll_25
L_polled_26:
    v_mfma_f32_16x16x32_bf16 v[116:119], a[164:167], a[112:115], v[116:119]
    ds_read_b128 a[188:191], v36 offset:31744
    v_mfma_f32_16x16x32_bf16 v[140:143], a[164:167], a[116:119], v[140:143]
    s_waitcnt lgkmcnt(4)
    v_mfma_f32_16x16x32_bf16 v[120:123], a[168:171], a[112:115], v[120:123]
    ds_read_b128 a[160:163], v36 offset:32768
    v_mfma_f32_16x16x32_bf16 v[144:147], a[168:171], a[116:119], v[144:147]
    buffer_load_dwordx4 a[0:3], v1, s[32:35], s4 offen offset:0 sc1
    v_mfma_f32_16x16x32_bf16 v[124:127], a[172:175], a[112:115], v[124:127]
    ds_read_b128 a[164:167], v36 offset:33792
    v_mfma_f32_16x16x32_bf16 v[148:151], a[172:175], a[116:119], v[148:151]
    s_waitcnt lgkmcnt(4)
    v_mfma_f32_16x16x32_bf16 v[128:131], a[176:179], a[112:115], v[128:131]
    ds_read_b128 a[168:171], v36 offset:34816
    v_mfma_f32_16x16x32_bf16 v[152:155], a[176:179], a[116:119], v[152:155]
    buffer_load_dwordx4 a[4:7], v1, s[32:35], s5 offen offset:0 sc1
    v_mfma_f32_16x16x32_bf16 v[132:135], a[180:183], a[112:115], v[132:135]
    ds_read_b128 a[172:175], v36 offset:35840
    v_mfma_f32_16x16x32_bf16 v[156:159], a[180:183], a[116:119], v[156:159]
    s_waitcnt lgkmcnt(4)
    v_mfma_f32_16x16x32_bf16 v[112:115], a[184:187], a[120:123], v[112:115]
    ds_read_b128 a[176:179], v36 offset:36864
    v_mfma_f32_16x16x32_bf16 v[136:139], a[184:187], a[124:127], v[136:139]
    buffer_load_dwordx4 a[8:11], v1, s[32:35], s6 offen offset:0 sc1
    v_mfma_f32_16x16x32_bf16 v[116:119], a[188:191], a[120:123], v[116:119]
    ds_read_b128 a[180:183], v36 offset:37888
    v_mfma_f32_16x16x32_bf16 v[140:143], a[188:191], a[124:127], v[140:143]
    s_waitcnt lgkmcnt(4)
    v_mfma_f32_16x16x32_bf16 v[120:123], a[160:163], a[120:123], v[120:123]
    ds_read_b128 a[184:187], v36 offset:38912
    v_mfma_f32_16x16x32_bf16 v[144:147], a[160:163], a[124:127], v[144:147]
    buffer_load_dwordx4 a[12:15], v1, s[32:35], s7 offen offset:0 sc1
    v_mfma_f32_16x16x32_bf16 v[124:127], a[164:167], a[120:123], v[124:127]
    ds_read_b128 a[188:191], v36 offset:39936
    v_mfma_f32_16x16x32_bf16 v[148:151], a[164:167], a[124:127], v[148:151]
    s_waitcnt lgkmcnt(4)
    v_mfma_f32_16x16x32_bf16 v[128:131], a[168:171], a[120:123], v[128:131]
    ds_read_b128 a[160:163], v36 offset:40960
    v_mfma_f32_16x16x32_bf16 v[152:155], a[168:171], a[124:127], v[152:155]
    buffer_load_dwordx4 a[16:19], v1, s[32:35], s4 offen offset:1024 sc1
    v_mfma_f32_16x16x32_bf16 v[132:135], a[172:175], a[120:123], v[132:135]
    ds_read_b128 a[164:167], v36 offset:41984
    v_mfma_f32_16x16x32_bf16 v[156:159], a[172:175], a[124:127], v[156:159]
    s_waitcnt lgkmcnt(4)
    v_mfma_f32_16x16x32_bf16 v[112:115], a[176:179], a[128:131], v[112:115]
    ds_read_b128 a[168:171], v36 offset:43008
    v_mfma_f32_16x16x32_bf16 v[136:139], a[176:179], a[132:135], v[136:139]
    buffer_load_dwordx4 a[20:23], v1, s[32:35], s5 offen offset:1024 sc1
    v_mfma_f32_16x16x32_bf16 v[116:119], a[180:183], a[128:131], v[116:119]
    ds_read_b128 a[172:175], v36 offset:44032
    v_mfma_f32_16x16x32_bf16 v[140:143], a[180:183], a[132:135], v[140:143]
    s_waitcnt lgkmcnt(4)
    v_mfma_f32_16x16x32_bf16 v[120:123], a[184:187], a[128:131], v[120:123]
    ds_read_b128 a[176:179], v36 offset:45056
    v_mfma_f32_16x16x32_bf16 v[144:147], a[184:187], a[132:135], v[144:147]
    buffer_load_dwordx4 a[24:27], v1, s[32:35], s6 offen offset:1024 sc1
    v_mfma_f32_16x16x32_bf16 v[124:127], a[188:191], a[128:131], v[124:127]
    ds_read_b128 a[180:183], v36 offset:46080
    v_mfma_f32_16x16x32_bf16 v[148:151], a[188:191], a[132:135], v[148:151]
    s_waitcnt lgkmcnt(4)
    v_mfma_f32_16x16x32_bf16 v[128:131], a[160:163], a[128:131], v[128:131]
    ds_read_b128 a[184:187], v36 offset:47104
    v_mfma_f32_16x16x32_bf16 v[152:155], a[160:163], a[132:135], v[152:155]
    buffer_load_dwordx4 a[28:31], v1, s[32:35], s7 offen offset:1024 sc1
    v_mfma_f32_16x16x32_bf16 v[132:135], a[164:167], a[128:131], v[132:135]
    ds_read_b128 a[188:191], v36 offset:48128
    v_mfma_f32_16x16x32_bf16 v[156:159], a[164:167], a[132:135], v[156:159]
    s_waitcnt lgkmcnt(4)
    v_mfma_f32_16x16x32_bf16 v[112:115], a[168:171], a[136:139], v[112:115]
    ds_read_b128 a[160:163], v36 offset:49152
    v_mfma_f32_16x16x32_bf16 v[136:139], a[168:171], a[140:143], v[136:139]
    buffer_load_dwordx4 a[32:35], v1, s[32:35], s4 offen offset:2048 sc1
    v_mfma_f32_16x16x32_bf16 v[116:119], a[172:175], a[136:139], v[116:119]
    ds_read_b128 a[164:167], v36 offset:50176
    v_mfma_f32_16x16x32_bf16 v[140:143], a[172:175], a[140:143], v[140:143]
    s_barrier
    s_waitcnt lgkmcnt(4)
    v_mfma_f32_16x16x32_bf16 v[120:123], a[176:179], a[136:139], v[120:123]
    ds_read_b128 a[168:171], v36 offset:51200
    v_mfma_f32_16x16x32_bf16 v[144:147], a[176:179], a[140:143], v[144:147]
    buffer_load_dwordx4 a[36:39], v1, s[32:35], s5 offen offset:2048 sc1
    v_mfma_f32_16x16x32_bf16 v[124:127], a[180:183], a[136:139], v[124:127]
    ds_read_b128 a[172:175], v36 offset:52224
    v_mfma_f32_16x16x32_bf16 v[148:151], a[180:183], a[140:143], v[148:151]
    s_waitcnt lgkmcnt(4)
    v_mfma_f32_16x16x32_bf16 v[128:131], a[184:187], a[136:139], v[128:131]
    ds_read_b128 a[176:179], v36 offset:53248
    v_mfma_f32_16x16x32_bf16 v[152:155], a[184:187], a[140:143], v[152:155]
    buffer_load_dwordx4 a[40:43], v1, s[32:35], s6 offen offset:2048 sc1
    v_mfma_f32_16x16x32_bf16 v[132:135], a[188:191], a[136:139], v[132:135]
    ds_read_b128 a[180:183], v36 offset:54272
    v_mfma_f32_16x16x32_bf16 v[156:159], a[188:191], a[140:143], v[156:159]
    s_waitcnt lgkmcnt(4)
    v_mfma_f32_16x16x32_bf16 v[112:115], a[160:163], a[144:147], v[112:115]
    ds_read_b128 a[184:187], v36 offset:55296
    v_mfma_f32_16x16x32_bf16 v[136:139], a[160:163], a[148:151], v[136:139]
    buffer_load_dwordx4 a[44:47], v1, s[32:35], s7 offen offset:2048 sc1
    v_mfma_f32_16x16x32_bf16 v[116:119], a[164:167], a[144:147], v[116:119]
    ds_read_b128 a[188:191], v36 offset:56320
    v_mfma_f32_16x16x32_bf16 v[140:143], a[164:167], a[148:151], v[140:143]
    s_waitcnt lgkmcnt(4)
    v_mfma_f32_16x16x32_bf16 v[120:123], a[168:171], a[144:147], v[120:123]
    ds_read_b128 a[160:163], v36 offset:57344
    v_mfma_f32_16x16x32_bf16 v[144:147], a[168:171], a[148:151], v[144:147]
    buffer_load_dwordx4 a[48:51], v1, s[32:35], s4 offen offset:3072 sc1
    v_mfma_f32_16x16x32_bf16 v[124:127], a[172:175], a[144:147], v[124:127]
    ds_read_b128 a[164:167], v36 offset:58368
    v_mfma_f32_16x16x32_bf16 v[148:151], a[172:175], a[148:151], v[148:151]
    s_waitcnt lgkmcnt(4)
    v_mfma_f32_16x16x32_bf16 v[128:131], a[176:179], a[144:147], v[128:131]
    ds_read_b128 a[168:171], v36 offset:59392
    v_mfma_f32_16x16x32_bf16 v[152:155], a[176:179], a[148:151], v[152:155]
    buffer_load_dwordx4 a[52:55], v1, s[32:35], s5 offen offset:3072 sc1
    v_mfma_f32_16x16x32_bf16 v[132:135], a[180:183], a[144:147], v[132:135]
    ds_read_b128 a[172:175], v36 offset:60416
    v_mfma_f32_16x16x32_bf16 v[156:159], a[180:183], a[148:151], v[156:159]
    s_waitcnt lgkmcnt(4)
    v_mfma_f32_16x16x32_bf16 v[112:115], a[184:187], a[152:155], v[112:115]
    v_mfma_f32_16x16x32_bf16 v[136:139], a[184:187], a[156:159], v[136:139]
    buffer_load_dwordx4 a[56:59], v1, s[32:35], s6 offen offset:3072 sc1
    v_mfma_f32_16x16x32_bf16 v[116:119], a[188:191], a[152:155], v[116:119]
    v_mfma_f32_16x16x32_bf16 v[140:143], a[188:191], a[156:159], v[140:143]
    s_waitcnt lgkmcnt(2)
    v_mfma_f32_16x16x32_bf16 v[120:123], a[160:163], a[152:155], v[120:123]
    v_mfma_f32_16x16x32_bf16 v[144:147], a[160:163], a[156:159], v[144:147]
    buffer_load_dwordx4 a[60:63], v1, s[32:35], s7 offen offset:3072 sc1
    v_mfma_f32_16x16x32_bf16 v[124:127], a[164:167], a[152:155], v[124:127]
    v_mfma_f32_16x16x32_bf16 v[148:151], a[164:167], a[156:159], v[148:151]
    s_waitcnt lgkmcnt(0)
    v_mfma_f32_16x16x32_bf16 v[128:131], a[168:171], a[152:155], v[128:131]
    v_mfma_f32_16x16x32_bf16 v[152:155], a[168:171], a[156:159], v[152:155]
    s_add_u32 s4, s4, 4096
    buffer_load_dwordx4 a[64:67], v1, s[32:35], s4 offen offset:0 sc1
    v_mfma_f32_16x16x32_bf16 v[132:135], a[172:175], a[152:155], v[132:135]
    v_mfma_f32_16x16x32_bf16 v[156:159], a[172:175], a[156:159], v[156:159]
    s_barrier
    v_pk_mul_f32 v[160:161], v[112:113], s[66:67] neg_lo:[1,0] neg_hi:[1,0]
    v_pk_mul_f32 v[162:163], v[114:115], s[66:67] neg_lo:[1,0] neg_hi:[1,0]
    v_pk_mul_f32 v[164:165], v[120:121], s[66:67] neg_lo:[1,0] neg_hi:[1,0]
    v_pk_mul_f32 v[166:167], v[122:123], s[66:67] neg_lo:[1,0] neg_hi:[1,0]
    v_exp_f32 v160, v160
    v_exp_f32 v161, v161
    v_exp_f32 v162, v162
    v_exp_f32 v163, v163
    v_exp_f32 v164, v164
    v_exp_f32 v165, v165
    v_exp_f32 v166, v166
    v_exp_f32 v167, v167
    v_pk_mul_f32 v[112:113], v[112:113], v[116:117]
    v_pk_mul_f32 v[114:115], v[114:115], v[118:119]
    v_pk_mul_f32 v[120:121], v[120:121], v[124:125]
    v_pk_mul_f32 v[122:123], v[122:123], v[126:127]
    v_pk_add_f32 v[160:161], v[160:161], 1.0 op_sel_hi:[1,0]
    v_pk_add_f32 v[162:163], v[162:163], 1.0 op_sel_hi:[1,0]
    v_pk_add_f32 v[164:165], v[164:165], 1.0 op_sel_hi:[1,0]
    v_pk_add_f32 v[166:167], v[166:167], 1.0 op_sel_hi:[1,0]
    v_rcp_f32 v160, v160
    v_rcp_f32 v161, v161
    v_rcp_f32 v162, v162
    v_rcp_f32 v163, v163
    v_rcp_f32 v164, v164
    v_rcp_f32 v165, v165
    v_rcp_f32 v166, v166
    v_rcp_f32 v167, v167
    v_pk_mul_f32 v[112:113], v[112:113], v[160:161]
    v_pk_mul_f32 v[114:115], v[114:115], v[162:163]
    v_pk_mul_f32 v[120:121], v[120:121], v[164:165]
    v_pk_mul_f32 v[122:123], v[122:123], v[166:167]
    v_cvt_pk_bf16_f32 v116, v112, v113
    v_cvt_pk_bf16_f32 v117, v114, v115
    v_cvt_pk_bf16_f32 v118, v120, v121
    v_cvt_pk_bf16_f32 v119, v122, v123
    buffer_store_dwordx4 v[116:119], v1, s[32:35], s79 offen sc1
    v_pk_mul_f32 v[168:169], v[136:137], s[66:67] neg_lo:[1,0] neg_hi:[1,0]
    v_pk_mul_f32 v[170:171], v[138:139], s[66:67] neg_lo:[1,0] neg_hi:[1,0]
    v_pk_mul_f32 v[172:173], v[144:145], s[66:67] neg_lo:[1,0] neg_hi:[1,0]
    v_pk_mul_f32 v[174:175], v[146:147], s[66:67] neg_lo:[1,0] neg_hi:[1,0]
    v_exp_f32 v168, v168
    v_exp_f32 v169, v169
    v_exp_f32 v170, v170
    v_exp_f32 v171, v171
    v_exp_f32 v172, v172
    v_exp_f32 v173, v173
    v_exp_f32 v174, v174
    v_exp_f32 v175, v175
    v_pk_mul_f32 v[136:137], v[136:137], v[140:141]
    v_pk_mul_f32 v[138:139], v[138:139], v[142:143]
    v_pk_mul_f32 v[144:145], v[144:145], v[148:149]
    v_pk_mul_f32 v[146:147], v[146:147], v[150:151]
    v_pk_add_f32 v[168:169], v[168:169], 1.0 op_sel_hi:[1,0]
    v_pk_add_f32 v[170:171], v[170:171], 1.0 op_sel_hi:[1,0]
    v_pk_add_f32 v[172:173], v[172:173], 1.0 op_sel_hi:[1,0]
    v_pk_add_f32 v[174:175], v[174:175], 1.0 op_sel_hi:[1,0]
    v_rcp_f32 v168, v168
    v_rcp_f32 v169, v169
    v_rcp_f32 v170, v170
    v_rcp_f32 v171, v171
    v_rcp_f32 v172, v172
    v_rcp_f32 v173, v173
    v_rcp_f32 v174, v174
    v_rcp_f32 v175, v175
    v_pk_mul_f32 v[136:137], v[136:137], v[168:169]
    v_pk_mul_f32 v[138:139], v[138:139], v[170:171]
    v_pk_mul_f32 v[144:145], v[144:145], v[172:173]
    v_pk_mul_f32 v[146:147], v[146:147], v[174:175]
    v_cvt_pk_bf16_f32 v140, v136, v137
    v_cvt_pk_bf16_f32 v141, v138, v139
    v_cvt_pk_bf16_f32 v142, v144, v145
    v_cvt_pk_bf16_f32 v143, v146, v147
    buffer_store_dwordx4 v[140:143], v44, s[32:35], s79 offen sc1
    v_pk_mul_f32 v[160:161], v[128:129], s[66:67] neg_lo:[1,0] neg_hi:[1,0]
    v_pk_mul_f32 v[162:163], v[130:131], s[66:67] neg_lo:[1,0] neg_hi:[1,0]
    v_pk_mul_f32 v[164:165], v[152:153], s[66:67] neg_lo:[1,0] neg_hi:[1,0]
    v_pk_mul_f32 v[166:167], v[154:155], s[66:67] neg_lo:[1,0] neg_hi:[1,0]
    v_exp_f32 v160, v160
    v_exp_f32 v161, v161
    v_exp_f32 v162, v162
    v_exp_f32 v163, v163
    v_exp_f32 v164, v164
    v_exp_f32 v165, v165
    v_exp_f32 v166, v166
    v_exp_f32 v167, v167
    v_pk_mul_f32 v[128:129], v[128:129], v[132:133]
    v_pk_mul_f32 v[130:131], v[130:131], v[134:135]
    v_pk_mul_f32 v[152:153], v[152:153], v[156:157]
    v_pk_mul_f32 v[154:155], v[154:155], v[158:159]
    v_pk_add_f32 v[160:161], v[160:161], 1.0 op_sel_hi:[1,0]
    v_pk_add_f32 v[162:163], v[162:163], 1.0 op_sel_hi:[1,0]
    v_pk_add_f32 v[164:165], v[164:165], 1.0 op_sel_hi:[1,0]
    v_pk_add_f32 v[166:167], v[166:167], 1.0 op_sel_hi:[1,0]
    v_rcp_f32 v160, v160
    v_rcp_f32 v161, v161
    v_rcp_f32 v162, v162
    v_rcp_f32 v163, v163
    v_rcp_f32 v164, v164
    v_rcp_f32 v165, v165
    v_rcp_f32 v166, v166
    v_rcp_f32 v167, v167
    v_pk_mul_f32 v[128:129], v[128:129], v[160:161]
    v_pk_mul_f32 v[130:131], v[130:131], v[162:163]
    v_pk_mul_f32 v[152:153], v[152:153], v[164:165]
    v_pk_mul_f32 v[154:155], v[154:155], v[166:167]
    v_cvt_pk_bf16_f32 v132, v128, v129
    v_cvt_pk_bf16_f32 v133, v130, v131
    v_cvt_pk_bf16_f32 v134, v152, v153
    v_cvt_pk_bf16_f32 v135, v154, v155
    s_nop 0
    v_permlane16_swap_b32 v132, v134
    v_permlane16_swap_b32 v133, v135
    buffer_store_dwordx4 v[132:135], v45, s[32:35], s79 offen offset:1024 sc1
    s_waitcnt vmcnt(16)
    v_mfma_f32_16x16x32_bf16 v[48:51], a[192:195], a[0:3], 0
    v_mfma_f32_16x16x32_bf16 v[68:71], a[192:195], a[4:7], 0
    v_mfma_f32_16x16x32_bf16 v[88:91], a[192:195], a[8:11], 0
    s_add_u32 s5, s5, 4096
    buffer_load_dwordx4 a[68:71], v1, s[32:35], s5 offen offset:0 sc1
    v_mfma_f32_16x16x32_bf16 v[108:111], a[192:195], a[12:15], 0
    v_mfma_f32_16x16x32_bf16 v[52:55], a[196:199], a[0:3], 0
    v_mfma_f32_16x16x32_bf16 v[72:75], a[196:199], a[4:7], 0
    v_mfma_f32_16x16x32_bf16 v[92:95], a[196:199], a[8:11], 0
    s_add_u32 s6, s6, 4096
    buffer_load_dwordx4 a[72:75], v1, s[32:35], s6 offen offset:0 sc1
    v_mfma_f32_16x16x32_bf16 v[112:115], a[196:199], a[12:15], 0
    v_mfma_f32_16x16x32_bf16 v[56:59], a[200:203], a[0:3], 0
    v_mfma_f32_16x16x32_bf16 v[76:79], a[200:203], a[4:7], 0
    v_mfma_f32_16x16x32_bf16 v[96:99], a[200:203], a[8:11], 0
    s_add_u32 s7, s7, 4096
    buffer_load_dwordx4 a[76:79], v1, s[32:35], s7 offen offset:0 sc1
    v_mfma_f32_16x16x32_bf16 v[116:119], a[200:203], a[12:15], 0
    v_mfma_f32_16x16x32_bf16 v[60:63], a[204:207], a[0:3], 0
    v_mfma_f32_16x16x32_bf16 v[80:83], a[204:207], a[4:7], 0
    v_mfma_f32_16x16x32_bf16 v[100:103], a[204:207], a[8:11], 0
    buffer_load_dwordx4 a[80:83], v1, s[32:35], s4 offen offset:1024 sc1
    v_mfma_f32_16x16x32_bf16 v[120:123], a[204:207], a[12:15], 0
    v_mfma_f32_16x16x32_bf16 v[64:67], a[208:211], a[0:3], 0
    v_mfma_f32_16x16x32_bf16 v[84:87], a[208:211], a[4:7], 0
    v_mfma_f32_16x16x32_bf16 v[104:107], a[208:211], a[8:11], 0
    buffer_load_dwordx4 a[84:87], v1, s[32:35], s5 offen offset:1024 sc1
    v_mfma_f32_16x16x32_bf16 v[124:127], a[208:211], a[12:15], 0
    s_waitcnt vmcnt(17)
    v_mfma_f32_16x16x32_bf16 v[48:51], a[212:215], a[16:19], v[48:51]
    v_mfma_f32_16x16x32_bf16 v[68:71], a[212:215], a[20:23], v[68:71]
    v_mfma_f32_16x16x32_bf16 v[88:91], a[212:215], a[24:27], v[88:91]
    buffer_load_dwordx4 a[88:91], v1, s[32:35], s6 offen offset:1024 sc1
    v_mfma_f32_16x16x32_bf16 v[108:111], a[212:215], a[28:31], v[108:111]
    v_mfma_f32_16x16x32_bf16 v[52:55], a[216:219], a[16:19], v[52:55]
    v_mfma_f32_16x16x32_bf16 v[72:75], a[216:219], a[20:23], v[72:75]
    v_mfma_f32_16x16x32_bf16 v[92:95], a[216:219], a[24:27], v[92:95]
    buffer_load_dwordx4 a[92:95], v1, s[32:35], s7 offen offset:1024 sc1
    v_mfma_f32_16x16x32_bf16 v[112:115], a[216:219], a[28:31], v[112:115]
    v_mfma_f32_16x16x32_bf16 v[56:59], a[220:223], a[16:19], v[56:59]
    v_mfma_f32_16x16x32_bf16 v[76:79], a[220:223], a[20:23], v[76:79]
    v_mfma_f32_16x16x32_bf16 v[96:99], a[220:223], a[24:27], v[96:99]
    buffer_load_dwordx4 a[96:99], v1, s[32:35], s4 offen offset:2048 sc1
    v_mfma_f32_16x16x32_bf16 v[116:119], a[220:223], a[28:31], v[116:119]
    v_mfma_f32_16x16x32_bf16 v[60:63], a[224:227], a[16:19], v[60:63]
    v_mfma_f32_16x16x32_bf16 v[80:83], a[224:227], a[20:23], v[80:83]
    v_mfma_f32_16x16x32_bf16 v[100:103], a[224:227], a[24:27], v[100:103]
    buffer_load_dwordx4 a[100:103], v1, s[32:35], s5 offen offset:2048 sc1
    v_mfma_f32_16x16x32_bf16 v[120:123], a[224:227], a[28:31], v[120:123]
    s_waitcnt vmcnt(9)
    s_barrier
    s_mov_b64 exec, 1
    buffer_store_dwordx2 v[2:3], off, s[32:35], s81 sc1
    s_mov_b64 exec, -1
    v_mfma_f32_16x16x32_bf16 v[64:67], a[228:231], a[16:19], v[64:67]
    v_mfma_f32_16x16x32_bf16 v[84:87], a[228:231], a[20:23], v[84:87]
    v_mfma_f32_16x16x32_bf16 v[104:107], a[228:231], a[24:27], v[104:107]
    buffer_load_dwordx4 a[104:107], v1, s[32:35], s6 offen offset:2048 sc1
    v_mfma_f32_16x16x32_bf16 v[124:127], a[228:231], a[28:31], v[124:127]
    v_mfma_f32_16x16x32_bf16 v[48:51], a[232:235], a[32:35], v[48:51]
    v_mfma_f32_16x16x32_bf16 v[68:71], a[232:235], a[36:39], v[68:71]
    v_mfma_f32_16x16x32_bf16 v[88:91], a[232:235], a[40:43], v[88:91]
    buffer_load_dwordx4 a[108:111], v1, s[32:35], s7 offen offset:2048 sc1
    v_mfma_f32_16x16x32_bf16 v[108:111], a[232:235], a[44:47], v[108:111]
    v_mfma_f32_16x16x32_bf16 v[52:55], a[236:239], a[32:35], v[52:55]
    v_mfma_f32_16x16x32_bf16 v[72:75], a[236:239], a[36:39], v[72:75]
    v_mfma_f32_16x16x32_bf16 v[92:95], a[236:239], a[40:43], v[92:95]
    buffer_load_dwordx4 a[112:115], v1, s[32:35], s4 offen offset:3072 sc1
    v_mfma_f32_16x16x32_bf16 v[112:115], a[236:239], a[44:47], v[112:115]
    v_mfma_f32_16x16x32_bf16 v[56:59], a[240:243], a[32:35], v[56:59]
    v_mfma_f32_16x16x32_bf16 v[76:79], a[240:243], a[36:39], v[76:79]
    v_mfma_f32_16x16x32_bf16 v[96:99], a[240:243], a[40:43], v[96:99]
    buffer_load_dwordx4 a[116:119], v1, s[32:35], s5 offen offset:3072 sc1
    v_mfma_f32_16x16x32_bf16 v[116:119], a[240:243], a[44:47], v[116:119]
    v_mfma_f32_16x16x32_bf16 v[60:63], a[244:247], a[32:35], v[60:63]
    v_mfma_f32_16x16x32_bf16 v[80:83], a[244:247], a[36:39], v[80:83]
    v_mfma_f32_16x16x32_bf16 v[100:103], a[244:247], a[40:43], v[100:103]
    buffer_load_dwordx4 a[120:123], v1, s[32:35], s6 offen offset:3072 sc1
    v_mfma_f32_16x16x32_bf16 v[120:123], a[244:247], a[44:47], v[120:123]
    v_mfma_f32_16x16x32_bf16 v[64:67], a[248:251], a[32:35], v[64:67]
    v_mfma_f32_16x16x32_bf16 v[84:87], a[248:251], a[36:39], v[84:87]
    v_mfma_f32_16x16x32_bf16 v[104:107], a[248:251], a[40:43], v[104:107]
    buffer_load_dwordx4 a[124:127], v1, s[32:35], s7 offen offset:3072 sc1
    v_mfma_f32_16x16x32_bf16 v[124:127], a[248:251], a[44:47], v[124:127]
    v_mfma_f32_16x16x32_bf16 v[48:51], a[252:255], a[48:51], v[48:51]
    v_mfma_f32_16x16x32_bf16 v[68:71], a[252:255], a[52:55], v[68:71]
    v_mfma_f32_16x16x32_bf16 v[88:91], a[252:255], a[56:59], v[88:91]
    buffer_load_dwordx4 v1, s[32:35], s14 offen sc1 lds
    s_add_u32 s14, s14, 1024
    s_add_u32 m0, s15, 12288
    v_mfma_f32_16x16x32_bf16 v[108:111], a[252:255], a[60:63], v[108:111]
    v_mfma_f32_16x16x32_bf16 v[52:55], v[176:179], a[48:51], v[52:55]
    v_mfma_f32_16x16x32_bf16 v[72:75], v[176:179], a[52:55], v[72:75]
    v_mfma_f32_16x16x32_bf16 v[92:95], v[176:179], a[56:59], v[92:95]
    buffer_load_dwordx4 v1, s[32:35], s14 offen sc1 lds
    s_add_u32 s14, s14, 1024
    s_add_u32 m0, s15, 16384
    v_mfma_f32_16x16x32_bf16 v[112:115], v[176:179], a[60:63], v[112:115]
    v_mfma_f32_16x16x32_bf16 v[56:59], v[180:183], a[48:51], v[56:59]
    v_mfma_f32_16x16x32_bf16 v[76:79], v[180:183], a[52:55], v[76:79]
    v_mfma_f32_16x16x32_bf16 v[96:99], v[180:183], a[56:59], v[96:99]
    buffer_load_dwordx4 v1, s[32:35], s14 offen sc1 lds
    s_add_u32 s14, s14, 1024
    s_add_u32 m0, s15, 20480
    v_mfma_f32_16x16x32_bf16 v[116:119], v[180:183], a[60:63], v[116:119]
    v_mfma_f32_16x16x32_bf16 v[60:63], v[184:187], a[48:51], v[60:63]
    v_mfma_f32_16x16x32_bf16 v[80:83], v[184:187], a[52:55], v[80:83]
    v_mfma_f32_16x16x32_bf16 v[100:103], v[184:187], a[56:59], v[100:103]
    buffer_load_dwordx4 v1, s[32:35], s14 offen sc1 lds
    s_add_u32 s14, s14, 1024
    s_add_u32 m0, s15, 24576
    v_mfma_f32_16x16x32_bf16 v[120:123], v[184:187], a[60:63], v[120:123]
    s_add_u32 s82, s18, 720896
    buffer_load_dwordx2 v[14:15], v7, s[32:35], s82 offen sc1
    v_mfma_f32_16x16x32_bf16 v[64:67], v[188:191], a[48:51], v[64:67]
    v_mfma_f32_16x16x32_bf16 v[84:87], v[188:191], a[52:55], v[84:87]
    v_mfma_f32_16x16x32_bf16 v[104:107], v[188:191], a[56:59], v[104:107]
    buffer_load_dwordx4 v1, s[32:35], s14 offen sc1 lds
    s_add_u32 s14, s14, 1024
    s_add_u32 m0, s15, 28672
    v_mfma_f32_16x16x32_bf16 v[124:127], v[188:191], a[60:63], v[124:127]
    s_waitcnt vmcnt(19)
    v_mfma_f32_16x16x32_bf16 v[48:51], v[192:195], a[64:67], v[48:51]
    v_mfma_f32_16x16x32_bf16 v[68:71], v[192:195], a[68:71], v[68:71]
    v_mfma_f32_16x16x32_bf16 v[88:91], v[192:195], a[72:75], v[88:91]
    buffer_load_dwordx4 v1, s[32:35], s14 offen sc1 lds
    s_add_u32 s14, s14, 1024
    s_add_u32 m0, s15, 32768
    v_mfma_f32_16x16x32_bf16 v[108:111], v[192:195], a[76:79], v[108:111]
    v_mfma_f32_16x16x32_bf16 v[52:55], v[196:199], a[64:67], v[52:55]
    v_mfma_f32_16x16x32_bf16 v[72:75], v[196:199], a[68:71], v[72:75]
    v_mfma_f32_16x16x32_bf16 v[92:95], v[196:199], a[72:75], v[92:95]
    buffer_load_dwordx4 v1, s[32:35], s14 offen sc1 lds
    s_add_u32 s14, s14, 1024
    s_add_u32 m0, s15, 36864
    v_mfma_f32_16x16x32_bf16 v[112:115], v[196:199], a[76:79], v[112:115]
    v_mfma_f32_16x16x32_bf16 v[56:59], v[200:203], a[64:67], v[56:59]
    v_mfma_f32_16x16x32_bf16 v[76:79], v[200:203], a[68:71], v[76:79]
    v_mfma_f32_16x16x32_bf16 v[96:99], v[200:203], a[72:75], v[96:99]
    buffer_load_dwordx4 v1, s[32:35], s14 offen sc1 lds
    s_add_u32 s14, s14, 1024
    v_mfma_f32_16x16x32_bf16 v[116:119], v[200:203], a[76:79], v[116:119]
    v_mfma_f32_16x16x32_bf16 v[60:63], v[204:207], a[64:67], v[60:63]
    v_mfma_f32_16x16x32_bf16 v[80:83], v[204:207], a[68:71], v[80:83]
    v_mfma_f32_16x16x32_bf16 v[100:103], v[204:207], a[72:75], v[100:103]
    v_mfma_f32_16x16x32_bf16 v[120:123], v[204:207], a[76:79], v[120:123]
    v_mfma_f32_16x16x32_bf16 v[64:67], v[208:211], a[64:67], v[64:67]
    v_mfma_f32_16x16x32_bf16 v[84:87], v[208:211], a[68:71], v[84:87]
    v_mfma_f32_16x16x32_bf16 v[104:107], v[208:211], a[72:75], v[104:107]
    v_mfma_f32_16x16x32_bf16 v[124:127], v[208:211], a[76:79], v[124:127]
    s_waitcnt vmcnt(18)
    v_mfma_f32_16x16x32_bf16 v[48:51], v[212:215], a[80:83], v[48:51]
    v_mfma_f32_16x16x32_bf16 v[68:71], v[212:215], a[84:87], v[68:71]
    v_mfma_f32_16x16x32_bf16 v[88:91], v[212:215], a[88:91], v[88:91]
    v_mfma_f32_16x16x32_bf16 v[108:111], v[212:215], a[92:95], v[108:111]
    v_mfma_f32_16x16x32_bf16 v[52:55], v[216:219], a[80:83], v[52:55]
    v_mfma_f32_16x16x32_bf16 v[72:75], v[216:219], a[84:87], v[72:75]
    v_mfma_f32_16x16x32_bf16 v[92:95], v[216:219], a[88:91], v[92:95]
    v_mfma_f32_16x16x32_bf16 v[112:115], v[216:219], a[92:95], v[112:115]
    v_mfma_f32_16x16x32_bf16 v[56:59], v[220:223], a[80:83], v[56:59]
    v_mfma_f32_16x16x32_bf16 v[76:79], v[220:223], a[84:87], v[76:79]
    v_mfma_f32_16x16x32_bf16 v[96:99], v[220:223], a[88:91], v[96:99]
    v_mfma_f32_16x16x32_bf16 v[116:119], v[220:223], a[92:95], v[116:119]
    v_mfma_f32_16x16x32_bf16 v[60:63], v[224:227], a[80:83], v[60:63]
    v_mfma_f32_16x16x32_bf16 v[80:83], v[224:227], a[84:87], v[80:83]
    v_mfma_f32_16x16x32_bf16 v[100:103], v[224:227], a[88:91], v[100:103]
    v_mfma_f32_16x16x32_bf16 v[120:123], v[224:227], a[92:95], v[120:123]
    s_waitcnt vmcnt(4)
    v_cmp_ne_u64 vcc, s[30:31], v[14:15]
    s_cbranch_vccz L_polled_28
    s_mov_b32 s65, 200000
L_poll_27:
    buffer_load_dwordx2 v[14:15], v7, s[32:35], s82 offen sc1
    s_waitcnt vmcnt(0)
    v_cmp_ne_u64 vcc, s[30:31], v[14:15]
    s_cbranch_vccz L_polled_28
    s_sub_u32 s65, s65, 1
    s_cmp_lg_u32 s65, 0
    s_cbranch_scc1 L_poll_27
L_polled_28:
    v_mfma_f32_16x16x32_bf16 v[64:67], v[228:231], a[80:83], v[64:67]
    v_mfma_f32_16x16x32_bf16 v[84:87], v[228:231], a[84:87], v[84:87]
    v_mfma_f32_16x16x32_bf16 v[104:107], v[228:231], a[88:91], v[104:107]
    s_add_u32 s4, s4, 4096
    buffer_load_dwordx4 a[128:131], v1, s[32:35], s4 offen offset:0 sc1
    v_mfma_f32_16x16x32_bf16 v[124:127], v[228:231], a[92:95], v[124:127]
    v_mfma_f32_16x16x32_bf16 v[48:51], v[232:235], a[96:99], v[48:51]
    v_mfma_f32_16x16x32_bf16 v[68:71], v[232:235], a[100:103], v[68:71]
    v_mfma_f32_16x16x32_bf16 v[88:91], v[232:235], a[104:107], v[88:91]
    s_add_u32 s5, s5, 4096
    buffer_load_dwordx4 a[132:135], v1, s[32:35], s5 offen offset:0 sc1
    v_mfma_f32_16x16x32_bf16 v[108:111], v[232:235], a[108:111], v[108:111]
    v_mfma_f32_16x16x32_bf16 v[52:55], v[236:239], a[96:99], v[52:55]
    v_mfma_f32_16x16x32_bf16 v[72:75], v[236:239], a[100:103], v[72:75]
    ds_read_b128 a[172:175], v4 offset:61440
    v_mfma_f32_16x16x32_bf16 v[92:95], v[236:239], a[104:107], v[92:95]
    s_add_u32 s6, s6, 4096
    buffer_load_dwordx4 a[136:139], v1, s[32:35], s6 offen offset:0 sc1
    v_mfma_f32_16x16x32_bf16 v[112:115], v[236:239], a[108:111], v[112:115]
    v_mfma_f32_16x16x32_bf16 v[56:59], v[240:243], a[96:99], v[56:59]
    v_mfma_f32_16x16x32_bf16 v[76:79], v[240:243], a[100:103], v[76:79]
    ds_read_b128 a[176:179], v5 offset:0
    v_mfma_f32_16x16x32_bf16 v[96:99], v[240:243], a[104:107], v[96:99]
    s_add_u32 s7, s7, 4096
    buffer_load_dwordx4 a[140:143], v1, s[32:35], s7 offen offset:0 sc1
    v_mfma_f32_16x16x32_bf16 v[116:119], v[240:243], a[108:111], v[116:119]
    v_mfma_f32_16x16x32_bf16 v[60:63], v[244:247], a[96:99], v[60:63]
    v_mfma_f32_16x16x32_bf16 v[80:83], v[244:247], a[100:103], v[80:83]
    ds_read_b128 a[180:183], v5 offset:4096
    v_mfma_f32_16x16x32_bf16 v[100:103], v[244:247], a[104:107], v[100:103]
    buffer_load_dwordx4 a[144:147], v1, s[32:35], s4 offen offset:1024 sc1
    v_mfma_f32_16x16x32_bf16 v[120:123], v[244:247], a[108:111], v[120:123]
    v_mfma_f32_16x16x32_bf16 v[64:67], v[248:251], a[96:99], v[64:67]
    v_mfma_f32_16x16x32_bf16 v[84:87], v[248:251], a[100:103], v[84:87]
    ds_read_b128 a[184:187], v5 offset:8192
    v_mfma_f32_16x16x32_bf16 v[104:107], v[248:251], a[104:107], v[104:107]
    buffer_load_dwordx4 a[148:151], v1, s[32:35], s5 offen offset:1024 sc1
    v_mfma_f32_16x16x32_bf16 v[124:127], v[248:251], a[108:111], v[124:127]
    s_waitcnt lgkmcnt(3)
    v_mfma_f32_16x16x32_bf16 v[48:51], a[172:175], a[112:115], v[48:51]
    v_mfma_f32_16x16x32_bf16 v[68:71], a[172:175], a[116:119], v[68:71]
    ds_read_b128 a[188:191], v5 offset:12288
    v_mfma_f32_16x16x32_bf16 v[88:91], a[172:175], a[120:123], v[88:91]
    buffer_load_dwordx4 a[152:155], v1, s[32:35], s6 offen offset:1024 sc1
    v_mfma_f32_16x16x32_bf16 v[108:111], a[172:175], a[124:127], v[108:111]
    s_waitcnt lgkmcnt(3)
    v_mfma_f32_16x16x32_bf16 v[52:55], a[176:179], a[112:115], v[52:55]
    v_mfma_f32_16x16x32_bf16 v[72:75], a[176:179], a[116:119], v[72:75]
    ds_read_b128 a[160:163], v5 offset:16384
    v_mfma_f32_16x16x32_bf16 v[92:95], a[176:179], a[120:123], v[92:95]
    buffer_load_dwordx4 a[156:159], v1, s[32:35], s7 offen offset:1024 sc1
    v_mfma_f32_16x16x32_bf16 v[112:115], a[176:179], a[124:127], v[112:115]
    s_waitcnt lgkmcnt(3)
    v_mfma_f32_16x16x32_bf16 v[56:59], a[180:183], a[112:115], v[56:59]
    v_mfma_f32_16x16x32_bf16 v[76:79], a[180:183], a[116:119], v[76:79]
    ds_read_b128 a[164:167], v5 offset:20480
    v_mfma_f32_16x16x32_bf16 v[96:99], a[180:183], a[120:123], v[96:99]
    buffer_load_dwordx4 a[0:3], v1, s[32:35], s4 offen offset:2048 sc1
    v_mfma_f32_16x16x32_bf16 v[116:119], a[180:183], a[124:127], v[116:119]
    s_waitcnt lgkmcnt(3)
    v_mfma_f32_16x16x32_bf16 v[60:63], a[184:187], a[112:115], v[60:63]
    v_mfma_f32_16x16x32_bf16 v[80:83], a[184:187], a[116:119], v[80:83]
    ds_read_b128 a[168:171], v5 offset:24576
    v_mfma_f32_16x16x32_bf16 v[100:103], a[184:187], a[120:123], v[100:103]
    buffer_load_dwordx4 a[4:7], v1, s[32:35], s5 offen offset:2048 sc1
    v_mfma_f32_16x16x32_bf16 v[120:123], a[184:187], a[124:127], v[120:123]
    s_waitcnt lgkmcnt(3)
    v_mfma_f32_16x16x32_bf16 v[64:67], a[188:191], a[112:115], v[64:67]
    v_mfma_f32_16x16x32_bf16 v[84:87], a[188:191], a[116:119], v[84:87]
    ds_read_b128 a[172:175], v5 offset:28672
    v_mfma_f32_16x16x32_bf16 v[104:107], a[188:191], a[120:123], v[104:107]
    buffer_load_dwordx4 a[8:11], v1, s[32:35], s6 offen offset:2048 sc1
    v_mfma_f32_16x16x32_bf16 v[124:127], a[188:191], a[124:127], v[124:127]
    s_waitcnt vmcnt(7) lgkmcnt(3)
    v_mfma_f32_16x16x32_bf16 v[48:51], a[160:163], a[128:131], v[48:51]
    v_mfma_f32_16x16x32_bf16 v[68:71], a[160:163], a[132:135], v[68:71]
    ds_read_b128 a[176:179], v5 offset:32768
    v_mfma_f32_16x16x32_bf16 v[88:91], a[160:163], a[136:139], v[88:91]
    buffer_load_dwordx4 a[12:15], v1, s[32:35], s7 offen offset:2048 sc1
    v_mfma_f32_16x16x32_bf16 v[108:111], a[160:163], a[140:143], v[108:111]
    s_waitcnt lgkmcnt(3)
    v_mfma_f32_16x16x32_bf16 v[52:55], a[164:167], a[128:131], v[52:55]
    v_mfma_f32_16x16x32_bf16 v[72:75], a[164:167], a[132:135], v[72:75]
    ds_read_b128 a[180:183], v5 offset:36864
    v_mfma_f32_16x16x32_bf16 v[92:95], a[164:167], a[136:139], v[92:95]
    buffer_load_dwordx4 a[16:19], v1, s[32:35], s4 offen offset:3072 sc1
    v_mfma_f32_16x16x32_bf16 v[112:115], a[164:167], a[140:143], v[112:115]
    s_waitcnt lgkmcnt(3)
    v_mfma_f32_16x16x32_bf16 v[56:59], a[168:171], a[128:131], v[56:59]
    v_mfma_f32_16x16x32_bf16 v[76:79], a[168:171], a[132:135], v[76:79]
    ds_read_b128 a[184:187], v5 offset:40960
    v_mfma_f32_16x16x32_bf16 v[96:99], a[168:171], a[136:139], v[96:99]
    buffer_load_dwordx4 a[20:23], v1, s[32:35], s5 offen offset:3072 sc1
    v_mfma_f32_16x16x32_bf16 v[116:119], a[168:171], a[140:143], v[116:119]
    s_waitcnt lgkmcnt(3)
    v_mfma_f32_16x16x32_bf16 v[60:63], a[172:175], a[128:131], v[60:63]
    v_mfma_f32_16x16x32_bf16 v[80:83], a[172:175], a[132:135], v[80:83]
    ds_read_b128 a[188:191], v5 offset:45056
    v_mfma_f32_16x16x32_bf16 v[100:103], a[172:175], a[136:139], v[100:103]
    buffer_load_dwordx4 a[24:27], v1, s[32:35], s6 offen offset:3072 sc1
    v_mfma_f32_16x16x32_bf16 v[120:123], a[172:175], a[140:143], v[120:123]
    s_waitcnt lgkmcnt(3)
    v_mfma_f32_16x16x32_bf16 v[64:67], a[176:179], a[128:131], v[64:67]
    v_mfma_f32_16x16x32_bf16 v[84:87], a[176:179], a[132:135], v[84:87]
    ds_read_b128 a[160:163], v5 offset:49152
    v_mfma_f32_16x16x32_bf16 v[104:107], a[176:179], a[136:139], v[104:107]
    buffer_load_dwordx4 a[28:31], v1, s[32:35], s7 offen offset:3072 sc1
    v_mfma_f32_16x16x32_bf16 v[124:127], a[176:179], a[140:143], v[124:127]
    s_waitcnt vmcnt(8) lgkmcnt(3)
    v_mfma_f32_16x16x32_bf16 v[48:51], a[180:183], a[144:147], v[48:51]
    v_mfma_f32_16x16x32_bf16 v[68:71], a[180:183], a[148:151], v[68:71]
    ds_read_b128 a[164:167], v5 offset:53248
    v_mfma_f32_16x16x32_bf16 v[88:91], a[180:183], a[152:155], v[88:91]
    s_add_u32 s4, s4, 4096
    buffer_load_dwordx4 a[32:35], v1, s[32:35], s4 offen offset:0 sc1
    v_mfma_f32_16x16x32_bf16 v[108:111], a[180:183], a[156:159], v[108:111]
    s_waitcnt lgkmcnt(3)
    v_mfma_f32_16x16x32_bf16 v[52:55], a[184:187], a[144:147], v[52:55]
    v_mfma_f32_16x16x32_bf16 v[72:75], a[184:187], a[148:151], v[72:75]
    ds_read_b128 a[168:171], v5 offset:57344
    v_mfma_f32_16x16x32_bf16 v[92:95], a[184:187], a[152:155], v[92:95]
    s_add_u32 s5, s5, 4096
    buffer_load_dwordx4 a[36:39], v1, s[32:35], s5 offen offset:0 sc1
    v_mfma_f32_16x16x32_bf16 v[112:115], a[184:187], a[156:159], v[112:115]
    s_waitcnt lgkmcnt(3)
    v_mfma_f32_16x16x32_bf16 v[56:59], a[188:191], a[144:147], v[56:59]
    v_mfma_f32_16x16x32_bf16 v[76:79], a[188:191], a[148:151], v[76:79]
    ds_read_b128 a[172:175], v5 offset:61440
    v_mfma_f32_16x16x32_bf16 v[96:99], a[188:191], a[152:155], v[96:99]
    s_add_u32 s6, s6, 4096
    buffer_load_dwordx4 a[40:43], v1, s[32:35], s6 offen offset:0 sc1
    v_mfma_f32_16x16x32_bf16 v[116:119], a[188:191], a[156:159], v[116:119]
    s_waitcnt lgkmcnt(3)
    v_mfma_f32_16x16x32_bf16 v[60:63], a[160:163], a[144:147], v[60:63]
    v_mfma_f32_16x16x32_bf16 v[80:83], a[160:163], a[148:151], v[80:83]
    ds_read_b128 a[176:179], v6 offset:0
    v_mfma_f32_16x16x32_bf16 v[100:103], a[160:163], a[152:155], v[100:103]
    s_add_u32 s7, s7, 4096
    buffer_load_dwordx4 a[44:47], v1, s[32:35], s7 offen offset:0 sc1
    v_mfma_f32_16x16x32_bf16 v[120:123], a[160:163], a[156:159], v[120:123]
    s_waitcnt lgkmcnt(3)
    v_mfma_f32_16x16x32_bf16 v[64:67], a[164:167], a[144:147], v[64:67]
    v_mfma_f32_16x16x32_bf16 v[84:87], a[164:167], a[148:151], v[84:87]
    ds_read_b128 a[180:183], v6 offset:4096
    v_mfma_f32_16x16x32_bf16 v[104:107], a[164:167], a[152:155], v[104:107]
    buffer_load_dwordx4 a[48:51], v46, s[32:35], s4 offen offset:1024 sc1
    v_mfma_f32_16x16x32_bf16 v[124:127], a[164:167], a[156:159], v[124:127]
    s_waitcnt vmcnt(9) lgkmcnt(3)
    v_mfma_f32_16x16x32_bf16 v[48:51], a[168:171], a[0:3], v[48:51]
    v_mfma_f32_16x16x32_bf16 v[68:71], a[168:171], a[4:7], v[68:71]
    ds_read_b128 a[184:187], v6 offset:8192
    v_mfma_f32_16x16x32_bf16 v[88:91], a[168:171], a[8:11], v[88:91]
    buffer_load_dwordx4 a[52:55], v46, s[32:35], s5 offen offset:1024 sc1
    v_mfma_f32_16x16x32_bf16 v[108:111], a[168:171], a[12:15], v[108:111]
    s_waitcnt lgkmcnt(3)
    v_mfma_f32_16x16x32_bf16 v[52:55], a[172:175], a[0:3], v[52:55]
    v_mfma_f32_16x16x32_bf16 v[72:75], a[172:175], a[4:7], v[72:75]
    ds_read_b128 a[188:191], v6 offset:12288
    v_mfma_f32_16x16x32_bf16 v[92:95], a[172:175], a[8:11], v[92:95]
    buffer_load_dwordx4 a[56:59], v46, s[32:35], s6 offen offset:1024 sc1
    v_mfma_f32_16x16x32_bf16 v[112:115], a[172:175], a[12:15], v[112:115]
    s_waitcnt lgkmcnt(3)
    v_mfma_f32_16x16x32_bf16 v[56:59], a[176:179], a[0:3], v[56:59]
    v_mfma_f32_16x16x32_bf16 v[76:79], a[176:179], a[4:7], v[76:79]
    ds_read_b128 a[160:163], v6 offset:16384
    v_mfma_f32_16x16x32_bf16 v[96:99], a[176:179], a[8:11], v[96:99]
    buffer_load_dwordx4 a[60:63], v46, s[32:35], s7 offen offset:1024 sc1
    v_mfma_f32_16x16x32_bf16 v[116:119], a[176:179], a[12:15], v[116:119]
    s_waitcnt lgkmcnt(3)
    v_mfma_f32_16x16x32_bf16 v[60:63], a[180:183], a[0:3], v[60:63]
    v_mfma_f32_16x16x32_bf16 v[80:83], a[180:183], a[4:7], v[80:83]
    ds_read_b128 a[164:167], v6 offset:20480
    v_mfma_f32_16x16x32_bf16 v[100:103], a[180:183], a[8:11], v[100:103]
    v_mfma_f32_16x16x32_bf16 v[120:123], a[180:183], a[12:15], v[120:123]
    s_waitcnt lgkmcnt(3)
    v_mfma_f32_16x16x32_bf16 v[64:67], a[184:187], a[0:3], v[64:67]
    v_mfma_f32_16x16x32_bf16 v[84:87], a[184:187], a[4:7], v[84:87]
    ds_read_b128 a[168:171], v6 offset:24576
    v_mfma_f32_16x16x32_bf16 v[104:107], a[184:187], a[8:11], v[104:107]
    v_mfma_f32_16x16x32_bf16 v[124:127], a[184:187], a[12:15], v[124:127]
    s_waitcnt vmcnt(8) lgkmcnt(3)
    v_mfma_f32_16x16x32_bf16 v[48:51], a[188:191], a[16:19], v[48:51]
    v_mfma_f32_16x16x32_bf16 v[68:71], a[188:191], a[20:23], v[68:71]
    ds_read_b128 a[172:175], v6 offset:28672
    v_mfma_f32_16x16x32_bf16 v[88:91], a[188:191], a[24:27], v[88:91]
    v_mfma_f32_16x16x32_bf16 v[108:111], a[188:191], a[28:31], v[108:111]
    s_waitcnt lgkmcnt(3)
    v_mfma_f32_16x16x32_bf16 v[52:55], a[160:163], a[16:19], v[52:55]
    v_mfma_f32_16x16x32_bf16 v[72:75], a[160:163], a[20:23], v[72:75]
    ds_read_b128 a[176:179], v4 offset:0
    v_mfma_f32_16x16x32_bf16 v[92:95], a[160:163], a[24:27], v[92:95]
    v_mfma_f32_16x16x32_bf16 v[112:115], a[160:163], a[28:31], v[112:115]
    s_waitcnt lgkmcnt(3)
    v_mfma_f32_16x16x32_bf16 v[56:59], a[164:167], a[16:19], v[56:59]
    v_mfma_f32_16x16x32_bf16 v[76:79], a[164:167], a[20:23], v[76:79]
    ds_read_b128 a[180:183], v4 offset:4096
    v_mfma_f32_16x16x32_bf16 v[96:99], a[164:167], a[24:27], v[96:99]
    v_mfma_f32_16x16x32_bf16 v[116:119], a[164:167], a[28:31], v[116:119]
    s_waitcnt lgkmcnt(3)
    v_mfma_f32_16x16x32_bf16 v[60:63], a[168:171], a[16:19], v[60:63]
    v_mfma_f32_16x16x32_bf16 v[80:83], a[168:171], a[20:23], v[80:83]
    ds_read_b128 a[184:187], v4 offset:8192
    v_mfma_f32_16x16x32_bf16 v[100:103], a[168:171], a[24:27], v[100:103]
    v_mfma_f32_16x16x32_bf16 v[120:123], a[168:171], a[28:31], v[120:123]
    s_waitcnt lgkmcnt(3)
    v_mfma_f32_16x16x32_bf16 v[64:67], a[172:175], a[16:19], v[64:67]
    v_mfma_f32_16x16x32_bf16 v[84:87], a[172:175], a[20:23], v[84:87]
    ds_read_b128 a[188:191], v4 offset:12288
    v_mfma_f32_16x16x32_bf16 v[104:107], a[172:175], a[24:27], v[104:107]
    v_mfma_f32_16x16x32_bf16 v[124:127], a[172:175], a[28:31], v[124:127]
    s_waitcnt vmcnt(4) lgkmcnt(3)
    v_mfma_f32_16x16x32_bf16 v[48:51], a[176:179], a[32:35], v[48:51]
    v_mfma_f32_16x16x32_bf16 v[68:71], a[176:179], a[36:39], v[68:71]
    ds_read_b128 a[160:163], v4 offset:16384
    v_mfma_f32_16x16x32_bf16 v[88:91], a[176:179], a[40:43], v[88:91]
    v_mfma_f32_16x16x32_bf16 v[108:111], a[176:179], a[44:47], v[108:111]
    v_add_u32 v12, s15, v1
    v_add_u32 v12, 0xf000, v12
    v_xor_b32 v9, 1024, v12
    v_xor_b32 v10, 2048, v12
    v_xor_b32 v11, 3072, v12
    s_waitcnt lgkmcnt(3)
    v_mfma_f32_16x16x32_bf16 v[52:55], a[180:183], a[32:35], v[52:55]
    v_mfma_f32_16x16x32_bf16 v[72:75], a[180:183], a[36:39], v[72:75]
    ds_read_b128 a[164:167], v4 offset:20480
    v_mfma_f32_16x16x32_bf16 v[92:95], a[180:183], a[40:43], v[92:95]
    v_mfma_f32_16x16x32_bf16 v[112:115], a[180:183], a[44:47], v[112:115]
    s_waitcnt lgkmcnt(3)
    v_mfma_f32_16x16x32_bf16 v[56:59], a[184:187], a[32:35], v[56:59]
    v_mfma_f32_16x16x32_bf16 v[76:79], a[184:187], a[36:39], v[76:79]
    ds_read_b128 a[168:171], v4 offset:24576
    v_mfma_f32_16x16x32_bf16 v[96:99], a[184:187], a[40:43], v[96:99]
    v_mfma_f32_16x16x32_bf16 v[116:119], a[184:187], a[44:47], v[116:119]
    s_waitcnt lgkmcnt(3)
    v_mfma_f32_16x16x32_bf16 v[60:63], a[188:191], a[32:35], v[60:63]
    v_mfma_f32_16x16x32_bf16 v[80:83], a[188:191], a[36:39], v[80:83]
    ds_read_b128 a[172:175], v4 offset:28672
    v_mfma_f32_16x16x32_bf16 v[100:103], a[188:191], a[40:43], v[100:103]
    v_mfma_f32_16x16x32_bf16 v[120:123], a[188:191], a[44:47], v[120:123]
    s_waitcnt lgkmcnt(3)
    v_mfma_f32_16x16x32_bf16 v[64:67], a[160:163], a[32:35], v[64:67]
    v_mfma_f32_16x16x32_bf16 v[84:87], a[160:163], a[36:39], v[84:87]
    ds_read_b128 a[176:179], v4 offset:32768
    v_mfma_f32_16x16x32_bf16 v[104:107], a[160:163], a[40:43], v[104:107]
    v_mfma_f32_16x16x32_bf16 v[124:127], a[160:163], a[44:47], v[124:127]
    s_waitcnt vmcnt(0) lgkmcnt(3)
    v_mfma_f32_16x16x32_bf16 v[68:71], a[164:167], a[52:55], v[68:71]
    ds_read_b128 a[180:183], v4 offset:36864
    v_mfma_f32_16x16x32_bf16 v[88:91], a[164:167], a[56:59], v[88:91]
    v_mfma_f32_16x16x32_bf16 v[108:111], a[164:167], a[60:63], v[108:111]
    v_mfma_f32_16x16x32_bf16 v[48:51], a[164:167], a[48:51], v[48:51]
    s_waitcnt lgkmcnt(3)
    v_mfma_f32_16x16x32_bf16 v[72:75], a[168:171], a[52:55], v[72:75]
    v_mfma_f32_16x16x32_bf16 v[92:95], a[168:171], a[56:59], v[92:95]
    v_mfma_f32_16x16x32_bf16 v[112:115], a[168:171], a[60:63], v[112:115]
    v_mfma_f32_16x16x32_bf16 v[52:55], a[168:171], a[48:51], v[52:55]
    ds_write_b128 v12, v[68:71] offset:0
    ds_write_b128 v12, v[88:91] offset:4096
    ds_write_b128 v12, v[108:111] offset:8192
    s_waitcnt lgkmcnt(5)
    v_mfma_f32_16x16x32_bf16 v[76:79], a[172:175], a[52:55], v[76:79]
    v_mfma_f32_16x16x32_bf16 v[96:99], a[172:175], a[56:59], v[96:99]
    v_mfma_f32_16x16x32_bf16 v[116:119], a[172:175], a[60:63], v[116:119]
    v_mfma_f32_16x16x32_bf16 v[56:59], a[172:175], a[48:51], v[56:59]
    ds_write_b128 v12, v[72:75] offset:12288
    ds_write_b128 v12, v[92:95] offset:16384
    ds_write_b128 v12, v[112:115] offset:20480
    s_waitcnt lgkmcnt(7)
    v_mfma_f32_16x16x32_bf16 v[80:83], a[176:179], a[52:55], v[80:83]
    v_mfma_f32_16x16x32_bf16 v[100:103], a[176:179], a[56:59], v[100:103]
    v_mfma_f32_16x16x32_bf16 v[120:123], a[176:179], a[60:63], v[120:123]
    v_mfma_f32_16x16x32_bf16 v[60:63], a[176:179], a[48:51], v[60:63]
    ds_write_b128 v12, v[76:79] offset:24576
    ds_write_b128 v12, v[96:99] offset:28672
    ds_write_b128 v12, v[116:119] offset:32768
    s_waitcnt lgkmcnt(9)
    v_mfma_f32_16x16x32_bf16 v[84:87], a[180:183], a[52:55], v[84:87]
    v_mfma_f32_16x16x32_bf16 v[104:107], a[180:183], a[56:59], v[104:107]
    v_mfma_f32_16x16x32_bf16 v[124:127], a[180:183], a[60:63], v[124:127]
    v_mfma_f32_16x16x32_bf16 v[64:67], a[180:183], a[48:51], v[64:67]
    ds_write_b128 v12, v[80:83] offset:36864
    ds_write_b128 v12, v[100:103] offset:40960
    ds_write_b128 v12, v[120:123] offset:45056
    s_nop 1
    ds_write_b128 v12, v[84:87] offset:49152
    ds_write_b128 v12, v[104:107] offset:53248
    ds_write_b128 v12, v[124:127] offset:57344
    v_lshlrev_b32 v128, 16, v16
    v_and_b32 v129, 0xffff0000, v16
    v_lshlrev_b32 v148, 16, v26
    v_and_b32 v149, 0xffff0000, v26
    v_lshlrev_b32 v130, 16, v17
    v_and_b32 v131, 0xffff0000, v17
    v_lshlrev_b32 v150, 16, v27
    v_and_b32 v151, 0xffff0000, v27
    v_lshlrev_b32 v132, 16, v18
    v_and_b32 v133, 0xffff0000, v18
    v_lshlrev_b32 v152, 16, v28
    v_and_b32 v153, 0xffff0000, v28
    v_lshlrev_b32 v134, 16, v19
    v_and_b32 v135, 0xffff0000, v19
    v_lshlrev_b32 v154, 16, v29
    v_and_b32 v155, 0xffff0000, v29
    v_lshlrev_b32 v136, 16, v20
    v_and_b32 v137, 0xffff0000, v20
    v_lshlrev_b32 v156, 16, v30
    v_and_b32 v157, 0xffff0000, v30
    v_lshlrev_b32 v138, 16, v21
    v_and_b32 v139, 0xffff0000, v21
    v_lshlrev_b32 v158, 16, v31
    v_and_b32 v159, 0xffff0000, v31
    v_lshlrev_b32 v140, 16, v22
    v_and_b32 v141, 0xffff0000, v22
    v_lshlrev_b32 v160, 16, v32
    v_and_b32 v161, 0xffff0000, v32
    v_lshlrev_b32 v142, 16, v23
    v_and_b32 v143, 0xffff0000, v23
    v_lshlrev_b32 v162, 16, v33
    v_and_b32 v163, 0xffff0000, v33
    v_lshlrev_b32 v144, 16, v24
    v_and_b32 v145, 0xffff0000, v24
    v_lshlrev_b32 v164, 16, v34
    v_and_b32 v165, 0xffff0000, v34
    v_lshlrev_b32 v146, 16, v25
    v_and_b32 v147, 0xffff0000, v25
    v_lshlrev_b32 v166, 16, v35
    v_and_b32 v167, 0xffff0000, v35
    s_mul_i32 s70, s56, 2560
    v_and_b32 v13, 15, v0
    v_mul_u32_u24 v13, 0xa0, v13
    v_add_u32 v13, s70, v13
    v_lshrrev_b32 v14, 4, v0
    v_lshl_add_u32 v15, v14, 3, v13
    v_lshl_add_u32 v13, v14, 4, v13
    v_add_u32 v14, s70, v1
    s_waitcnt lgkmcnt(0)
    s_barrier
    ds_read_b128 v[68:71], v9 offset:0
    ds_read_b128 v[88:91], v10 offset:4096
    ds_read_b128 v[108:111], v11 offset:8192
    ds_read_b128 v[72:75], v9 offset:12288
    ds_read_b128 v[92:95], v10 offset:16384
    ds_read_b128 v[112:115], v11 offset:20480
    ds_read_b128 v[76:79], v9 offset:24576
    ds_read_b128 v[96:99], v10 offset:28672
    ds_read_b128 v[116:119], v11 offset:32768
    ds_read_b128 v[80:83], v9 offset:36864
    ds_read_b128 v[100:103], v10 offset:40960
    ds_read_b128 v[120:123], v11 offset:45056
    ds_read_b128 v[84:87], v9 offset:49152
    ds_read_b128 v[104:107], v10 offset:53248
    ds_read_b128 v[124:127], v11 offset:57344
    s_waitcnt lgkmcnt(12)
    v_pk_add_f32 v[48:49], v[48:49], v[68:69]
    v_pk_add_f32 v[88:89], v[88:89], v[108:109]
    v_pk_add_f32 v[50:51], v[50:51], v[70:71]
    v_pk_add_f32 v[90:91], v[90:91], v[110:111]
    v_pk_add_f32 v[48:49], v[48:49], v[88:89]
    v_pk_add_f32 v[50:51], v[50:51], v[90:91]
    v_pk_fma_f32 v[48:49], v[48:49], v[148:149], v[128:129]
    v_pk_fma_f32 v[50:51], v[50:51], v[150:151], v[130:131]
    v_cvt_pk_bf16_f32 v176, v48, v49
    v_cvt_pk_bf16_f32 v177, v50, v51
    s_waitcnt lgkmcnt(9)
    v_pk_add_f32 v[52:53], v[52:53], v[72:73]
    v_pk_add_f32 v[92:93], v[92:93], v[112:113]
    v_pk_add_f32 v[54:55], v[54:55], v[74:75]
    v_pk_add_f32 v[94:95], v[94:95], v[114:115]
    v_pk_add_f32 v[52:53], v[52:53], v[92:93]
    v_pk_add_f32 v[54:55], v[54:55], v[94:95]
    v_pk_fma_f32 v[52:53], v[52:53], v[152:153], v[132:133]
    v_pk_fma_f32 v[54:55], v[54:55], v[154:155], v[134:135]
    v_cvt_pk_bf16_f32 v178, v52, v53
    v_cvt_pk_bf16_f32 v179, v54, v55
    s_waitcnt lgkmcnt(6)
    v_pk_add_f32 v[56:57], v[56:57], v[76:77]
    v_pk_add_f32 v[96:97], v[96:97], v[116:117]
    v_pk_add_f32 v[58:59], v[58:59], v[78:79]
    v_pk_add_f32 v[98:99], v[98:99], v[118:119]
    v_pk_add_f32 v[56:57], v[56:57], v[96:97]
    v_pk_add_f32 v[58:59], v[58:59], v[98:99]
    v_pk_fma_f32 v[56:57], v[56:57], v[156:157], v[136:137]
    v_pk_fma_f32 v[58:59], v[58:59], v[158:159], v[138:139]
    v_cvt_pk_bf16_f32 v180, v56, v57
    v_cvt_pk_bf16_f32 v181, v58, v59
    s_waitcnt lgkmcnt(3)
    v_pk_add_f32 v[60:61], v[60:61], v[80:81]
    v_pk_add_f32 v[100:101], v[100:101], v[120:121]
    v_pk_add_f32 v[62:63], v[62:63], v[82:83]
    v_pk_add_f32 v[102:103], v[102:103], v[122:123]
    v_pk_add_f32 v[60:61], v[60:61], v[100:101]
    v_pk_add_f32 v[62:63], v[62:63], v[102:103]
    v_pk_fma_f32 v[60:61], v[60:61], v[160:161], v[140:141]
    v_pk_fma_f32 v[62:63], v[62:63], v[162:163], v[142:143]
    v_cvt_pk_bf16_f32 v182, v60, v61
    v_cvt_pk_bf16_f32 v183, v62, v63
    s_waitcnt lgkmcnt(0)
    v_pk_add_f32 v[64:65], v[64:65], v[84:85]
    v_pk_add_f32 v[104:105], v[104:105], v[124:125]
    v_pk_add_f32 v[66:67], v[66:67], v[86:87]
    v_pk_add_f32 v[106:107], v[106:107], v[126:127]
    v_pk_add_f32 v[64:65], v[64:65], v[104:105]
    v_pk_add_f32 v[66:67], v[66:67], v[106:107]
    v_pk_fma_f32 v[64:65], v[64:65], v[164:165], v[144:145]
    v_pk_fma_f32 v[66:67], v[66:67], v[166:167], v[146:147]
    v_cvt_pk_bf16_f32 v184, v64, v65
    v_cvt_pk_bf16_f32 v185, v66, v67
    ds_write_b128 v13, v[176:179]
    ds_write_b128 v13, v[180:183] offset:64
    ds_write_b64 v15, v[184:185] offset:128
    ds_read_b128 v[188:191], v14 offset:0
    ds_read_b128 v[192:195], v14 offset:1024
    ds_read_b128 v[196:199], v14 offset:2048
    s_waitcnt lgkmcnt(2)
    buffer_store_dwordx4 v[188:191], v39, s[52:55], s17 offen
    s_waitcnt lgkmcnt(1)
    buffer_store_dwordx4 v[192:195], v40, s[52:55], s17 offen
    s_waitcnt lgkmcnt(0)
    s_mov_b32 exec_hi, 0
    buffer_store_dwordx4 v[196:199], v41, s[52:55], s17 offen
    s_mov_b64 exec, -1
L_end:
    s_endpgm
.section .rodata,"a"
.p2align 6
.amdhsa_kernel adaLN_cond__linear_kernel_hedgehog__glu_gated_swiglu__prompt_kernel
  .amdhsa_next_free_vgpr 512
  .amdhsa_next_free_sgpr 102
  .amdhsa_accum_offset 256
  .amdhsa_group_segment_fixed_size 0
  .amdhsa_kernarg_size 104
  .amdhsa_user_sgpr_count 2
  .amdhsa_user_sgpr_kernarg_segment_ptr 1
  .amdhsa_system_sgpr_workgroup_id_x 1
  .amdhsa_float_denorm_mode_32 3
.end_amdhsa_kernel
```
